```python
import torch

def _softmax(x, axis=-1):
    return torch.softmax(x, dim=axis)

def _gelu(x):
    return torch.nn.functional.gelu(x, approximate='tanh')

def _silu(x):
    return torch.nn.functional.silu(x)

def _sigmoid(x):
    return torch.sigmoid(x)

def _layernorm(x, axis=-1, eps=1e-05):
    m = x.mean(dim=axis, keepdim=True)
    v = x.var(dim=axis, keepdim=True, unbiased=False)
    return (x - m) / torch.sqrt(v + eps)

def _scatter_add(tgt, idx, src, axis=0):
    return tgt.clone().index_add_(axis, idx, src)

def _segment_sum(src, seg, n):
    out = torch.zeros((n,) + src.shape[1:], dtype=src.dtype)
    return out.index_add_(0, seg, src)

def _pad(x, pw):
    flat = tuple((v for pair in reversed(pw) for v in pair))
    return torch.nn.functional.pad(x, flat)
kernel_name = 'interleave_layers__memory_aug_recurrent_mem_tr__glu_gated_glu__prompt'

def setup_inputs():

    _w = lambda a: (lambda t: t.to(torch.bfloat16) if t.is_floating_point() else t)(torch.as_tensor(a))

    def _A_setup():
        B, S, Dm = (1, 2048, 448)
        H, Dh = (16, 256)
        M, seg = (8, 32)
        seg = min(seg, S)
        S = S // seg * seg
        return {'x': _w((lambda *s: torch.randn(*s, dtype=torch.bfloat16) * 0.05)(B, S, Dm)), 'mem0': _w((lambda *s: torch.randn(*s, dtype=torch.bfloat16) * 0.8)(B, M, Dm)), 'Wq': _w((lambda *s: torch.randn(*s, dtype=torch.bfloat16) * 0.8)(Dm, H, Dh) * Dm ** (-0.5)), 'Wk': _w((lambda *s: torch.randn(*s, dtype=torch.bfloat16) * 0.8)(Dm, H, Dh) * Dm ** (-0.5)), 'Wv': _w((lambda *s: torch.randn(*s, dtype=torch.bfloat16) * 0.8)(Dm, H, Dh) * Dm ** (-0.5)), 'Wo': _w((lambda *s: torch.randn(*s, dtype=torch.bfloat16) * 0.8)(H, Dh, Dm) * (H * Dh) ** (-0.5)), 'seg_len': seg}
    _A_in = _A_setup()

    def _B_setup():
        B, S, D, F = (1, 2048, 448, 1792)
        return {'x': _w((lambda *s: torch.randn(*s, dtype=torch.bfloat16) * 0.05)(B, S, D)), 'w_gate': _w((lambda *s: torch.randn(*s, dtype=torch.bfloat16) * 0.05)(D, F)), 'w_up': _w((lambda *s: torch.randn(*s, dtype=torch.bfloat16) * 0.05)(D, F)), 'w_down': _w((lambda *s: torch.randn(*s, dtype=torch.bfloat16) * 0.05)(F, D))}
    _B_in = _B_setup()
    return {'A_x': _A_in['x'], 'A_mem0': _A_in['mem0'], 'A_Wq': _A_in['Wq'], 'A_Wk': _A_in['Wk'], 'A_Wv': _A_in['Wv'], 'A_Wo': _A_in['Wo'], 'A_seg_len': _A_in['seg_len'], 'B_x': _B_in['x'], 'B_w_gate': _B_in['w_gate'], 'B_w_up': _B_in['w_up'], 'B_w_down': _B_in['w_down']}

def reference(A_x, A_mem0, A_Wq, A_Wk, A_Wv, A_Wo, A_seg_len, B_x, B_w_gate, B_w_up, B_w_down):

    def _A_ref(x, mem0, Wq, Wk, Wv, Wo, seg_len):
        B, S, Dm = x.shape
        H, Dh = (Wq.shape[1], Wq.shape[2])
        M = mem0.shape[1]
        scale = Dh ** (-0.5)
        n_seg = S // seg_len
        L = M + seg_len
        idx = torch.arange(L)
        mask = (idx[:, None] < M) | (idx[:, None] >= idx[None, :])
        mem = mem0
        outs = []
        for s in range(n_seg):
            xs = x[:, s * seg_len:(s + 1) * seg_len, :].clone()
            h = torch.concatenate([mem, xs], axis=1)
            q = torch.einsum('btd,dhe->bhte', h, Wq)
            k = torch.einsum('btd,dhe->bhte', h, Wk)
            v = torch.einsum('btd,dhe->bhte', h, Wv)
            scores = torch.einsum('bhqe,bhke->bhqk', q, k) * scale
            scores = torch.where(mask[None, None], scores, -1000000000.0)
            p = _softmax(scores, axis=-1)
            o = torch.einsum('bhqk,bhke->bhqe', p, v)
            o = torch.einsum('bhte,hed->btd', o, Wo)
            mem = o[:, :M, :].clone()
            outs.append(o[:, M:, :])
        return torch.concatenate(outs, axis=1)

    def _B_ref(x, w_gate, w_up, w_down):
        g = torch.einsum('bsd,df->bsf', x, w_gate)
        u = torch.einsum('bsd,df->bsf', x, w_up)
        h = _sigmoid(g) * u
        return torch.einsum('bsf,fd->bsd', h, w_down)
    x = A_x
    x = x + _A_ref(_layernorm(x, axis=-1), A_mem0, A_Wq, A_Wk, A_Wv, A_Wo, A_seg_len)
    x = x + _B_ref(_layernorm(x, axis=-1), B_w_gate, B_w_up, B_w_down)
    x = x + _A_ref(_layernorm(x, axis=-1), A_mem0, A_Wq, A_Wk, A_Wv, A_Wo, A_seg_len)
    x = x + _B_ref(_layernorm(x, axis=-1), B_w_gate, B_w_up, B_w_down)
    return x
```

```asm
; @launch grid=(256,1,1) block=(256,1,1) lds=163840
.amdgcn_target "amdgcn-amd-amdhsa--gfx950"
.text
.globl interleave_layers__memory_aug_recurrent_mem_tr__glu_gated_glu__prompt_kernel
.p2align 8
.type interleave_layers__memory_aug_recurrent_mem_tr__glu_gated_glu__prompt_kernel,@function
interleave_layers__memory_aug_recurrent_mem_tr__glu_gated_glu__prompt_kernel:
    s_cmp_ge_u32 s2, 256
    s_cbranch_scc1 interleave_layers__memory_aug_recurrent_mem_tr__glu_gated_glu__prompt_kernel_exit
    s_memrealtime s[78:79]
    s_load_dwordx2 s[4:5], s[0:1], 104
    s_load_dwordx2 s[80:81], s[0:1], 96
    s_load_dwordx4 s[40:43], s[0:1], 0
    s_load_dwordx4 s[44:47], s[0:1], 16
    s_load_dwordx4 s[48:51], s[0:1], 32
    s_load_dwordx4 s[52:55], s[0:1], 64
    s_load_dwordx2 s[56:57], s[0:1], 80
    s_getreg_b32 s7, hwreg(HW_REG_XCC_ID)
    s_and_b32 s7, s7, 7
    v_lshrrev_b32 v1, 6, v0
    s_mov_b32 s82, 256
    v_readfirstlane_b32 s12, v1
    s_mov_b32 s83, 0x20000
    s_mov_b32 s10, 0x10000000
    s_mov_b32 s11, 0x20000
    s_getpc_b64 s[22:23]
    s_waitcnt lgkmcnt(0)
    s_mov_b32 s8, s4
    s_mov_b32 s9, s5
    s_and_b32 s78, s78, 0xfffffff0
    s_lshl_b32 s20, s7, 1
    s_or_b32 s78, s78, s20
    s_or_b32 s78, s78, 1
    s_cmp_eq_u32 s12, 0
    s_cbranch_scc1 Ltouch_6
    s_cmp_lg_u32 s12, 1
    s_cbranch_scc1 Ltj_7
    s_bfe_u32 s20, s2, 0x50003
    s_lshl_b32 s20, s20, 11
    v_and_b32 v1, 15, v0
    v_lshlrev_b32 v1, 7, v1
    v_add_u32 v1, s20, v1
    v_min_u32 v2, interleave_layers__memory_aug_recurrent_mem_tr__glu_gated_glu__prompt_kernel_tab-interleave_layers__memory_aug_recurrent_mem_tr__glu_gated_glu__prompt_kernel-256, v1
    global_load_dword v250, v2, s[22:23]
    s_branch Ltj_7
Ltouch_6:
    s_cmp_lg_u32 s2, 248
    s_cbranch_scc1 Ltj_7
    s_mov_b64 exec, 0x1ff
    v_lshlrev_b32 v1, 7, v0
    v_mov_b32 v2, 0
    s_mov_b32 s21, 125730816
    buffer_store_dword v2, v1, s[8:11], s21 offen sc1
    v_mov_b32 v2, s78
    v_mov_b32 v3, s79
    s_mov_b64 exec, 1
    s_waitcnt vmcnt(0)
    buffer_store_dwordx2 v[2:3], v1, s[80:83], 0 offen offset:128 sc1
    s_mov_b64 exec, -1
Ltj_7:
    s_mov_b32 s6, 0
    v_and_b32 v7, 63, v0
    v_lshlrev_b32 v1, 4, v7
    v_lshlrev_b32 v2, 4, v0
    v_mov_b32 v16, -1
    v_mov_b32 v17, -1
    v_mov_b32 v18, -1
    v_mov_b32 v19, -1
    v_mov_b32 v20, 0
    v_mov_b32 v21, 0
    v_mov_b32 v22, 0
    v_mov_b32 v23, 0
    s_cmp_lt_u32 s12, 2
    s_cselect_b32 s24, s44, s48
    s_cselect_b32 s25, s45, s49
    s_cselect_b32 s28, s46, s50
    s_cselect_b32 s29, s47, s51
    s_bitcmp1_b32 s12, 0
    s_cselect_b32 s24, s28, s24
    s_cselect_b32 s25, s29, s25
    s_mov_b32 s26, 3670016
    s_mov_b32 s27, 0x20000
    s_mul_i32 s20, s2, 14336
    v_lshlrev_b32 v8, 7, v7
    v_min_u32 v9, 47, v7
    v_lshlrev_b32 v9, 7, v9
    s_add_u32 s21, s20, 8192
    buffer_load_dword v251, v8, s[24:27], s20 offen
    buffer_load_dword v251, v9, s[24:27], s21 offen
    s_cmp_ge_u32 s2, 224
    s_cbranch_scc1 Lln_9
    s_lshr_b32 s20, s2, 3
    s_mul_i32 s21, s20, 37
    s_lshr_b32 s21, s21, 8
    s_mul_i32 s22, s21, 7
    s_sub_u32 s14, s20, s22
    s_and_b32 s22, s2, 7
    s_lshl_b32 s21, s21, 3
    s_add_u32 s13, s21, s22
    s_and_b32 s15, s13, 15
    s_lshl_b32 s16, s14, 2
    s_add_u32 s16, s16, s12
    v_and_b32 v3, 15, v7
    v_lshrrev_b32 v4, 4, v7
    v_lshrrev_b32 v5, 2, v3
    v_and_b32 v6, 3, v3
    v_lshl_add_u32 v5, v5, 3, v6
    v_lshlrev_b32 v5, 13, v5
    v_lshl_add_u32 v5, v4, 4, v5
    s_lshl_b32 s17, s15, 9
    s_lshl_b32 s37, s12, 13
    s_mov_b32 s26, 3670016
    s_mov_b32 s27, 0x20000
    s_mov_b32 s30, 3670016
    s_mov_b32 s31, 0x20000
    s_cmp_ge_u32 s13, 16
    s_cbranch_scc1 Lfv_10
    s_mov_b32 s24, s44
    s_mov_b32 s25, s45
    s_mov_b32 s28, s46
    s_mov_b32 s29, s47
    v_lshrrev_b32 v24, 2, v7
    v_lshlrev_b32 v24, 13, v24
    v_and_b32 v25, 3, v7
    v_lshl_add_u32 v24, v25, 7, v24
    s_lshl_b32 s21, s16, 17
    s_add_u32 s21, s21, s17
    buffer_load_dword v251, v24, s[24:27], s21 offen
    s_mov_b32 s32, 1035512379
    s_mov_b32 s33, 0
    s_lshr_b32 s20, s16, 1
    s_lshl_b32 s20, s20, 5
    s_and_b32 s21, s16, 1
    s_lshl_b32 s21, s21, 2
    s_add_u32 s20, s20, s21
    s_lshl_b32 s20, s20, 13
    s_add_u32 s20, s20, s17
    s_add_u32 m0, s37, 0
    s_nop 0
    buffer_load_dwordx4 v5, s[28:31], s20 offen offset:0  lds
    s_add_u32 m0, s37, 960
    s_nop 0
    buffer_load_dwordx4 v5, s[28:31], s20 offen offset:64  lds
    s_add_u32 m0, s37, 1920
    s_nop 0
    buffer_load_dwordx4 v5, s[28:31], s20 offen offset:128  lds
    s_add_u32 m0, s37, 2880
    s_nop 0
    buffer_load_dwordx4 v5, s[28:31], s20 offen offset:192  lds
    s_add_u32 m0, s37, 3840
    s_nop 0
    buffer_load_dwordx4 v5, s[28:31], s20 offen offset:256  lds
    s_add_u32 m0, s37, 4800
    s_nop 0
    buffer_load_dwordx4 v5, s[28:31], s20 offen offset:320  lds
    s_add_u32 m0, s37, 5760
    s_nop 0
    buffer_load_dwordx4 v5, s[28:31], s20 offen offset:384  lds
    s_add_u32 m0, s37, 6720
    s_nop 0
    buffer_load_dwordx4 v5, s[28:31], s20 offen offset:448  lds
    s_branch Lfj_11
Lfv_10:
    s_mov_b32 s24, s48
    s_mov_b32 s25, s49
    s_mov_b32 s28, s50
    s_mov_b32 s29, s51
    v_lshrrev_b32 v24, 2, v7
    v_lshlrev_b32 v24, 13, v24
    v_and_b32 v25, 3, v7
    v_lshl_add_u32 v24, v25, 7, v24
    s_lshl_b32 s21, s16, 17
    s_add_u32 s21, s21, s17
    buffer_load_dword v251, v24, s[24:27], s21 offen
    s_mov_b32 s32, 1.0
    s_mov_b32 s33, 6422528
    v_lshrrev_b32 v8, 1, v7
    v_mul_u32_u24 v8, 896, v8
    v_and_b32 v9, 1, v7
    v_lshl_add_u32 v8, v9, 4, v8
    s_mul_i32 s21, s15, 229376
    s_lshl_b32 s20, s16, 5
    s_add_u32 s21, s21, s20
    s_add_u32 m0, s37, 0
    s_add_u32 s20, s21, 0
    buffer_load_dwordx4 v8, s[28:31], s20 offen  lds
    s_add_u32 m0, s37, 1024
    s_add_u32 s20, s21, 28672
    buffer_load_dwordx4 v8, s[28:31], s20 offen  lds
    s_add_u32 m0, s37, 2048
    s_add_u32 s20, s21, 57344
    buffer_load_dwordx4 v8, s[28:31], s20 offen  lds
    s_add_u32 m0, s37, 3072
    s_add_u32 s20, s21, 86016
    buffer_load_dwordx4 v8, s[28:31], s20 offen  lds
    s_add_u32 m0, s37, 4096
    s_add_u32 s20, s21, 114688
    buffer_load_dwordx4 v8, s[28:31], s20 offen  lds
    s_add_u32 m0, s37, 5120
    s_add_u32 s20, s21, 143360
    buffer_load_dwordx4 v8, s[28:31], s20 offen  lds
    s_add_u32 m0, s37, 6144
    s_add_u32 s20, s21, 172032
    buffer_load_dwordx4 v8, s[28:31], s20 offen  lds
    s_add_u32 m0, s37, 7168
    s_add_u32 s20, s21, 200704
    buffer_load_dwordx4 v8, s[28:31], s20 offen  lds
Lfj_11:
    v_lshrrev_b32 v24, 3, v7
    v_and_b32 v25, 7, v7
    v_bfe_u32 v26, v7, 4, 1
    v_xor_b32 v25, v25, v26
    v_lshlrev_b32 v24, 13, v24
    v_xor_b32 v26, 0, v25
    v_lshl_add_u32 v10, v26, 4, v24
    v_add_u32 v10, 0, v10
    v_xor_b32 v26, 2, v25
    v_lshl_add_u32 v11, v26, 4, v24
    v_add_u32 v11, 65536, v11
    v_xor_b32 v26, 4, v25
    v_lshl_add_u32 v12, v26, 4, v24
    v_add_u32 v12, 131072, v12
    v_xor_b32 v26, 6, v25
    v_lshl_add_u32 v13, v26, 4, v24
    v_add_u32 v13, 196608, v13
    s_lshl_b32 s38, s12, 15
    s_add_u32 s38, s38, 32768
    v_lshrrev_b32 v24, 2, v3
    v_lshlrev_b32 v14, 10, v24
    v_lshl_add_u32 v14, v6, 7, v14
    v_lshlrev_b32 v24, 1, v24
    v_lshrrev_b32 v25, 1, v6
    v_or_b32 v24, v24, v25
    v_xor_b32 v24, v24, v4
    v_lshl_add_u32 v14, v24, 4, v14
    v_add_u32 v14, s38, v14
    v_xor_b32 v15, 64, v14
    s_add_u32 s34, s12, 0
    s_lshl_b32 s34, s34, 18
    s_add_u32 s34, s34, s17
    s_add_u32 m0, s38, 0
    s_nop 0
    buffer_load_dwordx4 v10, s[24:27], s34 offen offset:0  lds
    s_add_u32 m0, s38, 1024
    s_nop 0
    buffer_load_dwordx4 v11, s[24:27], s34 offen offset:0  lds
    s_add_u32 m0, s38, 2048
    s_nop 0
    buffer_load_dwordx4 v12, s[24:27], s34 offen offset:0  lds
    s_add_u32 m0, s38, 3072
    s_nop 0
    buffer_load_dwordx4 v13, s[24:27], s34 offen offset:0  lds
    s_add_u32 m0, s38, 3968
    s_nop 0
    buffer_load_dwordx4 v10, s[24:27], s34 offen offset:128  lds
    s_add_u32 m0, s38, 4992
    s_nop 0
    buffer_load_dwordx4 v11, s[24:27], s34 offen offset:128  lds
    s_add_u32 m0, s38, 6016
    s_nop 0
    buffer_load_dwordx4 v12, s[24:27], s34 offen offset:128  lds
    s_add_u32 m0, s38, 7040
    s_nop 0
    buffer_load_dwordx4 v13, s[24:27], s34 offen offset:128  lds
    s_add_u32 m0, s38, 7936
    s_nop 0
    buffer_load_dwordx4 v10, s[24:27], s34 offen offset:256  lds
    s_add_u32 m0, s38, 8960
    s_nop 0
    buffer_load_dwordx4 v11, s[24:27], s34 offen offset:256  lds
    s_add_u32 m0, s38, 9984
    s_nop 0
    buffer_load_dwordx4 v12, s[24:27], s34 offen offset:256  lds
    s_add_u32 m0, s38, 11008
    s_nop 0
    buffer_load_dwordx4 v13, s[24:27], s34 offen offset:256  lds
    s_add_u32 m0, s38, 11904
    s_nop 0
    buffer_load_dwordx4 v10, s[24:27], s34 offen offset:384  lds
    s_add_u32 m0, s38, 12928
    s_nop 0
    buffer_load_dwordx4 v11, s[24:27], s34 offen offset:384  lds
    s_add_u32 m0, s38, 13952
    s_nop 0
    buffer_load_dwordx4 v12, s[24:27], s34 offen offset:384  lds
    s_add_u32 m0, s38, 14976
    s_nop 0
    buffer_load_dwordx4 v13, s[24:27], s34 offen offset:384  lds
    s_add_u32 s34, s12, 4
    s_lshl_b32 s34, s34, 18
    s_add_u32 s34, s34, s17
    s_add_u32 m0, s38, 16384
    s_nop 0
    buffer_load_dwordx4 v10, s[24:27], s34 offen offset:0  lds
    s_add_u32 m0, s38, 17408
    s_nop 0
    buffer_load_dwordx4 v11, s[24:27], s34 offen offset:0  lds
    s_add_u32 m0, s38, 18432
    s_nop 0
    buffer_load_dwordx4 v12, s[24:27], s34 offen offset:0  lds
    s_add_u32 m0, s38, 19456
    s_nop 0
    buffer_load_dwordx4 v13, s[24:27], s34 offen offset:0  lds
    s_add_u32 m0, s38, 20352
    s_nop 0
    buffer_load_dwordx4 v10, s[24:27], s34 offen offset:128  lds
    s_add_u32 m0, s38, 21376
    s_nop 0
    buffer_load_dwordx4 v11, s[24:27], s34 offen offset:128  lds
    s_add_u32 m0, s38, 22400
    s_nop 0
    buffer_load_dwordx4 v12, s[24:27], s34 offen offset:128  lds
    s_add_u32 m0, s38, 23424
    s_nop 0
    buffer_load_dwordx4 v13, s[24:27], s34 offen offset:128  lds
    s_add_u32 m0, s38, 24320
    s_nop 0
    buffer_load_dwordx4 v10, s[24:27], s34 offen offset:256  lds
    s_add_u32 m0, s38, 25344
    s_nop 0
    buffer_load_dwordx4 v11, s[24:27], s34 offen offset:256  lds
    s_add_u32 m0, s38, 26368
    s_nop 0
    buffer_load_dwordx4 v12, s[24:27], s34 offen offset:256  lds
    s_add_u32 m0, s38, 27392
    s_nop 0
    buffer_load_dwordx4 v13, s[24:27], s34 offen offset:256  lds
    s_add_u32 m0, s38, 28288
    s_nop 0
    buffer_load_dwordx4 v10, s[24:27], s34 offen offset:384  lds
    s_add_u32 m0, s38, 29312
    s_nop 0
    buffer_load_dwordx4 v11, s[24:27], s34 offen offset:384  lds
    s_add_u32 m0, s38, 30336
    s_nop 0
    buffer_load_dwordx4 v12, s[24:27], s34 offen offset:384  lds
    s_add_u32 m0, s38, 31360
    s_nop 0
    buffer_load_dwordx4 v13, s[24:27], s34 offen offset:384  lds
    s_lshl_b32 s20, s2, 13
    s_add_u32 s20, s20, 119013376
    s_cmp_eq_u32 s2, 0
    s_cselect_b32 s20, 1879048192, s20
    s_cmp_eq_u32 s2, 4
    s_cselect_b32 s20, 1879048192, s20
    s_cmp_eq_u32 s2, 24
    s_cselect_b32 s20, 1879048192, s20
    s_cmp_eq_u32 s2, 88
    s_cselect_b32 s20, 1879048192, s20
    s_add_u32 s21, s20, 4096
    buffer_store_dwordx4 v[16:19], v2, s[8:11], s20 offen sc1
    buffer_store_dwordx4 v[16:19], v2, s[8:11], s21 offen sc1
    s_lshl_b32 s20, s2, 13
    s_add_u32 s20, s20, 121110528
    s_cmp_ge_u32 s2, 88
    s_cselect_b32 s20, 1879048192, s20
    s_add_u32 s21, s20, 4096
    buffer_store_dwordx4 v[16:19], v2, s[8:11], s20 offen sc1
    buffer_store_dwordx4 v[16:19], v2, s[8:11], s21 offen sc1
    s_mul_i32 s20, s2, 20480
    s_add_u32 s20, s20, 113770496
    buffer_store_dwordx4 v[16:19], v2, s[8:11], s20 offen sc1
    s_add_u32 s20, s20, 4096
    buffer_store_dwordx4 v[16:19], v2, s[8:11], s20 offen sc1
    s_add_u32 s20, s20, 4096
    buffer_store_dwordx4 v[16:19], v2, s[8:11], s20 offen sc1
    s_add_u32 s20, s20, 4096
    buffer_store_dwordx4 v[16:19], v2, s[8:11], s20 offen sc1
    s_add_u32 s20, s20, 4096
    buffer_store_dwordx4 v[16:19], v2, s[8:11], s20 offen sc1
    s_add_u32 s20, s20, 4096
    s_lshl_b32 s20, s2, 12
    s_add_u32 s20, s20, 121831424
    buffer_store_dwordx4 v[20:23], v2, s[8:11], s20 offen sc1
    s_lshl_b32 s20, s2, 12
    s_add_u32 s20, s20, 122880000
    s_cmp_ge_u32 s2, 129
    s_cselect_b32 s20, 1879048192, s20
    buffer_store_dwordx4 v[20:23], v2, s[8:11], s20 offen sc1
    v_mov_b32 v44, 0
    s_waitcnt vmcnt(43)
    s_barrier
    s_cmp_ge_u32 s13, 16
    s_cbranch_scc1 Lfb_12
    ds_read_b128 v[128:131], v1 offset:0
    ds_read_b128 v[132:135], v1 offset:1024
    ds_read_b128 v[136:139], v1 offset:2048
    ds_read_b128 v[140:143], v1 offset:3072
    ds_read_b128 v[144:147], v1 offset:4096
    ds_read_b128 v[148:151], v1 offset:5120
    ds_read_b128 v[152:155], v1 offset:6144
    ds_read_b128 v[156:159], v1 offset:7168
    ds_read_b128 v[160:163], v1 offset:8192
    ds_read_b128 v[164:167], v1 offset:9216
    ds_read_b128 v[168:171], v1 offset:10240
    ds_read_b128 v[172:175], v1 offset:11264
    ds_read_b128 v[176:179], v1 offset:12288
    ds_read_b128 v[180:183], v1 offset:13312
    ds_read_b128 v[184:187], v1 offset:14336
    ds_read_b128 v[188:191], v1 offset:15360
    ds_read_b128 v[192:195], v1 offset:16384
    ds_read_b128 v[196:199], v1 offset:17408
    ds_read_b128 v[200:203], v1 offset:18432
    ds_read_b128 v[204:207], v1 offset:19456
    ds_read_b128 v[208:211], v1 offset:20480
    ds_read_b128 v[212:215], v1 offset:21504
    ds_read_b128 v[216:219], v1 offset:22528
    ds_read_b128 v[220:223], v1 offset:23552
    ds_read_b128 v[224:227], v1 offset:24576
    ds_read_b128 v[228:231], v1 offset:25600
    ds_read_b128 v[232:235], v1 offset:26624
    ds_read_b128 v[236:239], v1 offset:27648
    ds_read_b128 v[240:243], v1 offset:28672
    ds_read_b128 v[244:247], v1 offset:29696
    ds_read_b128 v[248:251], v1 offset:30720
    ds_read_b128 v[252:255], v1 offset:31744
    s_branch Lfc_13
Lfb_12:
    v_lshlrev_b32 v9, 8, v4
    v_lshl_add_u32 v9, v3, 3, v9
    ds_read_b64_tr_b16 v[128:129], v9 offset:0
    ds_read_b64_tr_b16 v[130:131], v9 offset:128
    ds_read_b64_tr_b16 v[132:133], v9 offset:1024
    ds_read_b64_tr_b16 v[134:135], v9 offset:1152
    ds_read_b64_tr_b16 v[136:137], v9 offset:2048
    ds_read_b64_tr_b16 v[138:139], v9 offset:2176
    ds_read_b64_tr_b16 v[140:141], v9 offset:3072
    ds_read_b64_tr_b16 v[142:143], v9 offset:3200
    s_waitcnt lgkmcnt(4)
    ds_read_b64_tr_b16 v[144:145], v9 offset:4096
    ds_read_b64_tr_b16 v[146:147], v9 offset:4224
    ds_read_b64_tr_b16 v[148:149], v9 offset:5120
    ds_read_b64_tr_b16 v[150:151], v9 offset:5248
    ds_read_b64_tr_b16 v[152:153], v9 offset:6144
    ds_read_b64_tr_b16 v[154:155], v9 offset:6272
    ds_read_b64_tr_b16 v[156:157], v9 offset:7168
    ds_read_b64_tr_b16 v[158:159], v9 offset:7296
    s_waitcnt lgkmcnt(4)
    ds_read_b64_tr_b16 v[160:161], v9 offset:8192
    ds_read_b64_tr_b16 v[162:163], v9 offset:8320
    ds_read_b64_tr_b16 v[164:165], v9 offset:9216
    ds_read_b64_tr_b16 v[166:167], v9 offset:9344
    ds_read_b64_tr_b16 v[168:169], v9 offset:10240
    ds_read_b64_tr_b16 v[170:171], v9 offset:10368
    ds_read_b64_tr_b16 v[172:173], v9 offset:11264
    ds_read_b64_tr_b16 v[174:175], v9 offset:11392
    s_waitcnt lgkmcnt(4)
    ds_read_b64_tr_b16 v[176:177], v9 offset:12288
    ds_read_b64_tr_b16 v[178:179], v9 offset:12416
    ds_read_b64_tr_b16 v[180:181], v9 offset:13312
    ds_read_b64_tr_b16 v[182:183], v9 offset:13440
    ds_read_b64_tr_b16 v[184:185], v9 offset:14336
    ds_read_b64_tr_b16 v[186:187], v9 offset:14464
    ds_read_b64_tr_b16 v[188:189], v9 offset:15360
    ds_read_b64_tr_b16 v[190:191], v9 offset:15488
    s_waitcnt lgkmcnt(4)
    ds_read_b64_tr_b16 v[192:193], v9 offset:16384
    ds_read_b64_tr_b16 v[194:195], v9 offset:16512
    ds_read_b64_tr_b16 v[196:197], v9 offset:17408
    ds_read_b64_tr_b16 v[198:199], v9 offset:17536
    ds_read_b64_tr_b16 v[200:201], v9 offset:18432
    ds_read_b64_tr_b16 v[202:203], v9 offset:18560
    ds_read_b64_tr_b16 v[204:205], v9 offset:19456
    ds_read_b64_tr_b16 v[206:207], v9 offset:19584
    s_waitcnt lgkmcnt(4)
    ds_read_b64_tr_b16 v[208:209], v9 offset:20480
    ds_read_b64_tr_b16 v[210:211], v9 offset:20608
    ds_read_b64_tr_b16 v[212:213], v9 offset:21504
    ds_read_b64_tr_b16 v[214:215], v9 offset:21632
    ds_read_b64_tr_b16 v[216:217], v9 offset:22528
    ds_read_b64_tr_b16 v[218:219], v9 offset:22656
    ds_read_b64_tr_b16 v[220:221], v9 offset:23552
    ds_read_b64_tr_b16 v[222:223], v9 offset:23680
    s_waitcnt lgkmcnt(4)
    ds_read_b64_tr_b16 v[224:225], v9 offset:24576
    ds_read_b64_tr_b16 v[226:227], v9 offset:24704
    ds_read_b64_tr_b16 v[228:229], v9 offset:25600
    ds_read_b64_tr_b16 v[230:231], v9 offset:25728
    ds_read_b64_tr_b16 v[232:233], v9 offset:26624
    ds_read_b64_tr_b16 v[234:235], v9 offset:26752
    ds_read_b64_tr_b16 v[236:237], v9 offset:27648
    ds_read_b64_tr_b16 v[238:239], v9 offset:27776
    s_waitcnt lgkmcnt(4)
    ds_read_b64_tr_b16 v[240:241], v9 offset:28672
    ds_read_b64_tr_b16 v[242:243], v9 offset:28800
    ds_read_b64_tr_b16 v[244:245], v9 offset:29696
    ds_read_b64_tr_b16 v[246:247], v9 offset:29824
    ds_read_b64_tr_b16 v[248:249], v9 offset:30720
    ds_read_b64_tr_b16 v[250:251], v9 offset:30848
    ds_read_b64_tr_b16 v[252:253], v9 offset:31744
    ds_read_b64_tr_b16 v[254:255], v9 offset:31872
    s_waitcnt lgkmcnt(4)
Lfc_13:
    s_mul_i32 s36, s15, 28
    s_lshl_b32 s20, s14, 2
    s_add_u32 s36, s36, s20
    s_mul_i32 s36, s36, 14336
    s_add_u32 s36, s36, s33
    s_lshl_b32 s20, s12, 10
    s_add_u32 s36, s36, s20
    s_waitcnt vmcnt(27)
    ds_read_b128 a[0:3], v14 offset:0
    ds_read_b128 a[4:7], v15 offset:0
    ds_read_b128 a[8:11], v14 offset:4096
    ds_read_b128 a[12:15], v15 offset:4096
    ds_read_b128 a[16:19], v14 offset:8192
    ds_read_b128 a[20:23], v15 offset:8192
    ds_read_b128 a[24:27], v14 offset:12288
    ds_read_b128 a[28:31], v15 offset:12288
    ds_read_b128 a[32:35], v14 offset:512
    ds_read_b128 a[36:39], v15 offset:512
    ds_read_b128 a[40:43], v14 offset:4608
    ds_read_b128 a[44:47], v15 offset:4608
    ds_read_b128 a[48:51], v14 offset:8704
    ds_read_b128 a[52:55], v15 offset:8704
    ds_read_b128 a[56:59], v14 offset:12800
    ds_read_b128 a[60:63], v15 offset:12800
    s_waitcnt lgkmcnt(0)
    v_mfma_f32_16x16x32_bf16 v[64:67], a[0:3], v[128:131], 0
    s_add_u32 s34, s12, 8
    v_mfma_f32_16x16x32_bf16 v[68:71], a[0:3], v[160:163], 0
    s_lshl_b32 s34, s34, 18
    v_mfma_f32_16x16x32_bf16 v[72:75], a[0:3], v[192:195], 0
    s_add_u32 s34, s34, s17
    v_mfma_f32_16x16x32_bf16 v[76:79], a[0:3], v[224:227], 0
    s_add_u32 m0, s38, 0
    v_mfma_f32_16x16x32_bf16 v[80:83], a[32:35], v[128:131], 0
    buffer_load_dwordx4 v10, s[24:27], s34 offen offset:0  lds
    v_mfma_f32_16x16x32_bf16 v[84:87], a[32:35], v[160:163], 0
    v_mfma_f32_16x16x32_bf16 v[88:91], a[32:35], v[192:195], 0
    s_add_u32 m0, s38, 1024
    v_mfma_f32_16x16x32_bf16 v[92:95], a[32:35], v[224:227], 0
    buffer_load_dwordx4 v11, s[24:27], s34 offen offset:0  lds
    v_mfma_f32_16x16x32_bf16 v[64:67], a[4:7], v[132:135], v[64:67]
    v_mfma_f32_16x16x32_bf16 v[68:71], a[4:7], v[164:167], v[68:71]
    s_add_u32 m0, s38, 2048
    v_mfma_f32_16x16x32_bf16 v[72:75], a[4:7], v[196:199], v[72:75]
    buffer_load_dwordx4 v12, s[24:27], s34 offen offset:0  lds
    v_mfma_f32_16x16x32_bf16 v[76:79], a[4:7], v[228:231], v[76:79]
    v_mfma_f32_16x16x32_bf16 v[80:83], a[36:39], v[132:135], v[80:83]
    s_add_u32 m0, s38, 3072
    v_mfma_f32_16x16x32_bf16 v[84:87], a[36:39], v[164:167], v[84:87]
    buffer_load_dwordx4 v13, s[24:27], s34 offen offset:0  lds
    v_mfma_f32_16x16x32_bf16 v[88:91], a[36:39], v[196:199], v[88:91]
    v_mfma_f32_16x16x32_bf16 v[92:95], a[36:39], v[228:231], v[92:95]
    s_add_u32 m0, s38, 3968
    v_mfma_f32_16x16x32_bf16 v[64:67], a[8:11], v[136:139], v[64:67]
    buffer_load_dwordx4 v10, s[24:27], s34 offen offset:128  lds
    v_mfma_f32_16x16x32_bf16 v[68:71], a[8:11], v[168:171], v[68:71]
    v_mfma_f32_16x16x32_bf16 v[72:75], a[8:11], v[200:203], v[72:75]
    s_add_u32 m0, s38, 4992
    v_mfma_f32_16x16x32_bf16 v[76:79], a[8:11], v[232:235], v[76:79]
    buffer_load_dwordx4 v11, s[24:27], s34 offen offset:128  lds
    v_mfma_f32_16x16x32_bf16 v[80:83], a[40:43], v[136:139], v[80:83]
    v_mfma_f32_16x16x32_bf16 v[84:87], a[40:43], v[168:171], v[84:87]
    s_add_u32 m0, s38, 6016
    v_mfma_f32_16x16x32_bf16 v[88:91], a[40:43], v[200:203], v[88:91]
    buffer_load_dwordx4 v12, s[24:27], s34 offen offset:128  lds
    v_mfma_f32_16x16x32_bf16 v[92:95], a[40:43], v[232:235], v[92:95]
    v_mfma_f32_16x16x32_bf16 v[64:67], a[12:15], v[140:143], v[64:67]
    s_add_u32 m0, s38, 7040
    v_mfma_f32_16x16x32_bf16 v[68:71], a[12:15], v[172:175], v[68:71]
    buffer_load_dwordx4 v13, s[24:27], s34 offen offset:128  lds
    v_mfma_f32_16x16x32_bf16 v[72:75], a[12:15], v[204:207], v[72:75]
    v_mfma_f32_16x16x32_bf16 v[76:79], a[12:15], v[236:239], v[76:79]
    s_add_u32 m0, s38, 7936
    v_mfma_f32_16x16x32_bf16 v[80:83], a[44:47], v[140:143], v[80:83]
    buffer_load_dwordx4 v10, s[24:27], s34 offen offset:256  lds
    v_mfma_f32_16x16x32_bf16 v[84:87], a[44:47], v[172:175], v[84:87]
    v_mfma_f32_16x16x32_bf16 v[88:91], a[44:47], v[204:207], v[88:91]
    s_add_u32 m0, s38, 8960
    v_mfma_f32_16x16x32_bf16 v[92:95], a[44:47], v[236:239], v[92:95]
    buffer_load_dwordx4 v11, s[24:27], s34 offen offset:256  lds
    v_mfma_f32_16x16x32_bf16 v[64:67], a[16:19], v[144:147], v[64:67]
    v_mfma_f32_16x16x32_bf16 v[68:71], a[16:19], v[176:179], v[68:71]
    s_add_u32 m0, s38, 9984
    v_mfma_f32_16x16x32_bf16 v[72:75], a[16:19], v[208:211], v[72:75]
    buffer_load_dwordx4 v12, s[24:27], s34 offen offset:256  lds
    v_mfma_f32_16x16x32_bf16 v[76:79], a[16:19], v[240:243], v[76:79]
    v_mfma_f32_16x16x32_bf16 v[80:83], a[48:51], v[144:147], v[80:83]
    s_add_u32 m0, s38, 11008
    v_mfma_f32_16x16x32_bf16 v[84:87], a[48:51], v[176:179], v[84:87]
    buffer_load_dwordx4 v13, s[24:27], s34 offen offset:256  lds
    v_mfma_f32_16x16x32_bf16 v[88:91], a[48:51], v[208:211], v[88:91]
    v_mfma_f32_16x16x32_bf16 v[92:95], a[48:51], v[240:243], v[92:95]
    s_add_u32 m0, s38, 11904
    v_mfma_f32_16x16x32_bf16 v[64:67], a[20:23], v[148:151], v[64:67]
    buffer_load_dwordx4 v10, s[24:27], s34 offen offset:384  lds
    v_mfma_f32_16x16x32_bf16 v[68:71], a[20:23], v[180:183], v[68:71]
    v_mfma_f32_16x16x32_bf16 v[72:75], a[20:23], v[212:215], v[72:75]
    s_add_u32 m0, s38, 12928
    v_mfma_f32_16x16x32_bf16 v[76:79], a[20:23], v[244:247], v[76:79]
    buffer_load_dwordx4 v11, s[24:27], s34 offen offset:384  lds
    v_mfma_f32_16x16x32_bf16 v[80:83], a[52:55], v[148:151], v[80:83]
    v_mfma_f32_16x16x32_bf16 v[84:87], a[52:55], v[180:183], v[84:87]
    s_add_u32 m0, s38, 13952
    v_mfma_f32_16x16x32_bf16 v[88:91], a[52:55], v[212:215], v[88:91]
    buffer_load_dwordx4 v12, s[24:27], s34 offen offset:384  lds
    v_mfma_f32_16x16x32_bf16 v[92:95], a[52:55], v[244:247], v[92:95]
    v_mfma_f32_16x16x32_bf16 v[64:67], a[24:27], v[152:155], v[64:67]
    s_add_u32 m0, s38, 14976
    v_mfma_f32_16x16x32_bf16 v[68:71], a[24:27], v[184:187], v[68:71]
    buffer_load_dwordx4 v13, s[24:27], s34 offen offset:384  lds
    v_mfma_f32_16x16x32_bf16 v[72:75], a[24:27], v[216:219], v[72:75]
    v_mfma_f32_16x16x32_bf16 v[76:79], a[24:27], v[248:251], v[76:79]
    v_mfma_f32_16x16x32_bf16 v[80:83], a[56:59], v[152:155], v[80:83]
    v_mfma_f32_16x16x32_bf16 v[84:87], a[56:59], v[184:187], v[84:87]
    v_mfma_f32_16x16x32_bf16 v[88:91], a[56:59], v[216:219], v[88:91]
    v_mfma_f32_16x16x32_bf16 v[92:95], a[56:59], v[248:251], v[92:95]
    v_mfma_f32_16x16x32_bf16 v[64:67], a[28:31], v[156:159], v[64:67]
    v_mfma_f32_16x16x32_bf16 v[68:71], a[28:31], v[188:191], v[68:71]
    v_mfma_f32_16x16x32_bf16 v[72:75], a[28:31], v[220:223], v[72:75]
    v_mfma_f32_16x16x32_bf16 v[76:79], a[28:31], v[252:255], v[76:79]
    v_mfma_f32_16x16x32_bf16 v[80:83], a[60:63], v[156:159], v[80:83]
    buffer_load_dwordx2 v[42:43], v44, s[80:83], 0 offen offset:128 sc1
    v_mfma_f32_16x16x32_bf16 v[84:87], a[60:63], v[188:191], v[84:87]
    v_mfma_f32_16x16x32_bf16 v[88:91], a[60:63], v[220:223], v[88:91]
    v_mfma_f32_16x16x32_bf16 v[92:95], a[60:63], v[252:255], v[92:95]
    s_waitcnt vmcnt(28)
    ds_read_b128 a[64:67], v14 offset:16384
    ds_read_b128 a[68:71], v15 offset:16384
    ds_read_b128 a[72:75], v14 offset:20480
    ds_read_b128 a[76:79], v15 offset:20480
    ds_read_b128 a[80:83], v14 offset:24576
    ds_read_b128 a[84:87], v15 offset:24576
    ds_read_b128 a[88:91], v14 offset:28672
    ds_read_b128 a[92:95], v15 offset:28672
    ds_read_b128 a[96:99], v14 offset:16896
    ds_read_b128 a[100:103], v15 offset:16896
    ds_read_b128 a[104:107], v14 offset:20992
    ds_read_b128 a[108:111], v15 offset:20992
    ds_read_b128 a[112:115], v14 offset:25088
    ds_read_b128 a[116:119], v15 offset:25088
    ds_read_b128 a[120:123], v14 offset:29184
    ds_read_b128 a[124:127], v15 offset:29184
    s_waitcnt lgkmcnt(0)
    v_mfma_f32_16x16x32_bf16 v[96:99], a[64:67], v[128:131], 0
    s_add_u32 s34, s12, 12
    v_mfma_f32_16x16x32_bf16 v[100:103], a[64:67], v[160:163], 0
    s_lshl_b32 s34, s34, 18
    v_mfma_f32_16x16x32_bf16 v[104:107], a[64:67], v[192:195], 0
    s_add_u32 s34, s34, s17
    v_mfma_f32_16x16x32_bf16 v[108:111], a[64:67], v[224:227], 0
    s_add_u32 m0, s38, 16384
    v_mfma_f32_16x16x32_bf16 v[112:115], a[96:99], v[128:131], 0
    buffer_load_dwordx4 v10, s[24:27], s34 offen offset:0  lds
    v_mfma_f32_16x16x32_bf16 v[116:119], a[96:99], v[160:163], 0
    v_mfma_f32_16x16x32_bf16 v[120:123], a[96:99], v[192:195], 0
    s_add_u32 m0, s38, 17408
    v_mfma_f32_16x16x32_bf16 v[124:127], a[96:99], v[224:227], 0
    buffer_load_dwordx4 v11, s[24:27], s34 offen offset:0  lds
    v_mfma_f32_16x16x32_bf16 v[96:99], a[68:71], v[132:135], v[96:99]
    v_mul_f32 v64, s32, v64
    v_mfma_f32_16x16x32_bf16 v[100:103], a[68:71], v[164:167], v[100:103]
    s_add_u32 m0, s38, 18432
    v_mul_f32 v65, s32, v65
    v_mfma_f32_16x16x32_bf16 v[104:107], a[68:71], v[196:199], v[104:107]
    buffer_load_dwordx4 v12, s[24:27], s34 offen offset:0  lds
    v_mul_f32 v66, s32, v66
    v_mfma_f32_16x16x32_bf16 v[108:111], a[68:71], v[228:231], v[108:111]
    v_mul_f32 v67, s32, v67
    v_mfma_f32_16x16x32_bf16 v[112:115], a[100:103], v[132:135], v[112:115]
    s_add_u32 m0, s38, 19456
    v_cvt_pk_bf16_f32 v24, v64, v65
    v_mfma_f32_16x16x32_bf16 v[116:119], a[100:103], v[164:167], v[116:119]
    buffer_load_dwordx4 v13, s[24:27], s34 offen offset:0  lds
    v_cvt_pk_bf16_f32 v25, v66, v67
    v_mfma_f32_16x16x32_bf16 v[120:123], a[100:103], v[196:199], v[120:123]
    v_mul_f32 v80, s32, v80
    v_mfma_f32_16x16x32_bf16 v[124:127], a[100:103], v[228:231], v[124:127]
    s_add_u32 m0, s38, 20352
    v_mul_f32 v81, s32, v81
    v_mfma_f32_16x16x32_bf16 v[96:99], a[72:75], v[136:139], v[96:99]
    buffer_load_dwordx4 v10, s[24:27], s34 offen offset:128  lds
    v_mul_f32 v82, s32, v82
    v_mfma_f32_16x16x32_bf16 v[100:103], a[72:75], v[168:171], v[100:103]
    v_mul_f32 v83, s32, v83
    v_mfma_f32_16x16x32_bf16 v[104:107], a[72:75], v[200:203], v[104:107]
    s_add_u32 m0, s38, 21376
    v_cvt_pk_bf16_f32 v26, v80, v81
    v_mfma_f32_16x16x32_bf16 v[108:111], a[72:75], v[232:235], v[108:111]
    buffer_load_dwordx4 v11, s[24:27], s34 offen offset:128  lds
    v_cvt_pk_bf16_f32 v27, v82, v83
    v_mfma_f32_16x16x32_bf16 v[112:115], a[104:107], v[136:139], v[112:115]
    s_add_u32 s20, s36, 0
    buffer_store_dwordx4 v[24:27], v1, s[8:11], s20 offen sc1
    v_mfma_f32_16x16x32_bf16 v[116:119], a[104:107], v[168:171], v[116:119]
    s_add_u32 m0, s38, 22400
    v_mul_f32 v68, s32, v68
    v_mfma_f32_16x16x32_bf16 v[120:123], a[104:107], v[200:203], v[120:123]
    buffer_load_dwordx4 v12, s[24:27], s34 offen offset:128  lds
    v_mul_f32 v69, s32, v69
    v_mfma_f32_16x16x32_bf16 v[124:127], a[104:107], v[232:235], v[124:127]
    v_mul_f32 v70, s32, v70
    v_mfma_f32_16x16x32_bf16 v[96:99], a[76:79], v[140:143], v[96:99]
    s_add_u32 m0, s38, 23424
    v_mul_f32 v71, s32, v71
    v_mfma_f32_16x16x32_bf16 v[100:103], a[76:79], v[172:175], v[100:103]
    buffer_load_dwordx4 v13, s[24:27], s34 offen offset:128  lds
    v_cvt_pk_bf16_f32 v28, v68, v69
    v_mfma_f32_16x16x32_bf16 v[104:107], a[76:79], v[204:207], v[104:107]
    v_cvt_pk_bf16_f32 v29, v70, v71
    v_mfma_f32_16x16x32_bf16 v[108:111], a[76:79], v[236:239], v[108:111]
    s_add_u32 m0, s38, 24320
    v_mul_f32 v84, s32, v84
    v_mfma_f32_16x16x32_bf16 v[112:115], a[108:111], v[140:143], v[112:115]
    buffer_load_dwordx4 v10, s[24:27], s34 offen offset:256  lds
    v_mul_f32 v85, s32, v85
    v_mfma_f32_16x16x32_bf16 v[116:119], a[108:111], v[172:175], v[116:119]
    v_mul_f32 v86, s32, v86
    v_mfma_f32_16x16x32_bf16 v[120:123], a[108:111], v[204:207], v[120:123]
    s_add_u32 m0, s38, 25344
    v_mul_f32 v87, s32, v87
    v_mfma_f32_16x16x32_bf16 v[124:127], a[108:111], v[236:239], v[124:127]
    buffer_load_dwordx4 v11, s[24:27], s34 offen offset:256  lds
    v_cvt_pk_bf16_f32 v30, v84, v85
    v_mfma_f32_16x16x32_bf16 v[96:99], a[80:83], v[144:147], v[96:99]
    v_cvt_pk_bf16_f32 v31, v86, v87
    v_mfma_f32_16x16x32_bf16 v[100:103], a[80:83], v[176:179], v[100:103]
    s_add_u32 m0, s38, 26368
    s_add_u32 s20, s36, 14336
    buffer_store_dwordx4 v[28:31], v1, s[8:11], s20 offen sc1
    v_mfma_f32_16x16x32_bf16 v[104:107], a[80:83], v[208:211], v[104:107]
    buffer_load_dwordx4 v12, s[24:27], s34 offen offset:256  lds
    v_mul_f32 v72, s32, v72
    v_mfma_f32_16x16x32_bf16 v[108:111], a[80:83], v[240:243], v[108:111]
    v_mul_f32 v73, s32, v73
    v_mfma_f32_16x16x32_bf16 v[112:115], a[112:115], v[144:147], v[112:115]
    s_add_u32 m0, s38, 27392
    v_mul_f32 v74, s32, v74
    v_mfma_f32_16x16x32_bf16 v[116:119], a[112:115], v[176:179], v[116:119]
    buffer_load_dwordx4 v13, s[24:27], s34 offen offset:256  lds
    v_mul_f32 v75, s32, v75
    v_mfma_f32_16x16x32_bf16 v[120:123], a[112:115], v[208:211], v[120:123]
    v_cvt_pk_bf16_f32 v32, v72, v73
    v_mfma_f32_16x16x32_bf16 v[124:127], a[112:115], v[240:243], v[124:127]
    s_add_u32 m0, s38, 28288
    v_cvt_pk_bf16_f32 v33, v74, v75
    v_mfma_f32_16x16x32_bf16 v[96:99], a[84:87], v[148:151], v[96:99]
    buffer_load_dwordx4 v10, s[24:27], s34 offen offset:384  lds
    v_mul_f32 v88, s32, v88
    v_mfma_f32_16x16x32_bf16 v[100:103], a[84:87], v[180:183], v[100:103]
    v_mul_f32 v89, s32, v89
    v_mfma_f32_16x16x32_bf16 v[104:107], a[84:87], v[212:215], v[104:107]
    s_add_u32 m0, s38, 29312
    v_mul_f32 v90, s32, v90
    v_mfma_f32_16x16x32_bf16 v[108:111], a[84:87], v[244:247], v[108:111]
    buffer_load_dwordx4 v11, s[24:27], s34 offen offset:384  lds
    v_mul_f32 v91, s32, v91
    v_mfma_f32_16x16x32_bf16 v[112:115], a[116:119], v[148:151], v[112:115]
    v_cvt_pk_bf16_f32 v34, v88, v89
    v_mfma_f32_16x16x32_bf16 v[116:119], a[116:119], v[180:183], v[116:119]
    s_add_u32 m0, s38, 30336
    v_cvt_pk_bf16_f32 v35, v90, v91
    v_mfma_f32_16x16x32_bf16 v[120:123], a[116:119], v[212:215], v[120:123]
    buffer_load_dwordx4 v12, s[24:27], s34 offen offset:384  lds
    s_add_u32 s20, s36, 28672
    buffer_store_dwordx4 v[32:35], v1, s[8:11], s20 offen sc1
    v_mfma_f32_16x16x32_bf16 v[124:127], a[116:119], v[244:247], v[124:127]
    v_mul_f32 v76, s32, v76
    v_mfma_f32_16x16x32_bf16 v[96:99], a[88:91], v[152:155], v[96:99]
    s_add_u32 m0, s38, 31360
    v_mul_f32 v77, s32, v77
    v_mfma_f32_16x16x32_bf16 v[100:103], a[88:91], v[184:187], v[100:103]
    buffer_load_dwordx4 v13, s[24:27], s34 offen offset:384  lds
    v_mul_f32 v78, s32, v78
    v_mfma_f32_16x16x32_bf16 v[104:107], a[88:91], v[216:219], v[104:107]
    v_mul_f32 v79, s32, v79
    v_mfma_f32_16x16x32_bf16 v[108:111], a[88:91], v[248:251], v[108:111]
    v_cvt_pk_bf16_f32 v36, v76, v77
    v_mfma_f32_16x16x32_bf16 v[112:115], a[120:123], v[152:155], v[112:115]
    v_cvt_pk_bf16_f32 v37, v78, v79
    v_mfma_f32_16x16x32_bf16 v[116:119], a[120:123], v[184:187], v[116:119]
    v_mul_f32 v92, s32, v92
    v_mfma_f32_16x16x32_bf16 v[120:123], a[120:123], v[216:219], v[120:123]
    v_mul_f32 v93, s32, v93
    v_mfma_f32_16x16x32_bf16 v[124:127], a[120:123], v[248:251], v[124:127]
    v_mul_f32 v94, s32, v94
    v_mfma_f32_16x16x32_bf16 v[96:99], a[92:95], v[156:159], v[96:99]
    v_mul_f32 v95, s32, v95
    v_mfma_f32_16x16x32_bf16 v[100:103], a[92:95], v[188:191], v[100:103]
    v_cvt_pk_bf16_f32 v38, v92, v93
    v_mfma_f32_16x16x32_bf16 v[104:107], a[92:95], v[220:223], v[104:107]
    v_cvt_pk_bf16_f32 v39, v94, v95
    v_mfma_f32_16x16x32_bf16 v[108:111], a[92:95], v[252:255], v[108:111]
    s_add_u32 s20, s36, 43008
    buffer_store_dwordx4 v[36:39], v1, s[8:11], s20 offen sc1
    v_mfma_f32_16x16x32_bf16 v[112:115], a[124:127], v[156:159], v[112:115]
    v_mfma_f32_16x16x32_bf16 v[116:119], a[124:127], v[188:191], v[116:119]
    v_mfma_f32_16x16x32_bf16 v[120:123], a[124:127], v[220:223], v[120:123]
    v_mfma_f32_16x16x32_bf16 v[124:127], a[124:127], v[252:255], v[124:127]
    s_waitcnt vmcnt(20)
    ds_read_b128 a[0:3], v14 offset:0
    ds_read_b128 a[4:7], v15 offset:0
    ds_read_b128 a[8:11], v14 offset:4096
    ds_read_b128 a[12:15], v15 offset:4096
    ds_read_b128 a[16:19], v14 offset:8192
    ds_read_b128 a[20:23], v15 offset:8192
    ds_read_b128 a[24:27], v14 offset:12288
    ds_read_b128 a[28:31], v15 offset:12288
    ds_read_b128 a[32:35], v14 offset:512
    ds_read_b128 a[36:39], v15 offset:512
    ds_read_b128 a[40:43], v14 offset:4608
    ds_read_b128 a[44:47], v15 offset:4608
    ds_read_b128 a[48:51], v14 offset:8704
    ds_read_b128 a[52:55], v15 offset:8704
    ds_read_b128 a[56:59], v14 offset:12800
    ds_read_b128 a[60:63], v15 offset:12800
    s_waitcnt lgkmcnt(0)
    s_cmp_lg_u32 s12, 0
    s_cbranch_scc1 Lhk_14
    v_readfirstlane_b32 s88, v42
    v_readfirstlane_b32 s89, v43
    s_cmp_eq_u64 s[88:89], 0
    s_cbranch_scc1 Lhk_14
    s_mov_b64 exec, 1
    s_bfe_u32 s21, s88, 0x30001
    s_sub_u32 s7, s7, s21
    s_and_b32 s7, s7, 7
    s_lshl_b32 s21, s7, 7
    s_add_u32 s21, s21, 125730816
    v_mov_b32 v41, 0
    v_mov_b32 v40, 1
    buffer_atomic_add v40, v41, s[8:11], s21 offen sc0 sc1
    s_mov_b64 exec, -1
    s_mov_b32 s6, 1
Lhk_14:
    v_mfma_f32_16x16x32_bf16 v[64:67], a[0:3], v[128:131], 0
    v_mfma_f32_16x16x32_bf16 v[68:71], a[0:3], v[160:163], 0
    v_mfma_f32_16x16x32_bf16 v[72:75], a[0:3], v[192:195], 0
    v_mfma_f32_16x16x32_bf16 v[76:79], a[0:3], v[224:227], 0
    v_mfma_f32_16x16x32_bf16 v[80:83], a[32:35], v[128:131], 0
    v_mfma_f32_16x16x32_bf16 v[84:87], a[32:35], v[160:163], 0
    v_mfma_f32_16x16x32_bf16 v[88:91], a[32:35], v[192:195], 0
    v_mfma_f32_16x16x32_bf16 v[92:95], a[32:35], v[224:227], 0
    v_mfma_f32_16x16x32_bf16 v[64:67], a[4:7], v[132:135], v[64:67]
    v_mul_f32 v96, s32, v96
    v_mfma_f32_16x16x32_bf16 v[68:71], a[4:7], v[164:167], v[68:71]
    v_mul_f32 v97, s32, v97
    v_mfma_f32_16x16x32_bf16 v[72:75], a[4:7], v[196:199], v[72:75]
    v_mul_f32 v98, s32, v98
    v_mfma_f32_16x16x32_bf16 v[76:79], a[4:7], v[228:231], v[76:79]
    v_mul_f32 v99, s32, v99
    v_mfma_f32_16x16x32_bf16 v[80:83], a[36:39], v[132:135], v[80:83]
    v_cvt_pk_bf16_f32 v24, v96, v97
    v_mfma_f32_16x16x32_bf16 v[84:87], a[36:39], v[164:167], v[84:87]
    v_cvt_pk_bf16_f32 v25, v98, v99
    v_mfma_f32_16x16x32_bf16 v[88:91], a[36:39], v[196:199], v[88:91]
    v_mul_f32 v112, s32, v112
    v_mfma_f32_16x16x32_bf16 v[92:95], a[36:39], v[228:231], v[92:95]
    v_mul_f32 v113, s32, v113
    v_mfma_f32_16x16x32_bf16 v[64:67], a[8:11], v[136:139], v[64:67]
    v_mul_f32 v114, s32, v114
    v_mfma_f32_16x16x32_bf16 v[68:71], a[8:11], v[168:171], v[68:71]
    v_mul_f32 v115, s32, v115
    v_mfma_f32_16x16x32_bf16 v[72:75], a[8:11], v[200:203], v[72:75]
    v_cvt_pk_bf16_f32 v26, v112, v113
    v_mfma_f32_16x16x32_bf16 v[76:79], a[8:11], v[232:235], v[76:79]
    v_cvt_pk_bf16_f32 v27, v114, v115
    v_mfma_f32_16x16x32_bf16 v[80:83], a[40:43], v[136:139], v[80:83]
    s_add_u32 s20, s36, 4096
    buffer_store_dwordx4 v[24:27], v1, s[8:11], s20 offen sc1
    v_mfma_f32_16x16x32_bf16 v[84:87], a[40:43], v[168:171], v[84:87]
    v_mul_f32 v100, s32, v100
    v_mfma_f32_16x16x32_bf16 v[88:91], a[40:43], v[200:203], v[88:91]
    v_mul_f32 v101, s32, v101
    v_mfma_f32_16x16x32_bf16 v[92:95], a[40:43], v[232:235], v[92:95]
    v_mul_f32 v102, s32, v102
    v_mfma_f32_16x16x32_bf16 v[64:67], a[12:15], v[140:143], v[64:67]
    v_mul_f32 v103, s32, v103
    v_mfma_f32_16x16x32_bf16 v[68:71], a[12:15], v[172:175], v[68:71]
    v_cvt_pk_bf16_f32 v28, v100, v101
    v_mfma_f32_16x16x32_bf16 v[72:75], a[12:15], v[204:207], v[72:75]
    v_cvt_pk_bf16_f32 v29, v102, v103
    v_mfma_f32_16x16x32_bf16 v[76:79], a[12:15], v[236:239], v[76:79]
    v_mul_f32 v116, s32, v116
    v_mfma_f32_16x16x32_bf16 v[80:83], a[44:47], v[140:143], v[80:83]
    v_mul_f32 v117, s32, v117
    v_mfma_f32_16x16x32_bf16 v[84:87], a[44:47], v[172:175], v[84:87]
    v_mul_f32 v118, s32, v118
    v_mfma_f32_16x16x32_bf16 v[88:91], a[44:47], v[204:207], v[88:91]
    v_mul_f32 v119, s32, v119
    v_mfma_f32_16x16x32_bf16 v[92:95], a[44:47], v[236:239], v[92:95]
    v_cvt_pk_bf16_f32 v30, v116, v117
    v_mfma_f32_16x16x32_bf16 v[64:67], a[16:19], v[144:147], v[64:67]
    v_cvt_pk_bf16_f32 v31, v118, v119
    v_mfma_f32_16x16x32_bf16 v[68:71], a[16:19], v[176:179], v[68:71]
    s_add_u32 s20, s36, 18432
    buffer_store_dwordx4 v[28:31], v1, s[8:11], s20 offen sc1
    v_mfma_f32_16x16x32_bf16 v[72:75], a[16:19], v[208:211], v[72:75]
    v_mul_f32 v104, s32, v104
    v_mfma_f32_16x16x32_bf16 v[76:79], a[16:19], v[240:243], v[76:79]
    v_mul_f32 v105, s32, v105
    v_mfma_f32_16x16x32_bf16 v[80:83], a[48:51], v[144:147], v[80:83]
    v_mul_f32 v106, s32, v106
    v_mfma_f32_16x16x32_bf16 v[84:87], a[48:51], v[176:179], v[84:87]
    v_mul_f32 v107, s32, v107
    v_mfma_f32_16x16x32_bf16 v[88:91], a[48:51], v[208:211], v[88:91]
    v_cvt_pk_bf16_f32 v32, v104, v105
    v_mfma_f32_16x16x32_bf16 v[92:95], a[48:51], v[240:243], v[92:95]
    v_cvt_pk_bf16_f32 v33, v106, v107
    v_mfma_f32_16x16x32_bf16 v[64:67], a[20:23], v[148:151], v[64:67]
    v_mul_f32 v120, s32, v120
    v_mfma_f32_16x16x32_bf16 v[68:71], a[20:23], v[180:183], v[68:71]
    v_mul_f32 v121, s32, v121
    v_mfma_f32_16x16x32_bf16 v[72:75], a[20:23], v[212:215], v[72:75]
    v_mul_f32 v122, s32, v122
    v_mfma_f32_16x16x32_bf16 v[76:79], a[20:23], v[244:247], v[76:79]
    v_mul_f32 v123, s32, v123
    v_mfma_f32_16x16x32_bf16 v[80:83], a[52:55], v[148:151], v[80:83]
    v_cvt_pk_bf16_f32 v34, v120, v121
    v_mfma_f32_16x16x32_bf16 v[84:87], a[52:55], v[180:183], v[84:87]
    v_cvt_pk_bf16_f32 v35, v122, v123
    v_mfma_f32_16x16x32_bf16 v[88:91], a[52:55], v[212:215], v[88:91]
    s_add_u32 s20, s36, 32768
    buffer_store_dwordx4 v[32:35], v1, s[8:11], s20 offen sc1
    v_mfma_f32_16x16x32_bf16 v[92:95], a[52:55], v[244:247], v[92:95]
    v_mul_f32 v108, s32, v108
    v_mfma_f32_16x16x32_bf16 v[64:67], a[24:27], v[152:155], v[64:67]
    v_mul_f32 v109, s32, v109
    v_mfma_f32_16x16x32_bf16 v[68:71], a[24:27], v[184:187], v[68:71]
    v_mul_f32 v110, s32, v110
    v_mfma_f32_16x16x32_bf16 v[72:75], a[24:27], v[216:219], v[72:75]
    v_mul_f32 v111, s32, v111
    v_mfma_f32_16x16x32_bf16 v[76:79], a[24:27], v[248:251], v[76:79]
    v_cvt_pk_bf16_f32 v36, v108, v109
    v_mfma_f32_16x16x32_bf16 v[80:83], a[56:59], v[152:155], v[80:83]
    v_cvt_pk_bf16_f32 v37, v110, v111
    v_mfma_f32_16x16x32_bf16 v[84:87], a[56:59], v[184:187], v[84:87]
    v_mul_f32 v124, s32, v124
    v_mfma_f32_16x16x32_bf16 v[88:91], a[56:59], v[216:219], v[88:91]
    v_mul_f32 v125, s32, v125
    v_mfma_f32_16x16x32_bf16 v[92:95], a[56:59], v[248:251], v[92:95]
    v_mul_f32 v126, s32, v126
    v_mfma_f32_16x16x32_bf16 v[64:67], a[28:31], v[156:159], v[64:67]
    v_mul_f32 v127, s32, v127
    v_mfma_f32_16x16x32_bf16 v[68:71], a[28:31], v[188:191], v[68:71]
    v_cvt_pk_bf16_f32 v38, v124, v125
    v_mfma_f32_16x16x32_bf16 v[72:75], a[28:31], v[220:223], v[72:75]
    v_cvt_pk_bf16_f32 v39, v126, v127
    v_mfma_f32_16x16x32_bf16 v[76:79], a[28:31], v[252:255], v[76:79]
    s_add_u32 s20, s36, 47104
    buffer_store_dwordx4 v[36:39], v1, s[8:11], s20 offen sc1
    v_mfma_f32_16x16x32_bf16 v[80:83], a[60:63], v[156:159], v[80:83]
    v_mfma_f32_16x16x32_bf16 v[84:87], a[60:63], v[188:191], v[84:87]
    v_mfma_f32_16x16x32_bf16 v[88:91], a[60:63], v[220:223], v[88:91]
    v_mfma_f32_16x16x32_bf16 v[92:95], a[60:63], v[252:255], v[92:95]
    s_waitcnt vmcnt(4)
    ds_read_b128 a[64:67], v14 offset:16384
    ds_read_b128 a[68:71], v15 offset:16384
    ds_read_b128 a[72:75], v14 offset:20480
    ds_read_b128 a[76:79], v15 offset:20480
    ds_read_b128 a[80:83], v14 offset:24576
    ds_read_b128 a[84:87], v15 offset:24576
    ds_read_b128 a[88:91], v14 offset:28672
    ds_read_b128 a[92:95], v15 offset:28672
    ds_read_b128 a[96:99], v14 offset:16896
    ds_read_b128 a[100:103], v15 offset:16896
    ds_read_b128 a[104:107], v14 offset:20992
    ds_read_b128 a[108:111], v15 offset:20992
    ds_read_b128 a[112:115], v14 offset:25088
    ds_read_b128 a[116:119], v15 offset:25088
    ds_read_b128 a[120:123], v14 offset:29184
    ds_read_b128 a[124:127], v15 offset:29184
    s_barrier
    s_cmp_lg_u32 s6, 1
    s_cbranch_scc1 Lhk_15
    s_lshl_b32 s21, s2, 7
    s_add_u32 s21, s21, 125698064
    s_mov_b64 exec, 1
    buffer_store_dwordx2 v[42:43], v44, s[8:11], s21 offen sc1
    s_mov_b64 exec, -1
Lhk_15:
    s_cmp_ge_u32 s12, 2
    s_cbranch_scc1 Lprep_end_8_e2
    s_waitcnt lgkmcnt(0)
    v_mfma_f32_16x16x32_bf16 v[96:99], a[64:67], v[128:131], 0
    v_mfma_f32_16x16x32_bf16 v[100:103], a[64:67], v[160:163], 0
    v_mfma_f32_16x16x32_bf16 v[104:107], a[64:67], v[192:195], 0
    v_mfma_f32_16x16x32_bf16 v[108:111], a[64:67], v[224:227], 0
    v_mfma_f32_16x16x32_bf16 v[112:115], a[96:99], v[128:131], 0
    v_mfma_f32_16x16x32_bf16 v[116:119], a[96:99], v[160:163], 0
    v_mfma_f32_16x16x32_bf16 v[120:123], a[96:99], v[192:195], 0
    v_mfma_f32_16x16x32_bf16 v[124:127], a[96:99], v[224:227], 0
    v_mfma_f32_16x16x32_bf16 v[96:99], a[68:71], v[132:135], v[96:99]
    v_mul_f32 v64, s32, v64
    v_mfma_f32_16x16x32_bf16 v[100:103], a[68:71], v[164:167], v[100:103]
    v_mul_f32 v65, s32, v65
    v_mfma_f32_16x16x32_bf16 v[104:107], a[68:71], v[196:199], v[104:107]
    v_mul_f32 v66, s32, v66
    v_mfma_f32_16x16x32_bf16 v[108:111], a[68:71], v[228:231], v[108:111]
    v_mul_f32 v67, s32, v67
    v_mfma_f32_16x16x32_bf16 v[112:115], a[100:103], v[132:135], v[112:115]
    v_cvt_pk_bf16_f32 v24, v64, v65
    v_mfma_f32_16x16x32_bf16 v[116:119], a[100:103], v[164:167], v[116:119]
    v_cvt_pk_bf16_f32 v25, v66, v67
    v_mfma_f32_16x16x32_bf16 v[120:123], a[100:103], v[196:199], v[120:123]
    v_mul_f32 v80, s32, v80
    v_mfma_f32_16x16x32_bf16 v[124:127], a[100:103], v[228:231], v[124:127]
    v_mul_f32 v81, s32, v81
    v_mfma_f32_16x16x32_bf16 v[96:99], a[72:75], v[136:139], v[96:99]
    v_mul_f32 v82, s32, v82
    v_mfma_f32_16x16x32_bf16 v[100:103], a[72:75], v[168:171], v[100:103]
    v_mul_f32 v83, s32, v83
    v_mfma_f32_16x16x32_bf16 v[104:107], a[72:75], v[200:203], v[104:107]
    v_cvt_pk_bf16_f32 v26, v80, v81
    v_mfma_f32_16x16x32_bf16 v[108:111], a[72:75], v[232:235], v[108:111]
    v_cvt_pk_bf16_f32 v27, v82, v83
    v_mfma_f32_16x16x32_bf16 v[112:115], a[104:107], v[136:139], v[112:115]
    s_add_u32 s20, s36, 8192
    buffer_store_dwordx4 v[24:27], v1, s[8:11], s20 offen sc1
    v_mfma_f32_16x16x32_bf16 v[116:119], a[104:107], v[168:171], v[116:119]
    v_mul_f32 v68, s32, v68
    v_mfma_f32_16x16x32_bf16 v[120:123], a[104:107], v[200:203], v[120:123]
    v_mul_f32 v69, s32, v69
    v_mfma_f32_16x16x32_bf16 v[124:127], a[104:107], v[232:235], v[124:127]
    v_mul_f32 v70, s32, v70
    v_mfma_f32_16x16x32_bf16 v[96:99], a[76:79], v[140:143], v[96:99]
    v_mul_f32 v71, s32, v71
    v_mfma_f32_16x16x32_bf16 v[100:103], a[76:79], v[172:175], v[100:103]
    v_cvt_pk_bf16_f32 v28, v68, v69
    v_mfma_f32_16x16x32_bf16 v[104:107], a[76:79], v[204:207], v[104:107]
    v_cvt_pk_bf16_f32 v29, v70, v71
    v_mfma_f32_16x16x32_bf16 v[108:111], a[76:79], v[236:239], v[108:111]
    v_mul_f32 v84, s32, v84
    v_mfma_f32_16x16x32_bf16 v[112:115], a[108:111], v[140:143], v[112:115]
    v_mul_f32 v85, s32, v85
    v_mfma_f32_16x16x32_bf16 v[116:119], a[108:111], v[172:175], v[116:119]
    v_mul_f32 v86, s32, v86
    v_mfma_f32_16x16x32_bf16 v[120:123], a[108:111], v[204:207], v[120:123]
    v_mul_f32 v87, s32, v87
    v_mfma_f32_16x16x32_bf16 v[124:127], a[108:111], v[236:239], v[124:127]
    v_cvt_pk_bf16_f32 v30, v84, v85
    v_mfma_f32_16x16x32_bf16 v[96:99], a[80:83], v[144:147], v[96:99]
    v_cvt_pk_bf16_f32 v31, v86, v87
    v_mfma_f32_16x16x32_bf16 v[100:103], a[80:83], v[176:179], v[100:103]
    s_add_u32 s20, s36, 22528
    buffer_store_dwordx4 v[28:31], v1, s[8:11], s20 offen sc1
    v_mfma_f32_16x16x32_bf16 v[104:107], a[80:83], v[208:211], v[104:107]
    v_mul_f32 v72, s32, v72
    v_mfma_f32_16x16x32_bf16 v[108:111], a[80:83], v[240:243], v[108:111]
    v_mul_f32 v73, s32, v73
    v_mfma_f32_16x16x32_bf16 v[112:115], a[112:115], v[144:147], v[112:115]
    v_mul_f32 v74, s32, v74
    v_mfma_f32_16x16x32_bf16 v[116:119], a[112:115], v[176:179], v[116:119]
    v_mul_f32 v75, s32, v75
    v_mfma_f32_16x16x32_bf16 v[120:123], a[112:115], v[208:211], v[120:123]
    v_cvt_pk_bf16_f32 v32, v72, v73
    v_mfma_f32_16x16x32_bf16 v[124:127], a[112:115], v[240:243], v[124:127]
    v_cvt_pk_bf16_f32 v33, v74, v75
    v_mfma_f32_16x16x32_bf16 v[96:99], a[84:87], v[148:151], v[96:99]
    v_mul_f32 v88, s32, v88
    v_mfma_f32_16x16x32_bf16 v[100:103], a[84:87], v[180:183], v[100:103]
    v_mul_f32 v89, s32, v89
    v_mfma_f32_16x16x32_bf16 v[104:107], a[84:87], v[212:215], v[104:107]
    v_mul_f32 v90, s32, v90
    v_mfma_f32_16x16x32_bf16 v[108:111], a[84:87], v[244:247], v[108:111]
    v_mul_f32 v91, s32, v91
    v_mfma_f32_16x16x32_bf16 v[112:115], a[116:119], v[148:151], v[112:115]
    v_cvt_pk_bf16_f32 v34, v88, v89
    v_mfma_f32_16x16x32_bf16 v[116:119], a[116:119], v[180:183], v[116:119]
    v_cvt_pk_bf16_f32 v35, v90, v91
    v_mfma_f32_16x16x32_bf16 v[120:123], a[116:119], v[212:215], v[120:123]
    s_add_u32 s20, s36, 36864
    buffer_store_dwordx4 v[32:35], v1, s[8:11], s20 offen sc1
    v_mfma_f32_16x16x32_bf16 v[124:127], a[116:119], v[244:247], v[124:127]
    v_mul_f32 v76, s32, v76
    v_mfma_f32_16x16x32_bf16 v[96:99], a[88:91], v[152:155], v[96:99]
    v_mul_f32 v77, s32, v77
    v_mfma_f32_16x16x32_bf16 v[100:103], a[88:91], v[184:187], v[100:103]
    v_mul_f32 v78, s32, v78
    v_mfma_f32_16x16x32_bf16 v[104:107], a[88:91], v[216:219], v[104:107]
    v_mul_f32 v79, s32, v79
    v_mfma_f32_16x16x32_bf16 v[108:111], a[88:91], v[248:251], v[108:111]
    v_cvt_pk_bf16_f32 v36, v76, v77
    v_mfma_f32_16x16x32_bf16 v[112:115], a[120:123], v[152:155], v[112:115]
    v_cvt_pk_bf16_f32 v37, v78, v79
    v_mfma_f32_16x16x32_bf16 v[116:119], a[120:123], v[184:187], v[116:119]
    v_mul_f32 v92, s32, v92
    v_mfma_f32_16x16x32_bf16 v[120:123], a[120:123], v[216:219], v[120:123]
    v_mul_f32 v93, s32, v93
    v_mfma_f32_16x16x32_bf16 v[124:127], a[120:123], v[248:251], v[124:127]
    v_mul_f32 v94, s32, v94
    v_mfma_f32_16x16x32_bf16 v[96:99], a[92:95], v[156:159], v[96:99]
    v_mul_f32 v95, s32, v95
    v_mfma_f32_16x16x32_bf16 v[100:103], a[92:95], v[188:191], v[100:103]
    v_cvt_pk_bf16_f32 v38, v92, v93
    v_mfma_f32_16x16x32_bf16 v[104:107], a[92:95], v[220:223], v[104:107]
    v_cvt_pk_bf16_f32 v39, v94, v95
    v_mfma_f32_16x16x32_bf16 v[108:111], a[92:95], v[252:255], v[108:111]
    s_add_u32 s20, s36, 51200
    buffer_store_dwordx4 v[36:39], v1, s[8:11], s20 offen sc1
    v_mfma_f32_16x16x32_bf16 v[112:115], a[124:127], v[156:159], v[112:115]
    v_mfma_f32_16x16x32_bf16 v[116:119], a[124:127], v[188:191], v[116:119]
    v_mfma_f32_16x16x32_bf16 v[120:123], a[124:127], v[220:223], v[120:123]
    v_mfma_f32_16x16x32_bf16 v[124:127], a[124:127], v[252:255], v[124:127]
    s_nop 7
    v_mul_f32 v96, s32, v96
    v_mul_f32 v97, s32, v97
    v_mul_f32 v98, s32, v98
    v_mul_f32 v99, s32, v99
    v_cvt_pk_bf16_f32 v24, v96, v97
    v_cvt_pk_bf16_f32 v25, v98, v99
    v_mul_f32 v112, s32, v112
    v_mul_f32 v113, s32, v113
    v_mul_f32 v114, s32, v114
    v_mul_f32 v115, s32, v115
    v_cvt_pk_bf16_f32 v26, v112, v113
    v_cvt_pk_bf16_f32 v27, v114, v115
    s_add_u32 s20, s36, 12288
    buffer_store_dwordx4 v[24:27], v1, s[8:11], s20 offen sc1
    v_mul_f32 v100, s32, v100
    v_mul_f32 v101, s32, v101
    v_mul_f32 v102, s32, v102
    v_mul_f32 v103, s32, v103
    v_cvt_pk_bf16_f32 v28, v100, v101
    v_cvt_pk_bf16_f32 v29, v102, v103
    v_mul_f32 v116, s32, v116
    v_mul_f32 v117, s32, v117
    v_mul_f32 v118, s32, v118
    v_mul_f32 v119, s32, v119
    v_cvt_pk_bf16_f32 v30, v116, v117
    v_cvt_pk_bf16_f32 v31, v118, v119
    s_add_u32 s20, s36, 26624
    buffer_store_dwordx4 v[28:31], v1, s[8:11], s20 offen sc1
    v_mul_f32 v104, s32, v104
    v_mul_f32 v105, s32, v105
    v_mul_f32 v106, s32, v106
    v_mul_f32 v107, s32, v107
    v_cvt_pk_bf16_f32 v32, v104, v105
    v_cvt_pk_bf16_f32 v33, v106, v107
    v_mul_f32 v120, s32, v120
    v_mul_f32 v121, s32, v121
    v_mul_f32 v122, s32, v122
    v_mul_f32 v123, s32, v123
    v_cvt_pk_bf16_f32 v34, v120, v121
    v_cvt_pk_bf16_f32 v35, v122, v123
    s_add_u32 s20, s36, 40960
    buffer_store_dwordx4 v[32:35], v1, s[8:11], s20 offen sc1
    v_mul_f32 v108, s32, v108
    v_mul_f32 v109, s32, v109
    v_mul_f32 v110, s32, v110
    v_mul_f32 v111, s32, v111
    v_cvt_pk_bf16_f32 v36, v108, v109
    v_cvt_pk_bf16_f32 v37, v110, v111
    v_mul_f32 v124, s32, v124
    v_mul_f32 v125, s32, v125
    v_mul_f32 v126, s32, v126
    v_mul_f32 v127, s32, v127
    v_cvt_pk_bf16_f32 v38, v124, v125
    v_cvt_pk_bf16_f32 v39, v126, v127
    s_add_u32 s20, s36, 55296
    buffer_store_dwordx4 v[36:39], v1, s[8:11], s20 offen sc1
    s_branch Lprep_end_8_f
Lprep_end_8_e2:
    s_nop 7
    v_mul_f32 v64, s32, v64
    v_mul_f32 v65, s32, v65
    v_mul_f32 v66, s32, v66
    v_mul_f32 v67, s32, v67
    v_cvt_pk_bf16_f32 v24, v64, v65
    v_cvt_pk_bf16_f32 v25, v66, v67
    v_mul_f32 v80, s32, v80
    v_mul_f32 v81, s32, v81
    v_mul_f32 v82, s32, v82
    v_mul_f32 v83, s32, v83
    v_cvt_pk_bf16_f32 v26, v80, v81
    v_cvt_pk_bf16_f32 v27, v82, v83
    s_add_u32 s20, s36, 8192
    buffer_store_dwordx4 v[24:27], v1, s[8:11], s20 offen sc1
    v_mul_f32 v68, s32, v68
    v_mul_f32 v69, s32, v69
    v_mul_f32 v70, s32, v70
    v_mul_f32 v71, s32, v71
    v_cvt_pk_bf16_f32 v28, v68, v69
    v_cvt_pk_bf16_f32 v29, v70, v71
    v_mul_f32 v84, s32, v84
    v_mul_f32 v85, s32, v85
    v_mul_f32 v86, s32, v86
    v_mul_f32 v87, s32, v87
    v_cvt_pk_bf16_f32 v30, v84, v85
    v_cvt_pk_bf16_f32 v31, v86, v87
    s_add_u32 s20, s36, 22528
    buffer_store_dwordx4 v[28:31], v1, s[8:11], s20 offen sc1
    v_mul_f32 v72, s32, v72
    v_mul_f32 v73, s32, v73
    v_mul_f32 v74, s32, v74
    v_mul_f32 v75, s32, v75
    v_cvt_pk_bf16_f32 v32, v72, v73
    v_cvt_pk_bf16_f32 v33, v74, v75
    v_mul_f32 v88, s32, v88
    v_mul_f32 v89, s32, v89
    v_mul_f32 v90, s32, v90
    v_mul_f32 v91, s32, v91
    v_cvt_pk_bf16_f32 v34, v88, v89
    v_cvt_pk_bf16_f32 v35, v90, v91
    s_add_u32 s20, s36, 36864
    buffer_store_dwordx4 v[32:35], v1, s[8:11], s20 offen sc1
    v_mul_f32 v76, s32, v76
    v_mul_f32 v77, s32, v77
    v_mul_f32 v78, s32, v78
    v_mul_f32 v79, s32, v79
    v_cvt_pk_bf16_f32 v36, v76, v77
    v_cvt_pk_bf16_f32 v37, v78, v79
    v_mul_f32 v92, s32, v92
    v_mul_f32 v93, s32, v93
    v_mul_f32 v94, s32, v94
    v_mul_f32 v95, s32, v95
    v_cvt_pk_bf16_f32 v38, v92, v93
    v_cvt_pk_bf16_f32 v39, v94, v95
    s_add_u32 s20, s36, 51200
    buffer_store_dwordx4 v[36:39], v1, s[8:11], s20 offen sc1
Lprep_end_8_f:
Lprep_end_8_d:
    s_branch Lprep_end_8
Lln_9:
    s_sub_u32 s13, s2, 224
    s_lshl_b32 s14, s13, 2
    s_add_u32 s14, s14, s12
    s_mov_b32 s24, s40
    s_mov_b32 s25, s41
    s_mov_b32 s26, 1835008
    s_mov_b32 s27, 0x20000
    v_and_b32 v3, 15, v7
    v_lshrrev_b32 v4, 4, v7
    v_mul_u32_u24 v5, 896, v3
    v_lshl_add_u32 v5, v4, 4, v5
    s_mul_i32 s16, s14, 14336
    buffer_load_dwordx4 v[24:27], v5, s[24:27], s16 offen offset:0
    buffer_load_dwordx4 v[28:31], v5, s[24:27], s16 offen offset:64
    buffer_load_dwordx4 v[32:35], v5, s[24:27], s16 offen offset:128
    buffer_load_dwordx4 v[36:39], v5, s[24:27], s16 offen offset:192
    buffer_load_dwordx4 v[40:43], v5, s[24:27], s16 offen offset:256
    buffer_load_dwordx4 v[44:47], v5, s[24:27], s16 offen offset:320
    buffer_load_dwordx4 v[48:51], v5, s[24:27], s16 offen offset:384
    buffer_load_dwordx4 v[52:55], v5, s[24:27], s16 offen offset:448
    buffer_load_dwordx4 v[56:59], v5, s[24:27], s16 offen offset:512
    buffer_load_dwordx4 v[60:63], v5, s[24:27], s16 offen offset:576
    buffer_load_dwordx4 v[64:67], v5, s[24:27], s16 offen offset:640
    buffer_load_dwordx4 v[68:71], v5, s[24:27], s16 offen offset:704
    buffer_load_dwordx4 v[72:75], v5, s[24:27], s16 offen offset:768
    buffer_load_dwordx4 v[76:79], v5, s[24:27], s16 offen offset:832
    s_lshl_b32 s20, s2, 13
    s_add_u32 s20, s20, 119013376
    s_cmp_eq_u32 s2, 0
    s_cselect_b32 s20, 1879048192, s20
    s_cmp_eq_u32 s2, 4
    s_cselect_b32 s20, 1879048192, s20
    s_cmp_eq_u32 s2, 24
    s_cselect_b32 s20, 1879048192, s20
    s_cmp_eq_u32 s2, 88
    s_cselect_b32 s20, 1879048192, s20
    s_add_u32 s21, s20, 4096
    buffer_store_dwordx4 v[16:19], v2, s[8:11], s20 offen sc1
    buffer_store_dwordx4 v[16:19], v2, s[8:11], s21 offen sc1
    s_lshl_b32 s20, s2, 13
    s_add_u32 s20, s20, 121110528
    s_cmp_ge_u32 s2, 88
    s_cselect_b32 s20, 1879048192, s20
    s_add_u32 s21, s20, 4096
    buffer_store_dwordx4 v[16:19], v2, s[8:11], s20 offen sc1
    buffer_store_dwordx4 v[16:19], v2, s[8:11], s21 offen sc1
    s_mul_i32 s20, s2, 20480
    s_add_u32 s20, s20, 113770496
    buffer_store_dwordx4 v[16:19], v2, s[8:11], s20 offen sc1
    s_add_u32 s20, s20, 4096
    buffer_store_dwordx4 v[16:19], v2, s[8:11], s20 offen sc1
    s_add_u32 s20, s20, 4096
    buffer_store_dwordx4 v[16:19], v2, s[8:11], s20 offen sc1
    s_add_u32 s20, s20, 4096
    buffer_store_dwordx4 v[16:19], v2, s[8:11], s20 offen sc1
    s_add_u32 s20, s20, 4096
    buffer_store_dwordx4 v[16:19], v2, s[8:11], s20 offen sc1
    s_add_u32 s20, s20, 4096
    s_lshl_b32 s20, s2, 12
    s_add_u32 s20, s20, 121831424
    buffer_store_dwordx4 v[20:23], v2, s[8:11], s20 offen sc1
    s_lshl_b32 s20, s2, 12
    s_add_u32 s20, s20, 122880000
    s_cmp_ge_u32 s2, 129
    s_cselect_b32 s20, 1879048192, s20
    buffer_store_dwordx4 v[20:23], v2, s[8:11], s20 offen sc1
    s_cmp_ge_u32 s13, 2
    s_cbranch_scc1 Lm0_16
    s_mov_b32 s28, s42
    s_mov_b32 s29, s43
    s_mov_b32 s30, 7168
    s_mov_b32 s31, 0x20000
    s_lshl_b32 s21, s13, 15
    s_add_u32 s21, s21, 119013376
    s_lshl_b32 s22, s13, 19
    s_add_u32 s22, s22, 119209984
    v_add_u32 v8, 0, v0
    v_min_u32 v8, 447, v8
    v_and_b32 v9, 7, v8
    v_mul_u32_u24 v10, 896, v9
    v_lshrrev_b32 v11, 3, v8
    v_lshl_add_u32 v10, v11, 4, v10
    buffer_load_dwordx4 v[12:15], v10, s[28:31], 0 offen
    v_lshlrev_b32 v10, 4, v8
    v_lshrrev_b32 v11, 4, v8
    v_lshlrev_b32 v11, 8, v11
    v_lshl_add_u32 v11, v9, 4, v11
    v_bfe_u32 v9, v8, 3, 1
    v_lshl_add_u32 v11, v9, 3, v11
    s_waitcnt vmcnt(0)
    v_min_u32 v12, 0xfffffffe, v12
    v_min_u32 v13, 0xfffffffe, v13
    v_min_u32 v14, 0xfffffffe, v14
    v_min_u32 v15, 0xfffffffe, v15
    buffer_store_dwordx4 v[12:15], v10, s[8:11], s22 offen sc1
    buffer_store_dword v12, v11, s[8:11], s21 offen sc1
    buffer_store_dword v13, v11, s[8:11], s21 offen offset:128 sc1
    buffer_store_dword v14, v11, s[8:11], s21 offen offset:4 sc1
    buffer_store_dword v15, v11, s[8:11], s21 offen offset:132 sc1
    s_nop 1
    v_add_u32 v8, 256, v0
    v_min_u32 v8, 447, v8
    v_and_b32 v9, 7, v8
    v_mul_u32_u24 v10, 896, v9
    v_lshrrev_b32 v11, 3, v8
    v_lshl_add_u32 v10, v11, 4, v10
    buffer_load_dwordx4 v[12:15], v10, s[28:31], 0 offen
    v_lshlrev_b32 v10, 4, v8
    v_lshrrev_b32 v11, 4, v8
    v_lshlrev_b32 v11, 8, v11
    v_lshl_add_u32 v11, v9, 4, v11
    v_bfe_u32 v9, v8, 3, 1
    v_lshl_add_u32 v11, v9, 3, v11
    s_waitcnt vmcnt(0)
    v_min_u32 v12, 0xfffffffe, v12
    v_min_u32 v13, 0xfffffffe, v13
    v_min_u32 v14, 0xfffffffe, v14
    v_min_u32 v15, 0xfffffffe, v15
    buffer_store_dwordx4 v[12:15], v10, s[8:11], s22 offen sc1
    buffer_store_dword v12, v11, s[8:11], s21 offen sc1
    buffer_store_dword v13, v11, s[8:11], s21 offen offset:128 sc1
    buffer_store_dword v14, v11, s[8:11], s21 offen offset:4 sc1
    buffer_store_dword v15, v11, s[8:11], s21 offen offset:132 sc1
    s_nop 1
Lm0_16:
    s_waitcnt vmcnt(0)
    v_mov_b32 v210, 0
    buffer_load_dwordx2 v[208:209], v210, s[80:83], 0 offen offset:128 sc1
    v_lshlrev_b32 v96, 16, v24
    v_and_b32 v97, 0xffff0000, v24
    v_lshlrev_b32 v98, 16, v25
    v_and_b32 v99, 0xffff0000, v25
    v_lshlrev_b32 v100, 16, v26
    v_and_b32 v101, 0xffff0000, v26
    v_lshlrev_b32 v102, 16, v27
    v_and_b32 v103, 0xffff0000, v27
    v_lshlrev_b32 v104, 16, v28
    v_and_b32 v105, 0xffff0000, v28
    v_lshlrev_b32 v106, 16, v29
    v_and_b32 v107, 0xffff0000, v29
    v_lshlrev_b32 v108, 16, v30
    v_and_b32 v109, 0xffff0000, v30
    v_lshlrev_b32 v110, 16, v31
    v_and_b32 v111, 0xffff0000, v31
    v_lshlrev_b32 v112, 16, v32
    v_and_b32 v113, 0xffff0000, v32
    v_lshlrev_b32 v114, 16, v33
    v_and_b32 v115, 0xffff0000, v33
    v_lshlrev_b32 v116, 16, v34
    v_and_b32 v117, 0xffff0000, v34
    v_lshlrev_b32 v118, 16, v35
    v_and_b32 v119, 0xffff0000, v35
    v_lshlrev_b32 v120, 16, v36
    v_and_b32 v121, 0xffff0000, v36
    v_lshlrev_b32 v122, 16, v37
    v_and_b32 v123, 0xffff0000, v37
    v_lshlrev_b32 v124, 16, v38
    v_and_b32 v125, 0xffff0000, v38
    v_lshlrev_b32 v126, 16, v39
    v_and_b32 v127, 0xffff0000, v39
    v_lshlrev_b32 v128, 16, v40
    v_and_b32 v129, 0xffff0000, v40
    v_lshlrev_b32 v130, 16, v41
    v_and_b32 v131, 0xffff0000, v41
    v_lshlrev_b32 v132, 16, v42
    v_and_b32 v133, 0xffff0000, v42
    v_lshlrev_b32 v134, 16, v43
    v_and_b32 v135, 0xffff0000, v43
    v_lshlrev_b32 v136, 16, v44
    v_and_b32 v137, 0xffff0000, v44
    v_lshlrev_b32 v138, 16, v45
    v_and_b32 v139, 0xffff0000, v45
    v_lshlrev_b32 v140, 16, v46
    v_and_b32 v141, 0xffff0000, v46
    v_lshlrev_b32 v142, 16, v47
    v_and_b32 v143, 0xffff0000, v47
    v_lshlrev_b32 v144, 16, v48
    v_and_b32 v145, 0xffff0000, v48
    v_lshlrev_b32 v146, 16, v49
    v_and_b32 v147, 0xffff0000, v49
    v_lshlrev_b32 v148, 16, v50
    v_and_b32 v149, 0xffff0000, v50
    v_lshlrev_b32 v150, 16, v51
    v_and_b32 v151, 0xffff0000, v51
    v_lshlrev_b32 v152, 16, v52
    v_and_b32 v153, 0xffff0000, v52
    v_lshlrev_b32 v154, 16, v53
    v_and_b32 v155, 0xffff0000, v53
    v_lshlrev_b32 v156, 16, v54
    v_and_b32 v157, 0xffff0000, v54
    v_lshlrev_b32 v158, 16, v55
    v_and_b32 v159, 0xffff0000, v55
    v_lshlrev_b32 v160, 16, v56
    v_and_b32 v161, 0xffff0000, v56
    v_lshlrev_b32 v162, 16, v57
    v_and_b32 v163, 0xffff0000, v57
    v_lshlrev_b32 v164, 16, v58
    v_and_b32 v165, 0xffff0000, v58
    v_lshlrev_b32 v166, 16, v59
    v_and_b32 v167, 0xffff0000, v59
    v_lshlrev_b32 v168, 16, v60
    v_and_b32 v169, 0xffff0000, v60
    v_lshlrev_b32 v170, 16, v61
    v_and_b32 v171, 0xffff0000, v61
    v_lshlrev_b32 v172, 16, v62
    v_and_b32 v173, 0xffff0000, v62
    v_lshlrev_b32 v174, 16, v63
    v_and_b32 v175, 0xffff0000, v63
    v_lshlrev_b32 v176, 16, v64
    v_and_b32 v177, 0xffff0000, v64
    v_lshlrev_b32 v178, 16, v65
    v_and_b32 v179, 0xffff0000, v65
    v_lshlrev_b32 v180, 16, v66
    v_and_b32 v181, 0xffff0000, v66
    v_lshlrev_b32 v182, 16, v67
    v_and_b32 v183, 0xffff0000, v67
    v_lshlrev_b32 v184, 16, v68
    v_and_b32 v185, 0xffff0000, v68
    v_lshlrev_b32 v186, 16, v69
    v_and_b32 v187, 0xffff0000, v69
    v_lshlrev_b32 v188, 16, v70
    v_and_b32 v189, 0xffff0000, v70
    v_lshlrev_b32 v190, 16, v71
    v_and_b32 v191, 0xffff0000, v71
    v_lshlrev_b32 v192, 16, v72
    v_and_b32 v193, 0xffff0000, v72
    v_lshlrev_b32 v194, 16, v73
    v_and_b32 v195, 0xffff0000, v73
    v_lshlrev_b32 v196, 16, v74
    v_and_b32 v197, 0xffff0000, v74
    v_lshlrev_b32 v198, 16, v75
    v_and_b32 v199, 0xffff0000, v75
    v_lshlrev_b32 v200, 16, v76
    v_and_b32 v201, 0xffff0000, v76
    v_lshlrev_b32 v202, 16, v77
    v_and_b32 v203, 0xffff0000, v77
    v_lshlrev_b32 v204, 16, v78
    v_and_b32 v205, 0xffff0000, v78
    v_lshlrev_b32 v206, 16, v79
    v_and_b32 v207, 0xffff0000, v79
    v_mov_b32 v8, 0
    v_mov_b32 v9, 0
    v_mov_b32 v10, 0
    v_mov_b32 v11, 0
    v_pk_add_f32 v[8:9], v[8:9], v[96:97]
    v_pk_fma_f32 v[10:11], v[96:97], v[96:97], v[10:11]
    v_pk_add_f32 v[8:9], v[8:9], v[98:99]
    v_pk_fma_f32 v[10:11], v[98:99], v[98:99], v[10:11]
    v_pk_add_f32 v[8:9], v[8:9], v[100:101]
    v_pk_fma_f32 v[10:11], v[100:101], v[100:101], v[10:11]
    v_pk_add_f32 v[8:9], v[8:9], v[102:103]
    v_pk_fma_f32 v[10:11], v[102:103], v[102:103], v[10:11]
    v_pk_add_f32 v[8:9], v[8:9], v[104:105]
    v_pk_fma_f32 v[10:11], v[104:105], v[104:105], v[10:11]
    v_pk_add_f32 v[8:9], v[8:9], v[106:107]
    v_pk_fma_f32 v[10:11], v[106:107], v[106:107], v[10:11]
    v_pk_add_f32 v[8:9], v[8:9], v[108:109]
    v_pk_fma_f32 v[10:11], v[108:109], v[108:109], v[10:11]
    v_pk_add_f32 v[8:9], v[8:9], v[110:111]
    v_pk_fma_f32 v[10:11], v[110:111], v[110:111], v[10:11]
    v_pk_add_f32 v[8:9], v[8:9], v[112:113]
    v_pk_fma_f32 v[10:11], v[112:113], v[112:113], v[10:11]
    v_pk_add_f32 v[8:9], v[8:9], v[114:115]
    v_pk_fma_f32 v[10:11], v[114:115], v[114:115], v[10:11]
    v_pk_add_f32 v[8:9], v[8:9], v[116:117]
    v_pk_fma_f32 v[10:11], v[116:117], v[116:117], v[10:11]
    v_pk_add_f32 v[8:9], v[8:9], v[118:119]
    v_pk_fma_f32 v[10:11], v[118:119], v[118:119], v[10:11]
    v_pk_add_f32 v[8:9], v[8:9], v[120:121]
    v_pk_fma_f32 v[10:11], v[120:121], v[120:121], v[10:11]
    v_pk_add_f32 v[8:9], v[8:9], v[122:123]
    v_pk_fma_f32 v[10:11], v[122:123], v[122:123], v[10:11]
    v_pk_add_f32 v[8:9], v[8:9], v[124:125]
    v_pk_fma_f32 v[10:11], v[124:125], v[124:125], v[10:11]
    v_pk_add_f32 v[8:9], v[8:9], v[126:127]
    v_pk_fma_f32 v[10:11], v[126:127], v[126:127], v[10:11]
    v_pk_add_f32 v[8:9], v[8:9], v[128:129]
    v_pk_fma_f32 v[10:11], v[128:129], v[128:129], v[10:11]
    v_pk_add_f32 v[8:9], v[8:9], v[130:131]
    v_pk_fma_f32 v[10:11], v[130:131], v[130:131], v[10:11]
    v_pk_add_f32 v[8:9], v[8:9], v[132:133]
    v_pk_fma_f32 v[10:11], v[132:133], v[132:133], v[10:11]
    v_pk_add_f32 v[8:9], v[8:9], v[134:135]
    v_pk_fma_f32 v[10:11], v[134:135], v[134:135], v[10:11]
    v_pk_add_f32 v[8:9], v[8:9], v[136:137]
    v_pk_fma_f32 v[10:11], v[136:137], v[136:137], v[10:11]
    v_pk_add_f32 v[8:9], v[8:9], v[138:139]
    v_pk_fma_f32 v[10:11], v[138:139], v[138:139], v[10:11]
    v_pk_add_f32 v[8:9], v[8:9], v[140:141]
    v_pk_fma_f32 v[10:11], v[140:141], v[140:141], v[10:11]
    v_pk_add_f32 v[8:9], v[8:9], v[142:143]
    v_pk_fma_f32 v[10:11], v[142:143], v[142:143], v[10:11]
    v_pk_add_f32 v[8:9], v[8:9], v[144:145]
    v_pk_fma_f32 v[10:11], v[144:145], v[144:145], v[10:11]
    v_pk_add_f32 v[8:9], v[8:9], v[146:147]
    v_pk_fma_f32 v[10:11], v[146:147], v[146:147], v[10:11]
    v_pk_add_f32 v[8:9], v[8:9], v[148:149]
    v_pk_fma_f32 v[10:11], v[148:149], v[148:149], v[10:11]
    v_pk_add_f32 v[8:9], v[8:9], v[150:151]
    v_pk_fma_f32 v[10:11], v[150:151], v[150:151], v[10:11]
    v_pk_add_f32 v[8:9], v[8:9], v[152:153]
    v_pk_fma_f32 v[10:11], v[152:153], v[152:153], v[10:11]
    v_pk_add_f32 v[8:9], v[8:9], v[154:155]
    v_pk_fma_f32 v[10:11], v[154:155], v[154:155], v[10:11]
    v_pk_add_f32 v[8:9], v[8:9], v[156:157]
    v_pk_fma_f32 v[10:11], v[156:157], v[156:157], v[10:11]
    v_pk_add_f32 v[8:9], v[8:9], v[158:159]
    v_pk_fma_f32 v[10:11], v[158:159], v[158:159], v[10:11]
    v_pk_add_f32 v[8:9], v[8:9], v[160:161]
    v_pk_fma_f32 v[10:11], v[160:161], v[160:161], v[10:11]
    v_pk_add_f32 v[8:9], v[8:9], v[162:163]
    v_pk_fma_f32 v[10:11], v[162:163], v[162:163], v[10:11]
    v_pk_add_f32 v[8:9], v[8:9], v[164:165]
    v_pk_fma_f32 v[10:11], v[164:165], v[164:165], v[10:11]
    v_pk_add_f32 v[8:9], v[8:9], v[166:167]
    v_pk_fma_f32 v[10:11], v[166:167], v[166:167], v[10:11]
    v_pk_add_f32 v[8:9], v[8:9], v[168:169]
    v_pk_fma_f32 v[10:11], v[168:169], v[168:169], v[10:11]
    v_pk_add_f32 v[8:9], v[8:9], v[170:171]
    v_pk_fma_f32 v[10:11], v[170:171], v[170:171], v[10:11]
    v_pk_add_f32 v[8:9], v[8:9], v[172:173]
    v_pk_fma_f32 v[10:11], v[172:173], v[172:173], v[10:11]
    v_pk_add_f32 v[8:9], v[8:9], v[174:175]
    v_pk_fma_f32 v[10:11], v[174:175], v[174:175], v[10:11]
    v_pk_add_f32 v[8:9], v[8:9], v[176:177]
    v_pk_fma_f32 v[10:11], v[176:177], v[176:177], v[10:11]
    v_pk_add_f32 v[8:9], v[8:9], v[178:179]
    v_pk_fma_f32 v[10:11], v[178:179], v[178:179], v[10:11]
    v_pk_add_f32 v[8:9], v[8:9], v[180:181]
    v_pk_fma_f32 v[10:11], v[180:181], v[180:181], v[10:11]
    v_pk_add_f32 v[8:9], v[8:9], v[182:183]
    v_pk_fma_f32 v[10:11], v[182:183], v[182:183], v[10:11]
    v_pk_add_f32 v[8:9], v[8:9], v[184:185]
    v_pk_fma_f32 v[10:11], v[184:185], v[184:185], v[10:11]
    v_pk_add_f32 v[8:9], v[8:9], v[186:187]
    v_pk_fma_f32 v[10:11], v[186:187], v[186:187], v[10:11]
    v_pk_add_f32 v[8:9], v[8:9], v[188:189]
    v_pk_fma_f32 v[10:11], v[188:189], v[188:189], v[10:11]
    v_pk_add_f32 v[8:9], v[8:9], v[190:191]
    v_pk_fma_f32 v[10:11], v[190:191], v[190:191], v[10:11]
    v_pk_add_f32 v[8:9], v[8:9], v[192:193]
    v_pk_fma_f32 v[10:11], v[192:193], v[192:193], v[10:11]
    v_pk_add_f32 v[8:9], v[8:9], v[194:195]
    v_pk_fma_f32 v[10:11], v[194:195], v[194:195], v[10:11]
    v_pk_add_f32 v[8:9], v[8:9], v[196:197]
    v_pk_fma_f32 v[10:11], v[196:197], v[196:197], v[10:11]
    v_pk_add_f32 v[8:9], v[8:9], v[198:199]
    v_pk_fma_f32 v[10:11], v[198:199], v[198:199], v[10:11]
    v_pk_add_f32 v[8:9], v[8:9], v[200:201]
    v_pk_fma_f32 v[10:11], v[200:201], v[200:201], v[10:11]
    v_pk_add_f32 v[8:9], v[8:9], v[202:203]
    v_pk_fma_f32 v[10:11], v[202:203], v[202:203], v[10:11]
    v_pk_add_f32 v[8:9], v[8:9], v[204:205]
    v_pk_fma_f32 v[10:11], v[204:205], v[204:205], v[10:11]
    v_pk_add_f32 v[8:9], v[8:9], v[206:207]
    v_pk_fma_f32 v[10:11], v[206:207], v[206:207], v[10:11]
    v_add_f32 v8, v8, v9
    v_add_f32 v9, v10, v11
    v_mov_b32 v10, v8
    v_mov_b32 v11, v9
    s_nop 1
    v_permlane16_swap_b32 v8, v10
    v_permlane16_swap_b32 v9, v11
    v_add_f32 v8, v8, v10
    v_add_f32 v9, v9, v11
    v_mov_b32 v10, v8
    v_mov_b32 v11, v9
    s_nop 1
    v_permlane32_swap_b32 v8, v10
    v_permlane32_swap_b32 v9, v11
    v_add_f32 v8, v8, v10
    v_add_f32 v9, v9, v11
    s_waitcnt vmcnt(0)
    s_cmp_lg_u32 s12, 0
    s_cbranch_scc1 Lhk_17
    v_readfirstlane_b32 s88, v208
    v_readfirstlane_b32 s89, v209
    s_cmp_eq_u64 s[88:89], 0
    s_cbranch_scc1 Lhk_17
    s_mov_b64 exec, 1
    s_bfe_u32 s21, s88, 0x30001
    s_sub_u32 s7, s7, s21
    s_and_b32 s7, s7, 7
    s_lshl_b32 s21, s7, 7
    s_add_u32 s21, s21, 125730816
    v_mov_b32 v213, 0
    v_mov_b32 v212, 1
    buffer_atomic_add v212, v213, s[8:11], s21 offen sc0 sc1
    s_mov_b64 exec, -1
    s_mov_b32 s6, 1
Lhk_17:
    s_mov_b32 s22, 0x3b124925
    s_mov_b32 s23, 0x3727c5ac
    v_mul_f32 v8, s22, v8
    v_mul_f32 v9, s22, v9
    v_fma_f32 v9, -v8, v8, v9
    v_max_f32 v9, 0, v9
    v_add_f32 v9, s23, v9
    v_rsq_f32 v10, v9
    s_add_u32 s20, s16, 12845056
    v_mul_f32 v8, v8, v10
    v_mov_b32 v11, v10
    v_sub_f32 v8, 0, v8
    v_mov_b32 v9, v8
    v_pk_fma_f32 v[96:97], v[96:97], v[10:11], v[8:9]
    v_cvt_pk_bf16_f32 v24, v96, v97
    v_min_u32 v24, 0xfffffffe, v24
    v_pk_fma_f32 v[98:99], v[98:99], v[10:11], v[8:9]
    v_cvt_pk_bf16_f32 v25, v98, v99
    v_min_u32 v25, 0xfffffffe, v25
    v_pk_fma_f32 v[100:101], v[100:101], v[10:11], v[8:9]
    v_cvt_pk_bf16_f32 v26, v100, v101
    v_min_u32 v26, 0xfffffffe, v26
    v_pk_fma_f32 v[102:103], v[102:103], v[10:11], v[8:9]
    v_cvt_pk_bf16_f32 v27, v102, v103
    v_min_u32 v27, 0xfffffffe, v27
    buffer_store_dwordx4 v[24:27], v1, s[8:11], s20 offen offset:0 sc1
    v_pk_fma_f32 v[104:105], v[104:105], v[10:11], v[8:9]
    v_cvt_pk_bf16_f32 v28, v104, v105
    v_min_u32 v28, 0xfffffffe, v28
    v_pk_fma_f32 v[106:107], v[106:107], v[10:11], v[8:9]
    v_cvt_pk_bf16_f32 v29, v106, v107
    v_min_u32 v29, 0xfffffffe, v29
    v_pk_fma_f32 v[108:109], v[108:109], v[10:11], v[8:9]
    v_cvt_pk_bf16_f32 v30, v108, v109
    v_min_u32 v30, 0xfffffffe, v30
    v_pk_fma_f32 v[110:111], v[110:111], v[10:11], v[8:9]
    v_cvt_pk_bf16_f32 v31, v110, v111
    v_min_u32 v31, 0xfffffffe, v31
    buffer_store_dwordx4 v[28:31], v1, s[8:11], s20 offen offset:1024 sc1
    v_pk_fma_f32 v[112:113], v[112:113], v[10:11], v[8:9]
    v_cvt_pk_bf16_f32 v32, v112, v113
    v_min_u32 v32, 0xfffffffe, v32
    v_pk_fma_f32 v[114:115], v[114:115], v[10:11], v[8:9]
    v_cvt_pk_bf16_f32 v33, v114, v115
    v_min_u32 v33, 0xfffffffe, v33
    v_pk_fma_f32 v[116:117], v[116:117], v[10:11], v[8:9]
    v_cvt_pk_bf16_f32 v34, v116, v117
    v_min_u32 v34, 0xfffffffe, v34
    v_pk_fma_f32 v[118:119], v[118:119], v[10:11], v[8:9]
    v_cvt_pk_bf16_f32 v35, v118, v119
    v_min_u32 v35, 0xfffffffe, v35
    buffer_store_dwordx4 v[32:35], v1, s[8:11], s20 offen offset:2048 sc1
    v_pk_fma_f32 v[120:121], v[120:121], v[10:11], v[8:9]
    v_cvt_pk_bf16_f32 v36, v120, v121
    v_min_u32 v36, 0xfffffffe, v36
    v_pk_fma_f32 v[122:123], v[122:123], v[10:11], v[8:9]
    v_cvt_pk_bf16_f32 v37, v122, v123
    v_min_u32 v37, 0xfffffffe, v37
    v_pk_fma_f32 v[124:125], v[124:125], v[10:11], v[8:9]
    v_cvt_pk_bf16_f32 v38, v124, v125
    v_min_u32 v38, 0xfffffffe, v38
    v_pk_fma_f32 v[126:127], v[126:127], v[10:11], v[8:9]
    v_cvt_pk_bf16_f32 v39, v126, v127
    v_min_u32 v39, 0xfffffffe, v39
    buffer_store_dwordx4 v[36:39], v1, s[8:11], s20 offen offset:3072 sc1
    s_add_u32 s20, s20, 4096
    v_pk_fma_f32 v[128:129], v[128:129], v[10:11], v[8:9]
    v_cvt_pk_bf16_f32 v40, v128, v129
    v_min_u32 v40, 0xfffffffe, v40
    v_pk_fma_f32 v[130:131], v[130:131], v[10:11], v[8:9]
    v_cvt_pk_bf16_f32 v41, v130, v131
    v_min_u32 v41, 0xfffffffe, v41
    v_pk_fma_f32 v[132:133], v[132:133], v[10:11], v[8:9]
    v_cvt_pk_bf16_f32 v42, v132, v133
    v_min_u32 v42, 0xfffffffe, v42
    v_pk_fma_f32 v[134:135], v[134:135], v[10:11], v[8:9]
    v_cvt_pk_bf16_f32 v43, v134, v135
    v_min_u32 v43, 0xfffffffe, v43
    buffer_store_dwordx4 v[40:43], v1, s[8:11], s20 offen offset:0 sc1
    v_pk_fma_f32 v[136:137], v[136:137], v[10:11], v[8:9]
    v_cvt_pk_bf16_f32 v44, v136, v137
    v_min_u32 v44, 0xfffffffe, v44
    v_pk_fma_f32 v[138:139], v[138:139], v[10:11], v[8:9]
    v_cvt_pk_bf16_f32 v45, v138, v139
    v_min_u32 v45, 0xfffffffe, v45
    v_pk_fma_f32 v[140:141], v[140:141], v[10:11], v[8:9]
    v_cvt_pk_bf16_f32 v46, v140, v141
    v_min_u32 v46, 0xfffffffe, v46
    v_pk_fma_f32 v[142:143], v[142:143], v[10:11], v[8:9]
    v_cvt_pk_bf16_f32 v47, v142, v143
    v_min_u32 v47, 0xfffffffe, v47
    buffer_store_dwordx4 v[44:47], v1, s[8:11], s20 offen offset:1024 sc1
    v_pk_fma_f32 v[144:145], v[144:145], v[10:11], v[8:9]
    v_cvt_pk_bf16_f32 v48, v144, v145
    v_min_u32 v48, 0xfffffffe, v48
    v_pk_fma_f32 v[146:147], v[146:147], v[10:11], v[8:9]
    v_cvt_pk_bf16_f32 v49, v146, v147
    v_min_u32 v49, 0xfffffffe, v49
    v_pk_fma_f32 v[148:149], v[148:149], v[10:11], v[8:9]
    v_cvt_pk_bf16_f32 v50, v148, v149
    v_min_u32 v50, 0xfffffffe, v50
    v_pk_fma_f32 v[150:151], v[150:151], v[10:11], v[8:9]
    v_cvt_pk_bf16_f32 v51, v150, v151
    v_min_u32 v51, 0xfffffffe, v51
    buffer_store_dwordx4 v[48:51], v1, s[8:11], s20 offen offset:2048 sc1
    v_pk_fma_f32 v[152:153], v[152:153], v[10:11], v[8:9]
    v_cvt_pk_bf16_f32 v52, v152, v153
    v_min_u32 v52, 0xfffffffe, v52
    v_pk_fma_f32 v[154:155], v[154:155], v[10:11], v[8:9]
    v_cvt_pk_bf16_f32 v53, v154, v155
    v_min_u32 v53, 0xfffffffe, v53
    v_pk_fma_f32 v[156:157], v[156:157], v[10:11], v[8:9]
    v_cvt_pk_bf16_f32 v54, v156, v157
    v_min_u32 v54, 0xfffffffe, v54
    v_pk_fma_f32 v[158:159], v[158:159], v[10:11], v[8:9]
    v_cvt_pk_bf16_f32 v55, v158, v159
    v_min_u32 v55, 0xfffffffe, v55
    buffer_store_dwordx4 v[52:55], v1, s[8:11], s20 offen offset:3072 sc1
    s_add_u32 s20, s20, 4096
    v_pk_fma_f32 v[160:161], v[160:161], v[10:11], v[8:9]
    v_cvt_pk_bf16_f32 v56, v160, v161
    v_min_u32 v56, 0xfffffffe, v56
    v_pk_fma_f32 v[162:163], v[162:163], v[10:11], v[8:9]
    v_cvt_pk_bf16_f32 v57, v162, v163
    v_min_u32 v57, 0xfffffffe, v57
    v_pk_fma_f32 v[164:165], v[164:165], v[10:11], v[8:9]
    v_cvt_pk_bf16_f32 v58, v164, v165
    v_min_u32 v58, 0xfffffffe, v58
    v_pk_fma_f32 v[166:167], v[166:167], v[10:11], v[8:9]
    v_cvt_pk_bf16_f32 v59, v166, v167
    v_min_u32 v59, 0xfffffffe, v59
    buffer_store_dwordx4 v[56:59], v1, s[8:11], s20 offen offset:0 sc1
    v_pk_fma_f32 v[168:169], v[168:169], v[10:11], v[8:9]
    v_cvt_pk_bf16_f32 v60, v168, v169
    v_min_u32 v60, 0xfffffffe, v60
    v_pk_fma_f32 v[170:171], v[170:171], v[10:11], v[8:9]
    v_cvt_pk_bf16_f32 v61, v170, v171
    v_min_u32 v61, 0xfffffffe, v61
    v_pk_fma_f32 v[172:173], v[172:173], v[10:11], v[8:9]
    v_cvt_pk_bf16_f32 v62, v172, v173
    v_min_u32 v62, 0xfffffffe, v62
    v_pk_fma_f32 v[174:175], v[174:175], v[10:11], v[8:9]
    v_cvt_pk_bf16_f32 v63, v174, v175
    v_min_u32 v63, 0xfffffffe, v63
    buffer_store_dwordx4 v[60:63], v1, s[8:11], s20 offen offset:1024 sc1
    v_pk_fma_f32 v[176:177], v[176:177], v[10:11], v[8:9]
    v_cvt_pk_bf16_f32 v64, v176, v177
    v_min_u32 v64, 0xfffffffe, v64
    v_pk_fma_f32 v[178:179], v[178:179], v[10:11], v[8:9]
    v_cvt_pk_bf16_f32 v65, v178, v179
    v_min_u32 v65, 0xfffffffe, v65
    v_pk_fma_f32 v[180:181], v[180:181], v[10:11], v[8:9]
    v_cvt_pk_bf16_f32 v66, v180, v181
    v_min_u32 v66, 0xfffffffe, v66
    v_pk_fma_f32 v[182:183], v[182:183], v[10:11], v[8:9]
    v_cvt_pk_bf16_f32 v67, v182, v183
    v_min_u32 v67, 0xfffffffe, v67
    buffer_store_dwordx4 v[64:67], v1, s[8:11], s20 offen offset:2048 sc1
    v_pk_fma_f32 v[184:185], v[184:185], v[10:11], v[8:9]
    v_cvt_pk_bf16_f32 v68, v184, v185
    v_min_u32 v68, 0xfffffffe, v68
    v_pk_fma_f32 v[186:187], v[186:187], v[10:11], v[8:9]
    v_cvt_pk_bf16_f32 v69, v186, v187
    v_min_u32 v69, 0xfffffffe, v69
    v_pk_fma_f32 v[188:189], v[188:189], v[10:11], v[8:9]
    v_cvt_pk_bf16_f32 v70, v188, v189
    v_min_u32 v70, 0xfffffffe, v70
    v_pk_fma_f32 v[190:191], v[190:191], v[10:11], v[8:9]
    v_cvt_pk_bf16_f32 v71, v190, v191
    v_min_u32 v71, 0xfffffffe, v71
    buffer_store_dwordx4 v[68:71], v1, s[8:11], s20 offen offset:3072 sc1
    s_add_u32 s20, s20, 4096
    v_pk_fma_f32 v[192:193], v[192:193], v[10:11], v[8:9]
    v_cvt_pk_bf16_f32 v72, v192, v193
    v_min_u32 v72, 0xfffffffe, v72
    v_pk_fma_f32 v[194:195], v[194:195], v[10:11], v[8:9]
    v_cvt_pk_bf16_f32 v73, v194, v195
    v_min_u32 v73, 0xfffffffe, v73
    v_pk_fma_f32 v[196:197], v[196:197], v[10:11], v[8:9]
    v_cvt_pk_bf16_f32 v74, v196, v197
    v_min_u32 v74, 0xfffffffe, v74
    v_pk_fma_f32 v[198:199], v[198:199], v[10:11], v[8:9]
    v_cvt_pk_bf16_f32 v75, v198, v199
    v_min_u32 v75, 0xfffffffe, v75
    buffer_store_dwordx4 v[72:75], v1, s[8:11], s20 offen offset:0 sc1
    v_pk_fma_f32 v[200:201], v[200:201], v[10:11], v[8:9]
    v_cvt_pk_bf16_f32 v76, v200, v201
    v_min_u32 v76, 0xfffffffe, v76
    v_pk_fma_f32 v[202:203], v[202:203], v[10:11], v[8:9]
    v_cvt_pk_bf16_f32 v77, v202, v203
    v_min_u32 v77, 0xfffffffe, v77
    v_pk_fma_f32 v[204:205], v[204:205], v[10:11], v[8:9]
    v_cvt_pk_bf16_f32 v78, v204, v205
    v_min_u32 v78, 0xfffffffe, v78
    v_pk_fma_f32 v[206:207], v[206:207], v[10:11], v[8:9]
    v_cvt_pk_bf16_f32 v79, v206, v207
    v_min_u32 v79, 0xfffffffe, v79
    buffer_store_dwordx4 v[76:79], v1, s[8:11], s20 offen offset:1024 sc1
    s_waitcnt vmcnt(14)
    v_mov_b32 v40, v212
Lprep_end_8:
    s_mov_b32 s18, 0x80000
    s_mov_b32 s16, 1
    s_waitcnt vmcnt(0)
    s_barrier
    s_cmp_lg_u32 s12, 0
    s_cbranch_scc1 Lra_1
    s_mov_b64 s[78:79], s[88:89]
    s_cmp_eq_u32 s6, 1
    s_cbranch_scc1 Lra_1_r
    v_mov_b32 v1, 0
Lra_1_n:
    buffer_load_dwordx2 v[2:3], v1, s[80:83], 0 offen offset:128 sc1
    s_sub_u32 s18, s18, 1
    s_cbranch_scc1 interleave_layers__memory_aug_recurrent_mem_tr__glu_gated_glu__prompt_kernel_exit
    s_waitcnt vmcnt(0)
    v_readfirstlane_b32 s78, v2
    v_readfirstlane_b32 s79, v3
    s_cmp_eq_u64 s[78:79], 0
    s_cbranch_scc1 Lra_1_n
    s_mov_b64 exec, 1
    s_bfe_u32 s21, s78, 0x30001
    s_sub_u32 s7, s7, s21
    s_and_b32 s7, s7, 7
    s_lshl_b32 s21, s7, 7
    s_add_u32 s21, s21, 125730816
    v_mov_b32 v41, 0
    v_mov_b32 v40, 1
    buffer_atomic_add v40, v41, s[8:11], s21 offen sc0 sc1
    s_mov_b64 exec, -1
    s_mov_b32 s6, 1
Lra_1_r:
    s_mov_b64 exec, 1
    v_mov_b32 v1, 0
    v_mov_b32 v2, s78
    v_mov_b32 v3, s79
    s_lshl_b32 s21, s2, 7
    s_add_u32 s21, s21, 125698048
    buffer_store_dwordx2 v[2:3], v1, s[8:11], s21 offen sc1
    buffer_store_dwordx2 v[2:3], v1, s[8:11], s21 offen offset:16 sc1
    s_waitcnt vmcnt(2)
    v_readfirstlane_b32 s6, v40
    s_lshl_b32 s13, s7, 5
    s_add_u32 s13, s13, s6
    s_cmp_lt_u32 s6, 32
    s_cbranch_scc1 Lnat_2
    v_mov_b32 v2, 1
    s_mov_b32 s21, 125730816
    buffer_atomic_add v2, v1, s[8:11], s21 offen offset:1024 sc0 sc1
    s_waitcnt vmcnt(0)
    v_readfirstlane_b32 s22, v2
    s_mov_b64 exec, 0xff
    v_mbcnt_lo_u32_b32 v1, -1, 0
    v_lshlrev_b32 v1, 7, v1
Lov_3:
    buffer_load_dword v2, v1, s[8:11], s21 offen sc1
    s_sub_u32 s18, s18, 1
    s_cbranch_scc1 interleave_layers__memory_aug_recurrent_mem_tr__glu_gated_glu__prompt_kernel_exit
    s_waitcnt vmcnt(0)
    s_mov_b32 s23, 0
    v_readlane_b32 s24, v2, 0
    s_add_u32 s23, s23, s24
    v_readlane_b32 s24, v2, 1
    s_add_u32 s23, s23, s24
    v_readlane_b32 s24, v2, 2
    s_add_u32 s23, s23, s24
    v_readlane_b32 s24, v2, 3
    s_add_u32 s23, s23, s24
    v_readlane_b32 s24, v2, 4
    s_add_u32 s23, s23, s24
    v_readlane_b32 s24, v2, 5
    s_add_u32 s23, s23, s24
    v_readlane_b32 s24, v2, 6
    s_add_u32 s23, s23, s24
    v_readlane_b32 s24, v2, 7
    s_add_u32 s23, s23, s24
    s_cmp_lt_u32 s23, 256
    s_cbranch_scc1 Lov_3
    s_mov_b32 s23, 0
Lov2_4:
    v_readlane_b32 s24, v2, s23
    s_min_u32 s24, s24, 32
    s_sub_u32 s25, 32, s24
    s_cmp_lt_u32 s22, s25
    s_cbranch_scc1 Lov3_5
    s_sub_u32 s22, s22, s25
    s_add_u32 s23, s23, 1
    s_cmp_lt_u32 s23, 8
    s_cbranch_scc1 Lov2_4
    s_mov_b32 s13, 30
    s_branch Lnat_2
Lov3_5:
    s_lshl_b32 s13, s23, 5
    s_add_u32 s13, s13, s24
    s_add_u32 s13, s13, s22
Lnat_2:
    s_mov_b64 exec, -1
    v_mov_b32 v1, 0
    v_mov_b32 v2, s13
    v_mov_b32 v3, s78
    v_mov_b32 v4, s79
    ds_write_b96 v1, v[2:4]
    s_waitcnt lgkmcnt(0)
Lra_1:
    s_barrier
    v_mov_b32 v1, 0
    ds_read_b96 v[2:4], v1
    s_getpc_b64 s[20:21]
interleave_layers__memory_aug_recurrent_mem_tr__glu_gated_glu__prompt_kernel_pc:
    s_add_u32 s20, s20, interleave_layers__memory_aug_recurrent_mem_tr__glu_gated_glu__prompt_kernel_tab-interleave_layers__memory_aug_recurrent_mem_tr__glu_gated_glu__prompt_kernel_pc
    s_addc_u32 s21, s21, 0
    s_waitcnt lgkmcnt(0)
    v_readfirstlane_b32 s13, v2
    v_readfirstlane_b32 s78, v3
    v_readfirstlane_b32 s79, v4
    s_and_b32 s13, s13, 255
    s_lshl_b32 s22, s13, 2
    s_load_dword s22, s[20:21], s22
    s_barrier
    s_waitcnt lgkmcnt(0)
    s_bfe_u32 s14, s22, 0x10004
    s_bfe_u32 s15, s22, 0x80008
    s_bfe_u32 s19, s22, 0x80010
    s_and_b32 s22, s22, 15
    s_cmp_eq_u32 s22, 1
    s_cbranch_scc1 Lrole1_18
    s_cmp_eq_u32 s22, 2
    s_cbranch_scc1 Lrole2_19
    s_cmp_eq_u32 s22, 3
    s_cbranch_scc1 Lrole3_20
    s_cmp_eq_u32 s22, 4
    s_cbranch_scc1 Lrole4_21
    s_cmp_eq_u32 s22, 5
    s_cbranch_scc1 Lrole5_22
    s_cmp_eq_u32 s22, 6
    s_cbranch_scc1 Lrole6_23
    s_cmp_eq_u32 s22, 7
    s_cbranch_scc1 Lrole7_24
interleave_layers__memory_aug_recurrent_mem_tr__glu_gated_glu__prompt_kernel_exit:
    s_endpgm
Lrole1_18:
    s_cmp_eq_u32 s14, 0
    s_cbranch_scc1 Lhb_27
    v_lshlrev_b32 v16, 7, v0
    s_mov_b32 s20, 125698048
Lwd_28:
    buffer_load_dwordx2 v[18:19], v16, s[8:11], s20 offen offset:0 sc1
    s_sub_u32 s18, s18, 1
    s_cbranch_scc1 interleave_layers__memory_aug_recurrent_mem_tr__glu_gated_glu__prompt_kernel_exit
    s_waitcnt vmcnt(0)
    v_xor_b32 v18, s78, v18
    v_xor_b32 v19, s79, v19
    v_or_b32 v18, v18, v19
    v_cmp_ne_u32 vcc, 0, v18
    s_cbranch_vccz Lwdok_29
    s_sleep 2
    s_branch Lwd_28
Lwdok_29:
    s_barrier
    v_and_b32 v16, 15, v0
    v_lshlrev_b32 v16, 7, v16
    s_mov_b32 s21, 121835520
Lwf_30:
    buffer_load_dword v18, v16, s[8:11], s21 offen sc1
    s_sub_u32 s18, s18, 1
    s_cbranch_scc1 interleave_layers__memory_aug_recurrent_mem_tr__glu_gated_glu__prompt_kernel_exit
    s_waitcnt vmcnt(0)
    v_cmp_eq_u32 vcc, 0, v18
    s_cbranch_vccz Lwfok_31
    s_sleep 2
    s_branch Lwf_30
Lwfok_31:
Lhb_27:
    s_mul_i32 s20, s15, 7
    s_add_u32 s20, s20, 0
    v_and_b32 v16, 7, v0
    v_min_u32 v16, 6, v16
    v_add_u32 v16, s20, v16
    v_mul_u32_u24 v17, 9363, v16
    v_lshrrev_b32 v17, 16, v17
    v_mul_u32_u24 v18, 7, v17
    v_sub_u32 v16, v16, v18
    v_lshrrev_b32 v18, 3, v17
    v_mul_u32_u24 v18, 7, v18
    v_add_u32 v16, v16, v18
    v_and_b32 v17, 7, v17
    v_lshl_add_u32 v16, v16, 3, v17
    v_lshlrev_b32 v16, 7, v16
    s_mov_b32 s20, 125698048
Lwd_32:
    buffer_load_dwordx2 v[18:19], v16, s[8:11], s20 offen offset:0 sc1
    s_sub_u32 s18, s18, 1
    s_cbranch_scc1 interleave_layers__memory_aug_recurrent_mem_tr__glu_gated_glu__prompt_kernel_exit
    s_waitcnt vmcnt(0)
    v_xor_b32 v18, s78, v18
    v_xor_b32 v19, s79, v19
    v_or_b32 v18, v18, v19
    v_cmp_ne_u32 vcc, 0, v18
    s_cbranch_vccz Lwdok_33
    s_sleep 2
    s_branch Lwd_32
Lwdok_33:
    v_and_b32 v7, 63, v0
    v_lshlrev_b32 v1, 4, v7
    s_mul_i32 s20, s12, 112
    v_add_u32 v2, s20, v7
    v_min_u32 v3, 47, v7
    s_add_u32 s20, s20, 64
    v_add_u32 v3, s20, v3
    v_lshlrev_b32 v2, 4, v2
    v_lshlrev_b32 v3, 4, v3
    v_and_b32 v8, 8, v7
    v_cmp_eq_u32 vcc, 0, v8
    v_mov_b32 v6, 0xeeee
    v_mov_b32 v8, 0x4444
    v_cndmask_b32 v6, v6, v8, vcc
    s_mul_i32 s20, s15, 28
    s_mul_i32 s21, s12, 7
    s_add_u32 s20, s20, s21
    s_and_b32 s22, s12, 1
    s_add_u32 s21, s20, s22
    s_mul_i32 s21, s21, 14336
    s_add_u32 s21, s21, 0
    s_xor_b32 s22, s22, 1
    s_mul_i32 s22, s22, 6
    s_add_u32 s20, s20, s22
    s_mul_i32 s20, s20, 14336
    s_add_u32 s20, s20, 0
    s_mov_b32 s24, s20
    s_mov_b32 s25, s21
    s_add_u32 s22, s24, 0
    buffer_load_dwordx4 a[0:3], v1, s[8:11], s22 offen offset:0 sc1
    buffer_load_dwordx4 a[4:7], v1, s[8:11], s22 offen offset:1024 sc1
    buffer_load_dwordx4 a[8:11], v1, s[8:11], s22 offen offset:2048 sc1
    buffer_load_dwordx4 a[12:15], v1, s[8:11], s22 offen offset:3072 sc1
    s_add_u32 s22, s25, 0
    buffer_load_dwordx4 a[56:59], v1, s[8:11], s22 offen offset:0 sc1
    buffer_load_dwordx4 a[60:63], v1, s[8:11], s22 offen offset:1024 sc1
    buffer_load_dwordx4 a[64:67], v1, s[8:11], s22 offen offset:2048 sc1
    buffer_load_dwordx4 a[68:71], v1, s[8:11], s22 offen offset:3072 sc1
    s_add_u32 s22, s25, 14336
    buffer_load_dwordx4 a[112:115], v1, s[8:11], s22 offen offset:0 sc1
    buffer_load_dwordx4 a[116:119], v1, s[8:11], s22 offen offset:1024 sc1
    buffer_load_dwordx4 a[120:123], v1, s[8:11], s22 offen offset:2048 sc1
    buffer_load_dwordx4 a[124:127], v1, s[8:11], s22 offen offset:3072 sc1
    s_mov_b32 s20, 125698048
    buffer_load_dwordx2 v[18:19], v16, s[8:11], s20 offen sc1
    s_add_u32 s22, s25, 28672
    buffer_load_dwordx4 a[168:171], v1, s[8:11], s22 offen offset:0 sc1
    buffer_load_dwordx4 a[172:175], v1, s[8:11], s22 offen offset:1024 sc1
    buffer_load_dwordx4 a[176:179], v1, s[8:11], s22 offen offset:2048 sc1
    buffer_load_dwordx4 a[180:183], v1, s[8:11], s22 offen offset:3072 sc1
    s_add_u32 s22, s25, 43008
    buffer_load_dwordx4 a[224:227], v1, s[8:11], s22 offen offset:0 sc1
    buffer_load_dwordx4 a[228:231], v1, s[8:11], s22 offen offset:1024 sc1
    buffer_load_dwordx4 a[232:235], v1, s[8:11], s22 offen offset:2048 sc1
    buffer_load_dwordx4 a[236:239], v1, s[8:11], s22 offen offset:3072 sc1
    s_add_u32 s22, s25, 57344
    buffer_load_dwordx4 v[144:147], v1, s[8:11], s22 offen offset:0 sc1
    buffer_load_dwordx4 v[148:151], v1, s[8:11], s22 offen offset:1024 sc1
    buffer_load_dwordx4 v[152:155], v1, s[8:11], s22 offen offset:2048 sc1
    buffer_load_dwordx4 v[156:159], v1, s[8:11], s22 offen offset:3072 sc1
    s_add_u32 s22, s25, 71680
    buffer_load_dwordx4 v[200:203], v1, s[8:11], s22 offen offset:0 sc1
    buffer_load_dwordx4 v[204:207], v1, s[8:11], s22 offen offset:1024 sc1
    buffer_load_dwordx4 v[208:211], v1, s[8:11], s22 offen offset:2048 sc1
    buffer_load_dwordx4 v[212:215], v1, s[8:11], s22 offen offset:3072 sc1
    s_waitcnt vmcnt(16)
    v_xor_b32 v18, s78, v18
    v_xor_b32 v19, s79, v19
    v_or_b32 v18, v18, v19
    v_cmp_ne_u32 vcc, 0, v18
    s_cbranch_vccz Lpk_34
    s_mov_b32 s20, 125698048
Lwd_35:
    buffer_load_dwordx2 v[18:19], v16, s[8:11], s20 offen offset:0 sc1
    s_sub_u32 s18, s18, 1
    s_cbranch_scc1 interleave_layers__memory_aug_recurrent_mem_tr__glu_gated_glu__prompt_kernel_exit
    s_waitcnt vmcnt(0)
    v_xor_b32 v18, s78, v18
    v_xor_b32 v19, s79, v19
    v_or_b32 v18, v18, v19
    v_cmp_ne_u32 vcc, 0, v18
    s_cbranch_vccz Lwdok_36
    s_sleep 2
    s_branch Lwd_35
Lwdok_36:
Lpk_34:
    s_add_u32 s22, s24, 4096
    buffer_load_dwordx4 a[16:19], v1, s[8:11], s22 offen offset:0 sc1
    buffer_load_dwordx4 a[20:23], v1, s[8:11], s22 offen offset:1024 sc1
    buffer_load_dwordx4 a[24:27], v1, s[8:11], s22 offen offset:2048 sc1
    buffer_load_dwordx4 a[28:31], v1, s[8:11], s22 offen offset:3072 sc1
    s_add_u32 s22, s24, 8192
    buffer_load_dwordx4 a[32:35], v1, s[8:11], s22 offen offset:0 sc1
    buffer_load_dwordx4 a[36:39], v1, s[8:11], s22 offen offset:1024 sc1
    buffer_load_dwordx4 a[40:43], v1, s[8:11], s22 offen offset:2048 sc1
    buffer_load_dwordx4 a[44:47], v1, s[8:11], s22 offen offset:3072 sc1
    s_add_u32 s22, s24, 12288
    buffer_load_dwordx4 a[48:51], v1, s[8:11], s22 offen offset:0 sc1
    buffer_load_dwordx4 a[52:55], v1, s[8:11], s22 offen offset:1024 sc1
    s_add_u32 s22, s25, 4096
    buffer_load_dwordx4 a[72:75], v1, s[8:11], s22 offen offset:0 sc1
    buffer_load_dwordx4 a[76:79], v1, s[8:11], s22 offen offset:1024 sc1
    buffer_load_dwordx4 a[80:83], v1, s[8:11], s22 offen offset:2048 sc1
    buffer_load_dwordx4 a[84:87], v1, s[8:11], s22 offen offset:3072 sc1
    s_add_u32 s22, s25, 8192
    buffer_load_dwordx4 a[88:91], v1, s[8:11], s22 offen offset:0 sc1
    buffer_load_dwordx4 a[92:95], v1, s[8:11], s22 offen offset:1024 sc1
    buffer_load_dwordx4 a[96:99], v1, s[8:11], s22 offen offset:2048 sc1
    buffer_load_dwordx4 a[100:103], v1, s[8:11], s22 offen offset:3072 sc1
    s_add_u32 s22, s25, 12288
    buffer_load_dwordx4 a[104:107], v1, s[8:11], s22 offen offset:0 sc1
    buffer_load_dwordx4 a[108:111], v1, s[8:11], s22 offen offset:1024 sc1
    s_add_u32 s22, s25, 18432
    buffer_load_dwordx4 a[128:131], v1, s[8:11], s22 offen offset:0 sc1
    buffer_load_dwordx4 a[132:135], v1, s[8:11], s22 offen offset:1024 sc1
    buffer_load_dwordx4 a[136:139], v1, s[8:11], s22 offen offset:2048 sc1
    buffer_load_dwordx4 a[140:143], v1, s[8:11], s22 offen offset:3072 sc1
    s_add_u32 s22, s25, 22528
    buffer_load_dwordx4 a[144:147], v1, s[8:11], s22 offen offset:0 sc1
    buffer_load_dwordx4 a[148:151], v1, s[8:11], s22 offen offset:1024 sc1
    buffer_load_dwordx4 a[152:155], v1, s[8:11], s22 offen offset:2048 sc1
    buffer_load_dwordx4 a[156:159], v1, s[8:11], s22 offen offset:3072 sc1
    s_add_u32 s22, s25, 26624
    buffer_load_dwordx4 a[160:163], v1, s[8:11], s22 offen offset:0 sc1
    buffer_load_dwordx4 a[164:167], v1, s[8:11], s22 offen offset:1024 sc1
    s_add_u32 s22, s25, 32768
    buffer_load_dwordx4 a[184:187], v1, s[8:11], s22 offen offset:0 sc1
    buffer_load_dwordx4 a[188:191], v1, s[8:11], s22 offen offset:1024 sc1
    buffer_load_dwordx4 a[192:195], v1, s[8:11], s22 offen offset:2048 sc1
    buffer_load_dwordx4 a[196:199], v1, s[8:11], s22 offen offset:3072 sc1
    s_add_u32 s22, s25, 36864
    buffer_load_dwordx4 a[200:203], v1, s[8:11], s22 offen offset:0 sc1
    buffer_load_dwordx4 a[204:207], v1, s[8:11], s22 offen offset:1024 sc1
    buffer_load_dwordx4 a[208:211], v1, s[8:11], s22 offen offset:2048 sc1
    buffer_load_dwordx4 a[212:215], v1, s[8:11], s22 offen offset:3072 sc1
    s_add_u32 s22, s25, 40960
    buffer_load_dwordx4 a[216:219], v1, s[8:11], s22 offen offset:0 sc1
    buffer_load_dwordx4 a[220:223], v1, s[8:11], s22 offen offset:1024 sc1
    s_add_u32 s22, s25, 47104
    buffer_load_dwordx4 a[240:243], v1, s[8:11], s22 offen offset:0 sc1
    buffer_load_dwordx4 a[244:247], v1, s[8:11], s22 offen offset:1024 sc1
    buffer_load_dwordx4 a[248:251], v1, s[8:11], s22 offen offset:2048 sc1
    buffer_load_dwordx4 a[252:255], v1, s[8:11], s22 offen offset:3072 sc1
    s_add_u32 s22, s25, 51200
    buffer_load_dwordx4 v[120:123], v1, s[8:11], s22 offen offset:0 sc1
    buffer_load_dwordx4 v[124:127], v1, s[8:11], s22 offen offset:1024 sc1
    buffer_load_dwordx4 v[128:131], v1, s[8:11], s22 offen offset:2048 sc1
    buffer_load_dwordx4 v[132:135], v1, s[8:11], s22 offen offset:3072 sc1
    s_add_u32 s22, s25, 55296
    buffer_load_dwordx4 v[136:139], v1, s[8:11], s22 offen offset:0 sc1
    buffer_load_dwordx4 v[140:143], v1, s[8:11], s22 offen offset:1024 sc1
    s_add_u32 s22, s25, 61440
    buffer_load_dwordx4 v[160:163], v1, s[8:11], s22 offen offset:0 sc1
    buffer_load_dwordx4 v[164:167], v1, s[8:11], s22 offen offset:1024 sc1
    s_waitcnt vmcnt(40)
    buffer_load_dwordx4 v[168:171], v1, s[8:11], s22 offen offset:2048 sc1
    buffer_load_dwordx4 v[172:175], v1, s[8:11], s22 offen offset:3072 sc1
    s_add_u32 s22, s25, 65536
    buffer_load_dwordx4 v[176:179], v1, s[8:11], s22 offen offset:0 sc1
    buffer_load_dwordx4 v[180:183], v1, s[8:11], s22 offen offset:1024 sc1
    buffer_load_dwordx4 v[184:187], v1, s[8:11], s22 offen offset:2048 sc1
    buffer_load_dwordx4 v[188:191], v1, s[8:11], s22 offen offset:3072 sc1
    s_add_u32 s22, s25, 69632
    buffer_load_dwordx4 v[192:195], v1, s[8:11], s22 offen offset:0 sc1
    buffer_load_dwordx4 v[196:199], v1, s[8:11], s22 offen offset:1024 sc1
    s_waitcnt vmcnt(40)
    s_add_u32 s22, s25, 75776
    buffer_load_dwordx4 v[216:219], v1, s[8:11], s22 offen offset:0 sc1
    buffer_load_dwordx4 v[220:223], v1, s[8:11], s22 offen offset:1024 sc1
    buffer_load_dwordx4 v[224:227], v1, s[8:11], s22 offen offset:2048 sc1
    buffer_load_dwordx4 v[228:231], v1, s[8:11], s22 offen offset:3072 sc1
    s_add_u32 s22, s25, 79872
    buffer_load_dwordx4 v[232:235], v1, s[8:11], s22 offen offset:0 sc1
    buffer_load_dwordx4 v[236:239], v1, s[8:11], s22 offen offset:1024 sc1
    buffer_load_dwordx4 v[240:243], v1, s[8:11], s22 offen offset:2048 sc1
    buffer_load_dwordx4 v[244:247], v1, s[8:11], s22 offen offset:3072 sc1
    s_waitcnt vmcnt(40)
    s_add_u32 s22, s25, 83968
    buffer_load_dwordx4 v[248:251], v1, s[8:11], s22 offen offset:0 sc1
    buffer_load_dwordx4 v[252:255], v1, s[8:11], s22 offen offset:1024 sc1
    v_mov_b32 v114, v7
    v_and_b32 v112, 15, v114
    v_lshrrev_b32 v113, 4, v114
    s_mul_i32 s20, s12, 3584
    s_add_u32 s20, s20, 8192
    v_lshlrev_b32 v8, 3, v114
    v_add_u32 v8, s20, v8
    v_lshlrev_b32 v7, 5, v112
    v_lshl_add_u32 v7, v113, 3, v7
    v_add_u32 v7, s20, v7
    s_mul_i32 s20, s12, 7
    s_add_u32 s20, s20, 1
    s_lshr_b32 s20, s20, 1
    s_lshr_b32 s21, s12, 1
    s_mul_i32 s21, s21, 7
    s_add_u32 s21, s21, 3
    s_lshl_b32 s30, s20, 10
    s_lshl_b32 s31, s21, 10
    s_and_b32 s22, s12, 1
    v_and_b32 v115, 7, v114
    v_lshlrev_b32 v116, 4, v115
    v_lshrrev_b32 v117, 1, v113
    v_lshl_add_u32 v116, v117, 8, v116
    v_and_b32 v117, 1, v113
    v_lshl_add_u32 v116, v117, 3, v116
    s_lshl_b32 s20, s20, 9
    s_add_u32 s20, s20, 0
    v_add_u32 v9, s20, v116
    v_add_u32 v4, 1024, v9
    s_lshl_b32 s21, s21, 9
    s_lshl_b32 s23, s22, 2
    s_add_u32 s21, s21, s23
    s_add_u32 s21, s21, 0
    v_add_u32 v10, s21, v116
    s_lshl_b32 s22, s22, 3
    v_add_u32 v12, s22, v1
    s_lshl_b32 s20, s12, 11
    s_add_u32 s20, s20, 24576
    v_bfe_u32 v117, v114, 3, 1
    v_lshl_add_u32 v118, v117, 2, v113
    v_mul_u32_u24 v13, 144, v118
    v_lshl_add_u32 v13, v115, 4, v13
    v_add_u32 v13, s20, v13
    v_lshl_add_u32 v118, v113, 1, v117
    v_mul_u32_u24 v5, 80, v118
    v_lshl_add_u32 v5, v115, 3, v5
    s_add_u32 s20, s20, 1152
    v_add_u32 v5, s20, v5
    v_and_b32 v115, 31, v114
    v_lshrrev_b32 v116, 5, v114
    s_lshl_b32 s20, s12, 1
    v_add_u32 v116, s20, v116
    v_lshrrev_b32 v117, 1, v115
    v_and_b32 v118, 1, v115
    v_mul_u32_u24 v14, 144, v117
    v_lshl_add_u32 v14, v116, 4, v14
    v_lshl_add_u32 v14, v118, 3, v14
    v_min_u32 v119, 19, v115
    v_subrev_u32 v119, 16, v119
    v_mul_u32_u24 v119, 80, v119
    v_lshl_add_u32 v119, v116, 3, v119
    v_add_u32 v119, 1152, v119
    v_cmp_gt_u32 vcc, 16, v115
    s_nop 1
    v_cndmask_b32 v14, v119, v14, vcc
    v_add_u32 v14, 24576, v14
    s_lshr_b32 s20, s15, 1
    s_lshl_b32 s20, s20, 10
    s_and_b32 s21, s15, 1
    s_lshl_b32 s22, s21, 7
    s_add_u32 s20, s20, s22
    v_and_b32 v119, 3, v117
    v_lshlrev_b32 v15, 8, v119
    v_lshl_add_u32 v15, v116, 4, v15
    v_lshl_add_u32 v15, v118, 2, v15
    v_lshrrev_b32 v119, 3, v115
    v_lshl_add_u32 v15, v119, 3, v15
    v_add_u32 v15, s20, v15
    s_lshr_b32 s20, s15, 2
    s_lshl_b32 s20, s20, 9
    s_add_u32 s20, s20, 8192
    s_lshl_b32 s21, s21, 3
    s_add_u32 s20, s20, s21
    s_and_b32 s21, s15, 2
    s_lshl_b32 s21, s21, 7
    s_add_u32 s20, s20, s21
    v_and_b32 v119, 1, v117
    v_lshlrev_b32 v119, 7, v119
    v_lshl_add_u32 v119, v116, 4, v119
    v_lshl_add_u32 v119, v118, 2, v119
    v_add_u32 v119, s20, v119
    v_cndmask_b32 v15, v119, v15, vcc
    v_cmp_gt_u32 vcc, 20, v115
    v_mov_b32 v117, 0x7f000000
    v_mov_b32 v118, 0xff800000
    v_mov_b32 v119, 0x7f800000
    v_cndmask_b32 v15, v117, v15, vcc
    v_cndmask_b32 v90, v118, v119, vcc
    v_and_b32 v91, 7, v114
    v_min_u32 v91, 6, v91
    v_lshlrev_b32 v91, 7, v91
    v_mov_b32 v88, -1
    s_lshl_b32 s32, s14, 15
    s_add_u32 s32, s32, 119013376
    s_lshl_b32 s33, s14, 16
    s_add_u32 s33, s33, 119078912
    s_lshl_b32 s20, s14, 6
    s_mul_i32 s26, s20, 28672
    s_add_u32 s26, s26, 12845056
    s_mul_i32 s27, s20, 1024
    s_add_u32 s27, s27, 122097664
    s_mul_i32 s40, s14, 1024
    s_cmp_eq_u32 s14, 0
    s_cselect_b32 s27, 120265728, s27
    s_mov_b32 s17, 0
    s_mov_b32 s24, s32
    s_mov_b32 s25, s33
    s_add_u32 s34, s33, 49152
    s_lshl_b32 s42, s14, 7
    s_lshl_b32 s20, s15, 2
    s_add_u32 s42, s42, s20
    s_add_u32 s42, s42, 121833472
    v_lshlrev_b32 v16, 7, v0
    s_mov_b32 s20, 125698048
Lwd_37:
    buffer_load_dwordx2 v[18:19], v16, s[8:11], s20 offen offset:0 sc1
    s_sub_u32 s18, s18, 1
    s_cbranch_scc1 interleave_layers__memory_aug_recurrent_mem_tr__glu_gated_glu__prompt_kernel_exit
    s_waitcnt vmcnt(0)
    v_xor_b32 v18, s78, v18
    v_xor_b32 v19, s79, v19
    v_or_b32 v18, v18, v19
    v_cmp_ne_u32 vcc, 0, v18
    s_cbranch_vccz Lwdok_38
    s_sleep 2
    s_branch Lwd_37
Lwdok_38:
    s_barrier
    v_and_b32 v92, 7, v0
    v_lshlrev_b32 v92, 7, v92
    s_mov_b32 s21, 125730816
Lcm_39:
    buffer_load_dword v93, v92, s[8:11], s21 offen sc1
    s_sub_u32 s18, s18, 1
    s_cbranch_scc1 interleave_layers__memory_aug_recurrent_mem_tr__glu_gated_glu__prompt_kernel_exit
    s_waitcnt vmcnt(0)
    s_lshr_b32 s23, s13, 5
    s_nop 3
    v_readlane_b32 s22, v93, s23
    s_cmp_ge_u32 s22, 30
    s_cbranch_scc1 Lcmd_40
    s_mov_b32 s23, 0
    v_readlane_b32 s22, v93, 0
    s_add_u32 s23, s23, s22
    v_readlane_b32 s22, v93, 1
    s_add_u32 s23, s23, s22
    v_readlane_b32 s22, v93, 2
    s_add_u32 s23, s23, s22
    v_readlane_b32 s22, v93, 3
    s_add_u32 s23, s23, s22
    v_readlane_b32 s22, v93, 4
    s_add_u32 s23, s23, s22
    v_readlane_b32 s22, v93, 5
    s_add_u32 s23, s23, s22
    v_readlane_b32 s22, v93, 6
    s_add_u32 s23, s23, s22
    v_readlane_b32 s22, v93, 7
    s_add_u32 s23, s23, s22
    s_cmp_lt_u32 s23, 256
    s_cbranch_scc1 Lcm_39
    s_mov_b32 s16, 0
Lcmd_40:
Lwf_41:
    buffer_load_dword v89, v91, s[8:11], s27 offen sc1
    s_sub_u32 s18, s18, 1
    s_cbranch_scc1 interleave_layers__memory_aug_recurrent_mem_tr__glu_gated_glu__prompt_kernel_exit
    s_waitcnt vmcnt(0)
    v_cmp_eq_u32 vcc, 0, v89
    s_cbranch_vccz Lwfok_42
    s_sleep 2
    s_branch Lwf_41
Lwfok_42:
    s_add_u32 s36, s26, s30
    s_add_u32 s37, s26, s31
    s_add_u32 s38, s36, 14336
    s_add_u32 s39, s37, 14336
    s_add_u32 s26, s26, 28672
    s_add_u32 s27, s27, s40
    buffer_load_dwordx2 v[68:69], v12, s[8:11], s37 offen sc1
    buffer_load_dwordx2 v[70:71], v12, s[8:11], s39 offen sc1
    buffer_load_dwordx4 v[72:75], v1, s[8:11], s36 offen offset:0 sc1
    buffer_load_dwordx4 v[76:79], v1, s[8:11], s38 offen offset:0 sc1
    buffer_load_dwordx4 v[80:83], v1, s[8:11], s36 offen offset:1024 sc1
    buffer_load_dwordx4 v[84:87], v1, s[8:11], s38 offen offset:1024 sc1
    buffer_load_dwordx4 v[104:107], v1, s[8:11], s36 offen offset:2048 sc1
    buffer_load_dwordx4 v[108:111], v1, s[8:11], s38 offen offset:2048 sc1
    buffer_load_dword v89, v91, s[8:11], s27 offen sc1
    s_waitcnt vmcnt(0)
    s_cmp_eq_u32 s16, 1
    s_cbranch_scc0 Lkslow_43
Lk_44:
    s_waitcnt vmcnt(1)
Lkc_47:
    v_max3_u32 v112, v68, v70, v72
    v_max3_u32 v113, v76, v80, v84
    v_max3_u32 v112, v112, v104, v108
    v_max_u32 v112, v112, v113
    v_cmp_eq_u32 vcc, -1, v112
    s_cbranch_vccnz Lkb_46
    v_cmp_eq_u32 vcc, 0, v89
    s_cbranch_vccz Lkf_45
Lwf_48:
    buffer_load_dword v89, v91, s[8:11], s27 offen sc1
    s_sub_u32 s18, s18, 1
    s_cbranch_scc1 interleave_layers__memory_aug_recurrent_mem_tr__glu_gated_glu__prompt_kernel_exit
    s_waitcnt vmcnt(0)
    v_cmp_eq_u32 vcc, 0, v89
    s_cbranch_vccz Lwfok_49
    s_sleep 2
    s_branch Lwf_48
Lwfok_49:
Lkf_45:
    s_add_u32 s36, s26, s30
    s_add_u32 s37, s26, s31
    s_add_u32 s38, s36, 14336
    s_add_u32 s39, s37, 14336
    s_add_u32 s26, s26, 28672
    s_add_u32 s27, s27, s40
    s_add_u32 s25, s17, 0
    s_and_b32 s25, s25, 3
    s_lshl_b32 s25, s25, 14
    s_add_u32 s25, s25, s33
    v_mov_b64 v[44:45], 0
    v_mov_b64 v[46:47], 0
    v_mov_b64 v[48:49], 0
    v_mov_b64 v[50:51], 0
    v_mov_b64 v[52:53], 0
    v_mov_b64 v[54:55], 0
    v_mov_b64 v[56:57], 0
    v_mov_b64 v[58:59], 0
    v_mov_b64 v[64:65], 0
    v_mov_b64 v[66:67], 0
    s_sleep 14
    buffer_load_dwordx4 v[92:95], v2, s[8:11], s24 offen sc1
    buffer_load_dwordx4 v[96:99], v3, s[8:11], s24 offen sc1
    s_sleep 2
Lpm_50:
    buffer_load_dwordx4 v[60:63], v2, s[8:11], s24 offen sc1
    buffer_load_dwordx4 v[100:103], v3, s[8:11], s24 offen sc1
    s_waitcnt vmcnt(2)
    v_max3_u32 v112, v92, v93, v94
    v_max3_u32 v113, v95, v96, v97
    v_max3_u32 v112, v112, v98, v99
    v_max_u32 v112, v112, v113
    v_cmp_eq_u32 vcc, -1, v112
    ds_write_b128 v2, v[92:95] offset:0
    ds_write_b128 v3, v[96:99] offset:0
    s_cbranch_vccz Lpmok_51
    buffer_load_dwordx4 v[92:95], v2, s[8:11], s24 offen sc1
    buffer_load_dwordx4 v[96:99], v3, s[8:11], s24 offen sc1
    s_sub_u32 s18, s18, 1
    s_cbranch_scc1 interleave_layers__memory_aug_recurrent_mem_tr__glu_gated_glu__prompt_kernel_exit
    s_waitcnt vmcnt(2)
    v_max3_u32 v112, v60, v61, v62
    v_max3_u32 v113, v63, v100, v101
    v_max3_u32 v112, v112, v102, v103
    v_max_u32 v112, v112, v113
    v_cmp_eq_u32 vcc, -1, v112
    ds_write_b128 v2, v[60:63] offset:0
    ds_write_b128 v3, v[100:103] offset:0
    s_cbranch_vccnz Lpm_50
Lpmok_51:
    s_waitcnt lgkmcnt(0)
    s_barrier
    ds_read_b128 v[16:19], v1 offset:0
    ds_read_b128 v[20:23], v1 offset:1024
    ds_read_b128 v[24:27], v1 offset:2048
    ds_read_b128 v[28:31], v1 offset:3072
    ds_read_b128 v[32:35], v1 offset:4096
    ds_read_b128 v[36:39], v1 offset:5120
    ds_read_b128 v[40:43], v1 offset:6144
    s_waitcnt lgkmcnt(6)
    v_smfmac_f32_16x16x64_bf16 v[44:47], v[16:19], a[0:7], v6
    s_waitcnt lgkmcnt(5)
    v_smfmac_f32_16x16x64_bf16 v[44:47], v[20:23], a[8:15], v6
    s_waitcnt lgkmcnt(4)
    v_smfmac_f32_16x16x64_bf16 v[44:47], v[24:27], a[16:23], v6
    s_waitcnt lgkmcnt(3)
    v_smfmac_f32_16x16x64_bf16 v[44:47], v[28:31], a[24:31], v6
    s_waitcnt lgkmcnt(2)
    v_smfmac_f32_16x16x64_bf16 v[44:47], v[32:35], a[32:39], v6
    s_waitcnt lgkmcnt(1)
    v_smfmac_f32_16x16x64_bf16 v[44:47], v[36:39], a[40:47], v6
    s_waitcnt lgkmcnt(0)
    v_smfmac_f32_16x16x64_bf16 v[44:47], v[40:43], a[48:55], v6
    v_smfmac_f32_16x16x64_bf16 v[48:51], v[16:19], a[56:63], v6
    ds_read2_b32 v[116:117], v10 offset0:0 offset1:32
    v_smfmac_f32_16x16x64_bf16 v[48:51], v[20:23], a[64:71], v6
    buffer_store_dword v88, v15, s[8:11], s34 offen
    v_smfmac_f32_16x16x64_bf16 v[48:51], v[24:27], a[72:79], v6
    v_smfmac_f32_16x16x64_bf16 v[48:51], v[28:31], a[80:87], v6
    buffer_load_dword v89, v91, s[8:11], s27 offen sc1
    v_smfmac_f32_16x16x64_bf16 v[48:51], v[32:35], a[88:95], v6
    v_smfmac_f32_16x16x64_bf16 v[48:51], v[36:39], a[96:103], v6
    v_smfmac_f32_16x16x64_bf16 v[48:51], v[40:43], a[104:111], v6
    s_waitcnt vmcnt(2)
    v_smfmac_f32_16x16x64_bf16 v[52:55], v[16:19], a[112:119], v6
    v_cvt_pk_bf16_f32 v112, v44, v45
    v_smfmac_f32_16x16x64_bf16 v[52:55], v[20:23], a[120:127], v6
    v_cvt_pk_bf16_f32 v113, v46, v47
    v_smfmac_f32_16x16x64_bf16 v[52:55], v[24:27], a[128:135], v6
    ds_write_b64 v7, v[112:113] offset:0
    v_smfmac_f32_16x16x64_bf16 v[52:55], v[28:31], a[136:143], v6
    ds_read_b64_tr_b16 v[60:61], v8 offset:0
    v_smfmac_f32_16x16x64_bf16 v[52:55], v[32:35], a[144:151], v6
    v_mov_b64 v[44:45], 0
    v_smfmac_f32_16x16x64_bf16 v[52:55], v[36:39], a[152:159], v6
    v_mov_b64 v[46:47], 0
    v_smfmac_f32_16x16x64_bf16 v[52:55], v[40:43], a[160:167], v6
    v_cvt_pk_bf16_f32 v112, v48, v49
    v_smfmac_f32_16x16x64_bf16 v[56:59], v[16:19], a[168:175], v6
    v_cvt_pk_bf16_f32 v113, v50, v51
    v_smfmac_f32_16x16x64_bf16 v[56:59], v[20:23], a[176:183], v6
    s_waitcnt lgkmcnt(0)
    v_mfma_f32_16x16x16_bf16 v[92:95], v[68:69], v[60:61], 0
    ds_write_b64 v7, v[112:113] offset:512
    v_mfma_f32_16x16x16_bf16 v[96:99], v[70:71], v[60:61], 0
    buffer_load_dwordx2 v[68:69], v12, s[8:11], s37 offen sc1
    v_mfma_f32_16x16x16_bf16 v[100:103], v[116:117], v[60:61], 0
    ds_read_b64_tr_b16 v[60:61], v8 offset:512
    v_smfmac_f32_16x16x64_bf16 v[56:59], v[24:27], a[184:191], v6
    ds_read2_b32 v[116:117], v9 offset0:0 offset1:32
    v_smfmac_f32_16x16x64_bf16 v[56:59], v[28:31], a[192:199], v6
    ds_read2_b32 v[118:119], v9 offset0:1 offset1:33
    v_smfmac_f32_16x16x64_bf16 v[56:59], v[32:35], a[200:207], v6
    v_mov_b64 v[48:49], 0
    v_smfmac_f32_16x16x64_bf16 v[56:59], v[36:39], a[208:215], v6
    v_mov_b64 v[50:51], 0
    v_smfmac_f32_16x16x64_bf16 v[56:59], v[40:43], a[216:223], v6
    buffer_load_dwordx2 v[70:71], v12, s[8:11], s39 offen sc1
    v_smfmac_f32_16x16x64_bf16 v[44:47], v[16:19], a[224:231], v6
    v_cvt_pk_bf16_f32 v114, v52, v53
    v_smfmac_f32_16x16x64_bf16 v[44:47], v[20:23], a[232:239], v6
    v_cvt_pk_bf16_f32 v115, v54, v55
    v_smfmac_f32_16x16x64_bf16 v[44:47], v[24:27], a[240:247], v6
    ds_write_b64 v7, v[114:115] offset:1024
    v_smfmac_f32_16x16x64_bf16 v[44:47], v[28:31], a[248:255], v6
    ds_read_b64_tr_b16 v[62:63], v8 offset:1024
    v_smfmac_f32_16x16x64_bf16 v[44:47], v[32:35], v[120:127], v6
    ds_read2_b32 v[52:53], v4 offset0:0 offset1:32
    v_smfmac_f32_16x16x64_bf16 v[44:47], v[36:39], v[128:135], v6
    ds_read2_b32 v[54:55], v4 offset0:1 offset1:33
    v_smfmac_f32_16x16x64_bf16 v[44:47], v[40:43], v[136:143], v6
    v_smfmac_f32_16x16x64_bf16 v[48:51], v[16:19], v[144:151], v6
    v_cvt_pk_bf16_f32 v112, v56, v57
    v_smfmac_f32_16x16x64_bf16 v[48:51], v[20:23], v[152:159], v6
    v_cvt_pk_bf16_f32 v113, v58, v59
    s_waitcnt lgkmcnt(0)
    v_mfma_f32_16x16x32_bf16 v[92:95], v[72:75], v[60:63], v[92:95]
    ds_write_b64 v7, v[112:113] offset:1536
    v_mfma_f32_16x16x32_bf16 v[96:99], v[76:79], v[60:63], v[96:99]
    buffer_load_dwordx4 v[72:75], v1, s[8:11], s36 offen offset:0 sc1
    v_mfma_f32_16x16x32_bf16 v[100:103], v[116:119], v[60:63], v[100:103]
    ds_read_b64_tr_b16 v[60:61], v8 offset:1536
    v_smfmac_f32_16x16x64_bf16 v[48:51], v[24:27], v[160:167], v6
    ds_read2_b32 v[116:117], v9 offset0:128 offset1:160
    v_smfmac_f32_16x16x64_bf16 v[48:51], v[28:31], v[168:175], v6
    ds_read2_b32 v[118:119], v9 offset0:129 offset1:161
    v_smfmac_f32_16x16x64_bf16 v[48:51], v[32:35], v[176:183], v6
    v_smfmac_f32_16x16x64_bf16 v[48:51], v[36:39], v[184:191], v6
    buffer_load_dwordx4 v[76:79], v1, s[8:11], s38 offen offset:0 sc1
    v_smfmac_f32_16x16x64_bf16 v[48:51], v[40:43], v[192:199], v6
    v_smfmac_f32_16x16x64_bf16 v[64:67], v[16:19], v[200:207], v6
    v_cvt_pk_bf16_f32 v114, v44, v45
    v_smfmac_f32_16x16x64_bf16 v[64:67], v[20:23], v[208:215], v6
    v_cvt_pk_bf16_f32 v115, v46, v47
    v_smfmac_f32_16x16x64_bf16 v[64:67], v[24:27], v[216:223], v6
    ds_write_b64 v7, v[114:115] offset:2048
    v_smfmac_f32_16x16x64_bf16 v[64:67], v[28:31], v[224:231], v6
    ds_read_b64_tr_b16 v[62:63], v8 offset:2048
    v_smfmac_f32_16x16x64_bf16 v[64:67], v[32:35], v[232:239], v6
    v_smfmac_f32_16x16x64_bf16 v[64:67], v[36:39], v[240:247], v6
    v_smfmac_f32_16x16x64_bf16 v[64:67], v[40:43], v[248:255], v6
    v_cvt_pk_bf16_f32 v112, v48, v49
    s_waitcnt lgkmcnt(0)
    v_mfma_f32_16x16x32_bf16 v[92:95], v[80:83], v[60:63], v[92:95]
    v_cvt_pk_bf16_f32 v113, v50, v51
    v_mfma_f32_16x16x32_bf16 v[96:99], v[84:87], v[60:63], v[96:99]
    ds_write_b64 v7, v[112:113] offset:2560
    v_mfma_f32_16x16x32_bf16 v[100:103], v[116:119], v[60:63], v[100:103]
    ds_read_b64_tr_b16 v[56:57], v8 offset:2560
    v_cvt_pk_bf16_f32 v114, v64, v65
    v_cvt_pk_bf16_f32 v115, v66, v67
    ds_write_b64 v7, v[114:115] offset:3072
    ds_read_b64_tr_b16 v[58:59], v8 offset:3072
    buffer_load_dwordx4 v[80:83], v1, s[8:11], s36 offen offset:1024 sc1
    s_add_u32 s24, s17, 1
    s_and_b32 s24, s24, 3
    s_lshl_b32 s24, s24, 13
    s_add_u32 s24, s24, s32
    buffer_load_dwordx4 v[84:87], v1, s[8:11], s38 offen offset:1024 sc1
    s_waitcnt lgkmcnt(0)
    v_mfma_f32_16x16x32_bf16 v[100:103], v[52:55], v[56:59], v[100:103]
    v_mfma_f32_16x16x32_bf16 v[92:95], v[104:107], v[56:59], v[92:95]
    v_mfma_f32_16x16x32_bf16 v[96:99], v[108:111], v[56:59], v[96:99]
    buffer_load_dwordx4 v[104:107], v1, s[8:11], s36 offen offset:2048 sc1
    s_mov_b32 s34, s25
    buffer_load_dwordx4 v[108:111], v1, s[8:11], s38 offen offset:2048 sc1
    s_nop 2
    v_add_f32_dpp v112, v100, v100 row_ror:8 row_mask:0xf bank_mask:0x3
    v_add_f32_dpp v112, v102, v102 row_ror:8 row_mask:0xf bank_mask:0xc
    v_add_f32_dpp v113, v101, v101 row_ror:8 row_mask:0xf bank_mask:0x3
    v_add_f32_dpp v113, v103, v103 row_ror:8 row_mask:0xf bank_mask:0xc
    ds_write_b64 v5, v[112:113]
    v_add_f32_dpp v60, v92, v92 row_ror:8 row_mask:0xf bank_mask:0x3
    v_add_f32_dpp v60, v96, v96 row_ror:8 row_mask:0xf bank_mask:0xc
    v_add_f32_dpp v61, v93, v93 row_ror:8 row_mask:0xf bank_mask:0x3
    v_add_f32_dpp v61, v97, v97 row_ror:8 row_mask:0xf bank_mask:0xc
    v_add_f32_dpp v62, v94, v94 row_ror:8 row_mask:0xf bank_mask:0x3
    v_add_f32_dpp v62, v98, v98 row_ror:8 row_mask:0xf bank_mask:0xc
    v_add_f32_dpp v63, v95, v95 row_ror:8 row_mask:0xf bank_mask:0x3
    v_add_f32_dpp v63, v99, v99 row_ror:8 row_mask:0xf bank_mask:0xc
    ds_write_b128 v13, v[60:63]
    s_waitcnt lgkmcnt(0)
    s_barrier
    ds_read_b64 v[44:45], v14 offset:0
    ds_read_b64 v[46:47], v14 offset:2048
    ds_read_b64 v[48:49], v14 offset:4096
    ds_read_b64 v[50:51], v14 offset:6144
    s_waitcnt lgkmcnt(2)
    v_pk_add_f32 v[44:45], v[44:45], v[46:47]
    s_waitcnt lgkmcnt(0)
    v_pk_add_f32 v[48:49], v[48:49], v[50:51]
    v_pk_add_f32 v[44:45], v[44:45], v[48:49]
    v_min_f32 v44, v44, v90
    v_min_f32 v45, v45, v90
    v_max_f32 v48, v44, v45
    s_nop 1
    v_max_f32_dpp v48, v48, v48 row_ror:8 row_mask:0xf bank_mask:0xf
    s_nop 1
    v_max_f32_dpp v48, v48, v48 row_ror:4 row_mask:0xf bank_mask:0xf
    s_nop 1
    v_max_f32_dpp v48, v48, v48 row_ror:2 row_mask:0xf bank_mask:0xf
    s_nop 1
    v_max_f32_dpp v48, v48, v48 row_ror:1 row_mask:0xf bank_mask:0xf
    v_mov_b32 v49, v48
    s_nop 1
    v_permlane16_swap_b32 v48, v49
    v_max_f32 v48, v48, v49
    v_sub_f32 v44, v44, v48
    v_sub_f32 v45, v45, v48
    v_exp_f32 v44, v44
    v_exp_f32 v45, v45
    s_nop 0
    v_add_f32 v48, v44, v45
    s_nop 1
    v_add_f32_dpp v48, v48, v48 row_ror:8 row_mask:0xf bank_mask:0xf
    s_nop 1
    v_add_f32_dpp v48, v48, v48 row_ror:4 row_mask:0xf bank_mask:0xf
    s_nop 1
    v_add_f32_dpp v48, v48, v48 row_ror:2 row_mask:0xf bank_mask:0xf
    s_nop 1
    v_add_f32_dpp v48, v48, v48 row_ror:1 row_mask:0xf bank_mask:0xf
    v_mov_b32 v49, v48
    s_nop 1
    v_permlane16_swap_b32 v48, v49
    v_add_f32 v48, v48, v49
    v_rcp_f32 v48, v48
    s_add_u32 s17, s17, 1
    v_mul_f32 v44, v44, v48
    v_mul_f32 v45, v45, v48
    v_cvt_pk_bf16_f32 v44, v44, v45
    v_min_u32 v44, 0xfffffffe, v44
    buffer_store_dword v44, v15, s[8:11], s25 offen
    s_cmp_ge_u32 s17, 63
    s_cbranch_scc1 Ldone_26
    s_branch Lk_44
Lkb_46:
    s_sub_u32 s18, s18, 1
    s_cbranch_scc1 interleave_layers__memory_aug_recurrent_mem_tr__glu_gated_glu__prompt_kernel_exit
    buffer_load_dwordx2 v[68:69], v12, s[8:11], s37 offen sc1
    buffer_load_dwordx2 v[70:71], v12, s[8:11], s39 offen sc1
    buffer_load_dwordx4 v[72:75], v1, s[8:11], s36 offen offset:0 sc1
    buffer_load_dwordx4 v[76:79], v1, s[8:11], s38 offen offset:0 sc1
    buffer_load_dwordx4 v[80:83], v1, s[8:11], s36 offen offset:1024 sc1
    buffer_load_dwordx4 v[84:87], v1, s[8:11], s38 offen offset:1024 sc1
    buffer_load_dwordx4 v[104:107], v1, s[8:11], s36 offen offset:2048 sc1
    buffer_load_dwordx4 v[108:111], v1, s[8:11], s38 offen offset:2048 sc1
    s_waitcnt vmcnt(0)
    s_branch Lkc_47
Lkslow_43:
Lk_52:
    s_waitcnt vmcnt(1)
Lkc_55:
    v_max3_u32 v112, v68, v70, v72
    v_max3_u32 v113, v76, v80, v84
    v_max3_u32 v112, v112, v104, v108
    v_max_u32 v112, v112, v113
    v_cmp_eq_u32 vcc, -1, v112
    s_cbranch_vccnz Lkb_54
    v_cmp_eq_u32 vcc, 0, v89
    s_cbranch_vccz Lkf_53
Lwf_56:
    buffer_load_dword v89, v91, s[8:11], s27 offen sc1
    s_sub_u32 s18, s18, 1
    s_cbranch_scc1 interleave_layers__memory_aug_recurrent_mem_tr__glu_gated_glu__prompt_kernel_exit
    s_waitcnt vmcnt(0)
    v_cmp_eq_u32 vcc, 0, v89
    s_cbranch_vccz Lwfok_57
    s_sleep 2
    s_branch Lwf_56
Lwfok_57:
Lkf_53:
    s_add_u32 s36, s26, s30
    s_add_u32 s37, s26, s31
    s_add_u32 s38, s36, 14336
    s_add_u32 s39, s37, 14336
    s_add_u32 s26, s26, 28672
    s_add_u32 s27, s27, s40
    s_add_u32 s25, s17, 0
    s_and_b32 s25, s25, 3
    s_lshl_b32 s25, s25, 14
    s_add_u32 s25, s25, s33
    v_mov_b64 v[44:45], 0
    v_mov_b64 v[46:47], 0
    v_mov_b64 v[48:49], 0
    v_mov_b64 v[50:51], 0
    v_mov_b64 v[52:53], 0
    v_mov_b64 v[54:55], 0
    v_mov_b64 v[56:57], 0
    v_mov_b64 v[58:59], 0
    v_mov_b64 v[64:65], 0
    v_mov_b64 v[66:67], 0
    s_sleep 14
    buffer_load_dwordx4 v[92:95], v2, s[8:11], s24 offen sc1
    buffer_load_dwordx4 v[96:99], v3, s[8:11], s24 offen sc1
    s_sleep 2
Lpm_58:
    buffer_load_dwordx4 v[60:63], v2, s[8:11], s24 offen sc1
    buffer_load_dwordx4 v[100:103], v3, s[8:11], s24 offen sc1
    s_waitcnt vmcnt(2)
    v_max3_u32 v112, v92, v93, v94
    v_max3_u32 v113, v95, v96, v97
    v_max3_u32 v112, v112, v98, v99
    v_max_u32 v112, v112, v113
    v_cmp_eq_u32 vcc, -1, v112
    ds_write_b128 v2, v[92:95] offset:0
    ds_write_b128 v3, v[96:99] offset:0
    s_cbranch_vccz Lpmok_59
    buffer_load_dwordx4 v[92:95], v2, s[8:11], s24 offen sc1
    buffer_load_dwordx4 v[96:99], v3, s[8:11], s24 offen sc1
    s_sub_u32 s18, s18, 1
    s_cbranch_scc1 interleave_layers__memory_aug_recurrent_mem_tr__glu_gated_glu__prompt_kernel_exit
    s_waitcnt vmcnt(2)
    v_max3_u32 v112, v60, v61, v62
    v_max3_u32 v113, v63, v100, v101
    v_max3_u32 v112, v112, v102, v103
    v_max_u32 v112, v112, v113
    v_cmp_eq_u32 vcc, -1, v112
    ds_write_b128 v2, v[60:63] offset:0
    ds_write_b128 v3, v[100:103] offset:0
    s_cbranch_vccnz Lpm_58
Lpmok_59:
    s_waitcnt lgkmcnt(0)
    s_barrier
    ds_read_b128 v[16:19], v1 offset:0
    ds_read_b128 v[20:23], v1 offset:1024
    ds_read_b128 v[24:27], v1 offset:2048
    ds_read_b128 v[28:31], v1 offset:3072
    ds_read_b128 v[32:35], v1 offset:4096
    ds_read_b128 v[36:39], v1 offset:5120
    ds_read_b128 v[40:43], v1 offset:6144
    s_waitcnt lgkmcnt(6)
    v_smfmac_f32_16x16x64_bf16 v[44:47], v[16:19], a[0:7], v6
    s_waitcnt lgkmcnt(5)
    v_smfmac_f32_16x16x64_bf16 v[44:47], v[20:23], a[8:15], v6
    s_waitcnt lgkmcnt(4)
    v_smfmac_f32_16x16x64_bf16 v[44:47], v[24:27], a[16:23], v6
    s_waitcnt lgkmcnt(3)
    v_smfmac_f32_16x16x64_bf16 v[44:47], v[28:31], a[24:31], v6
    s_waitcnt lgkmcnt(2)
    v_smfmac_f32_16x16x64_bf16 v[44:47], v[32:35], a[32:39], v6
    s_waitcnt lgkmcnt(1)
    v_smfmac_f32_16x16x64_bf16 v[44:47], v[36:39], a[40:47], v6
    s_waitcnt lgkmcnt(0)
    v_smfmac_f32_16x16x64_bf16 v[44:47], v[40:43], a[48:55], v6
    v_smfmac_f32_16x16x64_bf16 v[48:51], v[16:19], a[56:63], v6
    ds_read2_b32 v[116:117], v10 offset0:0 offset1:32
    v_smfmac_f32_16x16x64_bf16 v[48:51], v[20:23], a[64:71], v6
    buffer_store_dword v88, v15, s[8:11], s34 offen sc1
    v_smfmac_f32_16x16x64_bf16 v[48:51], v[24:27], a[72:79], v6
    v_smfmac_f32_16x16x64_bf16 v[48:51], v[28:31], a[80:87], v6
    buffer_load_dword v89, v91, s[8:11], s27 offen sc1
    v_smfmac_f32_16x16x64_bf16 v[48:51], v[32:35], a[88:95], v6
    v_smfmac_f32_16x16x64_bf16 v[48:51], v[36:39], a[96:103], v6
    v_smfmac_f32_16x16x64_bf16 v[48:51], v[40:43], a[104:111], v6
    s_waitcnt vmcnt(2)
    v_smfmac_f32_16x16x64_bf16 v[52:55], v[16:19], a[112:119], v6
    v_cvt_pk_bf16_f32 v112, v44, v45
    v_smfmac_f32_16x16x64_bf16 v[52:55], v[20:23], a[120:127], v6
    v_cvt_pk_bf16_f32 v113, v46, v47
    v_smfmac_f32_16x16x64_bf16 v[52:55], v[24:27], a[128:135], v6
    ds_write_b64 v7, v[112:113] offset:0
    v_smfmac_f32_16x16x64_bf16 v[52:55], v[28:31], a[136:143], v6
    ds_read_b64_tr_b16 v[60:61], v8 offset:0
    v_smfmac_f32_16x16x64_bf16 v[52:55], v[32:35], a[144:151], v6
    v_mov_b64 v[44:45], 0
    v_smfmac_f32_16x16x64_bf16 v[52:55], v[36:39], a[152:159], v6
    v_mov_b64 v[46:47], 0
    v_smfmac_f32_16x16x64_bf16 v[52:55], v[40:43], a[160:167], v6
    v_cvt_pk_bf16_f32 v112, v48, v49
    v_smfmac_f32_16x16x64_bf16 v[56:59], v[16:19], a[168:175], v6
    v_cvt_pk_bf16_f32 v113, v50, v51
    v_smfmac_f32_16x16x64_bf16 v[56:59], v[20:23], a[176:183], v6
    s_waitcnt lgkmcnt(0)
    v_mfma_f32_16x16x16_bf16 v[92:95], v[68:69], v[60:61], 0
    ds_write_b64 v7, v[112:113] offset:512
    v_mfma_f32_16x16x16_bf16 v[96:99], v[70:71], v[60:61], 0
    buffer_load_dwordx2 v[68:69], v12, s[8:11], s37 offen sc1
    v_mfma_f32_16x16x16_bf16 v[100:103], v[116:117], v[60:61], 0
    ds_read_b64_tr_b16 v[60:61], v8 offset:512
    v_smfmac_f32_16x16x64_bf16 v[56:59], v[24:27], a[184:191], v6
    ds_read2_b32 v[116:117], v9 offset0:0 offset1:32
    v_smfmac_f32_16x16x64_bf16 v[56:59], v[28:31], a[192:199], v6
    ds_read2_b32 v[118:119], v9 offset0:1 offset1:33
    v_smfmac_f32_16x16x64_bf16 v[56:59], v[32:35], a[200:207], v6
    v_mov_b64 v[48:49], 0
    v_smfmac_f32_16x16x64_bf16 v[56:59], v[36:39], a[208:215], v6
    v_mov_b64 v[50:51], 0
    v_smfmac_f32_16x16x64_bf16 v[56:59], v[40:43], a[216:223], v6
    buffer_load_dwordx2 v[70:71], v12, s[8:11], s39 offen sc1
    v_smfmac_f32_16x16x64_bf16 v[44:47], v[16:19], a[224:231], v6
    v_cvt_pk_bf16_f32 v114, v52, v53
    v_smfmac_f32_16x16x64_bf16 v[44:47], v[20:23], a[232:239], v6
    v_cvt_pk_bf16_f32 v115, v54, v55
    v_smfmac_f32_16x16x64_bf16 v[44:47], v[24:27], a[240:247], v6
    ds_write_b64 v7, v[114:115] offset:1024
    v_smfmac_f32_16x16x64_bf16 v[44:47], v[28:31], a[248:255], v6
    ds_read_b64_tr_b16 v[62:63], v8 offset:1024
    v_smfmac_f32_16x16x64_bf16 v[44:47], v[32:35], v[120:127], v6
    ds_read2_b32 v[52:53], v4 offset0:0 offset1:32
    v_smfmac_f32_16x16x64_bf16 v[44:47], v[36:39], v[128:135], v6
    ds_read2_b32 v[54:55], v4 offset0:1 offset1:33
    v_smfmac_f32_16x16x64_bf16 v[44:47], v[40:43], v[136:143], v6
    v_smfmac_f32_16x16x64_bf16 v[48:51], v[16:19], v[144:151], v6
    v_cvt_pk_bf16_f32 v112, v56, v57
    v_smfmac_f32_16x16x64_bf16 v[48:51], v[20:23], v[152:159], v6
    v_cvt_pk_bf16_f32 v113, v58, v59
    s_waitcnt lgkmcnt(0)
    v_mfma_f32_16x16x32_bf16 v[92:95], v[72:75], v[60:63], v[92:95]
    ds_write_b64 v7, v[112:113] offset:1536
    v_mfma_f32_16x16x32_bf16 v[96:99], v[76:79], v[60:63], v[96:99]
    buffer_load_dwordx4 v[72:75], v1, s[8:11], s36 offen offset:0 sc1
    v_mfma_f32_16x16x32_bf16 v[100:103], v[116:119], v[60:63], v[100:103]
    ds_read_b64_tr_b16 v[60:61], v8 offset:1536
    v_smfmac_f32_16x16x64_bf16 v[48:51], v[24:27], v[160:167], v6
    ds_read2_b32 v[116:117], v9 offset0:128 offset1:160
    v_smfmac_f32_16x16x64_bf16 v[48:51], v[28:31], v[168:175], v6
    ds_read2_b32 v[118:119], v9 offset0:129 offset1:161
    v_smfmac_f32_16x16x64_bf16 v[48:51], v[32:35], v[176:183], v6
    v_smfmac_f32_16x16x64_bf16 v[48:51], v[36:39], v[184:191], v6
    buffer_load_dwordx4 v[76:79], v1, s[8:11], s38 offen offset:0 sc1
    v_smfmac_f32_16x16x64_bf16 v[48:51], v[40:43], v[192:199], v6
    v_smfmac_f32_16x16x64_bf16 v[64:67], v[16:19], v[200:207], v6
    v_cvt_pk_bf16_f32 v114, v44, v45
    v_smfmac_f32_16x16x64_bf16 v[64:67], v[20:23], v[208:215], v6
    v_cvt_pk_bf16_f32 v115, v46, v47
    v_smfmac_f32_16x16x64_bf16 v[64:67], v[24:27], v[216:223], v6
    ds_write_b64 v7, v[114:115] offset:2048
    v_smfmac_f32_16x16x64_bf16 v[64:67], v[28:31], v[224:231], v6
    ds_read_b64_tr_b16 v[62:63], v8 offset:2048
    v_smfmac_f32_16x16x64_bf16 v[64:67], v[32:35], v[232:239], v6
    v_smfmac_f32_16x16x64_bf16 v[64:67], v[36:39], v[240:247], v6
    v_smfmac_f32_16x16x64_bf16 v[64:67], v[40:43], v[248:255], v6
    v_cvt_pk_bf16_f32 v112, v48, v49
    s_waitcnt lgkmcnt(0)
    v_mfma_f32_16x16x32_bf16 v[92:95], v[80:83], v[60:63], v[92:95]
    v_cvt_pk_bf16_f32 v113, v50, v51
    v_mfma_f32_16x16x32_bf16 v[96:99], v[84:87], v[60:63], v[96:99]
    ds_write_b64 v7, v[112:113] offset:2560
    v_mfma_f32_16x16x32_bf16 v[100:103], v[116:119], v[60:63], v[100:103]
    ds_read_b64_tr_b16 v[56:57], v8 offset:2560
    v_cvt_pk_bf16_f32 v114, v64, v65
    v_cvt_pk_bf16_f32 v115, v66, v67
    ds_write_b64 v7, v[114:115] offset:3072
    ds_read_b64_tr_b16 v[58:59], v8 offset:3072
    buffer_load_dwordx4 v[80:83], v1, s[8:11], s36 offen offset:1024 sc1
    s_add_u32 s24, s17, 1
    s_and_b32 s24, s24, 3
    s_lshl_b32 s24, s24, 13
    s_add_u32 s24, s24, s32
    buffer_load_dwordx4 v[84:87], v1, s[8:11], s38 offen offset:1024 sc1
    s_waitcnt lgkmcnt(0)
    v_mfma_f32_16x16x32_bf16 v[100:103], v[52:55], v[56:59], v[100:103]
    v_mfma_f32_16x16x32_bf16 v[92:95], v[104:107], v[56:59], v[92:95]
    v_mfma_f32_16x16x32_bf16 v[96:99], v[108:111], v[56:59], v[96:99]
    buffer_load_dwordx4 v[104:107], v1, s[8:11], s36 offen offset:2048 sc1
    s_mov_b32 s34, s25
    buffer_load_dwordx4 v[108:111], v1, s[8:11], s38 offen offset:2048 sc1
    s_nop 2
    v_add_f32_dpp v112, v100, v100 row_ror:8 row_mask:0xf bank_mask:0x3
    v_add_f32_dpp v112, v102, v102 row_ror:8 row_mask:0xf bank_mask:0xc
    v_add_f32_dpp v113, v101, v101 row_ror:8 row_mask:0xf bank_mask:0x3
    v_add_f32_dpp v113, v103, v103 row_ror:8 row_mask:0xf bank_mask:0xc
    ds_write_b64 v5, v[112:113]
    v_add_f32_dpp v60, v92, v92 row_ror:8 row_mask:0xf bank_mask:0x3
    v_add_f32_dpp v60, v96, v96 row_ror:8 row_mask:0xf bank_mask:0xc
    v_add_f32_dpp v61, v93, v93 row_ror:8 row_mask:0xf bank_mask:0x3
    v_add_f32_dpp v61, v97, v97 row_ror:8 row_mask:0xf bank_mask:0xc
    v_add_f32_dpp v62, v94, v94 row_ror:8 row_mask:0xf bank_mask:0x3
    v_add_f32_dpp v62, v98, v98 row_ror:8 row_mask:0xf bank_mask:0xc
    v_add_f32_dpp v63, v95, v95 row_ror:8 row_mask:0xf bank_mask:0x3
    v_add_f32_dpp v63, v99, v99 row_ror:8 row_mask:0xf bank_mask:0xc
    ds_write_b128 v13, v[60:63]
    s_waitcnt lgkmcnt(0)
    s_barrier
    ds_read_b64 v[44:45], v14 offset:0
    ds_read_b64 v[46:47], v14 offset:2048
    ds_read_b64 v[48:49], v14 offset:4096
    ds_read_b64 v[50:51], v14 offset:6144
    s_waitcnt lgkmcnt(2)
    v_pk_add_f32 v[44:45], v[44:45], v[46:47]
    s_waitcnt lgkmcnt(0)
    v_pk_add_f32 v[48:49], v[48:49], v[50:51]
    v_pk_add_f32 v[44:45], v[44:45], v[48:49]
    v_min_f32 v44, v44, v90
    v_min_f32 v45, v45, v90
    v_max_f32 v48, v44, v45
    s_nop 1
    v_max_f32_dpp v48, v48, v48 row_ror:8 row_mask:0xf bank_mask:0xf
    s_nop 1
    v_max_f32_dpp v48, v48, v48 row_ror:4 row_mask:0xf bank_mask:0xf
    s_nop 1
    v_max_f32_dpp v48, v48, v48 row_ror:2 row_mask:0xf bank_mask:0xf
    s_nop 1
    v_max_f32_dpp v48, v48, v48 row_ror:1 row_mask:0xf bank_mask:0xf
    v_mov_b32 v49, v48
    s_nop 1
    v_permlane16_swap_b32 v48, v49
    v_max_f32 v48, v48, v49
    v_sub_f32 v44, v44, v48
    v_sub_f32 v45, v45, v48
    v_exp_f32 v44, v44
    v_exp_f32 v45, v45
    s_nop 0
    v_add_f32 v48, v44, v45
    s_nop 1
    v_add_f32_dpp v48, v48, v48 row_ror:8 row_mask:0xf bank_mask:0xf
    s_nop 1
    v_add_f32_dpp v48, v48, v48 row_ror:4 row_mask:0xf bank_mask:0xf
    s_nop 1
    v_add_f32_dpp v48, v48, v48 row_ror:2 row_mask:0xf bank_mask:0xf
    s_nop 1
    v_add_f32_dpp v48, v48, v48 row_ror:1 row_mask:0xf bank_mask:0xf
    v_mov_b32 v49, v48
    s_nop 1
    v_permlane16_swap_b32 v48, v49
    v_add_f32 v48, v48, v49
    v_rcp_f32 v48, v48
    s_add_u32 s17, s17, 1
    v_mul_f32 v44, v44, v48
    v_mul_f32 v45, v45, v48
    v_cvt_pk_bf16_f32 v44, v44, v45
    v_min_u32 v44, 0xfffffffe, v44
    buffer_store_dword v44, v15, s[8:11], s25 offen sc1
    s_cmp_ge_u32 s17, 63
    s_cbranch_scc1 Ldone_26
    s_branch Lk_52
Lkb_54:
    s_sub_u32 s18, s18, 1
    s_cbranch_scc1 interleave_layers__memory_aug_recurrent_mem_tr__glu_gated_glu__prompt_kernel_exit
    buffer_load_dwordx2 v[68:69], v12, s[8:11], s37 offen sc1
    buffer_load_dwordx2 v[70:71], v12, s[8:11], s39 offen sc1
    buffer_load_dwordx4 v[72:75], v1, s[8:11], s36 offen offset:0 sc1
    buffer_load_dwordx4 v[76:79], v1, s[8:11], s38 offen offset:0 sc1
    buffer_load_dwordx4 v[80:83], v1, s[8:11], s36 offen offset:1024 sc1
    buffer_load_dwordx4 v[84:87], v1, s[8:11], s38 offen offset:1024 sc1
    buffer_load_dwordx4 v[104:107], v1, s[8:11], s36 offen offset:2048 sc1
    buffer_load_dwordx4 v[108:111], v1, s[8:11], s38 offen offset:2048 sc1
    s_waitcnt vmcnt(0)
    s_branch Lkc_55
Ldone_26:
    s_branch interleave_layers__memory_aug_recurrent_mem_tr__glu_gated_glu__prompt_kernel_exit
Lrole2_19:
    s_cmp_eq_u32 s14, 0
    s_cbranch_scc1 Lhb_61
    v_lshlrev_b32 v16, 7, v0
    s_mov_b32 s20, 125698048
Lwd_62:
    buffer_load_dwordx2 v[18:19], v16, s[8:11], s20 offen offset:0 sc1
    s_sub_u32 s18, s18, 1
    s_cbranch_scc1 interleave_layers__memory_aug_recurrent_mem_tr__glu_gated_glu__prompt_kernel_exit
    s_waitcnt vmcnt(0)
    v_xor_b32 v18, s78, v18
    v_xor_b32 v19, s79, v19
    v_or_b32 v18, v18, v19
    v_cmp_ne_u32 vcc, 0, v18
    s_cbranch_vccz Lwdok_63
    s_sleep 2
    s_branch Lwd_62
Lwdok_63:
    s_barrier
    v_and_b32 v16, 15, v0
    v_lshlrev_b32 v16, 7, v16
    s_mov_b32 s21, 121835520
Lwf_64:
    buffer_load_dword v18, v16, s[8:11], s21 offen sc1
    s_sub_u32 s18, s18, 1
    s_cbranch_scc1 interleave_layers__memory_aug_recurrent_mem_tr__glu_gated_glu__prompt_kernel_exit
    s_waitcnt vmcnt(0)
    v_cmp_eq_u32 vcc, 0, v18
    s_cbranch_vccz Lwfok_65
    s_sleep 2
    s_branch Lwf_64
Lwfok_65:
Lhb_61:
    v_and_b32 v16, 15, v0
    v_mul_u32_u24 v16, 7, v16
    s_lshr_b32 s20, s15, 1
    s_add_u32 s20, s20, 112
    v_add_u32 v16, s20, v16
    v_mul_u32_u24 v17, 9363, v16
    v_lshrrev_b32 v17, 16, v17
    v_mul_u32_u24 v18, 7, v17
    v_sub_u32 v16, v16, v18
    v_lshrrev_b32 v18, 3, v17
    v_mul_u32_u24 v18, 7, v18
    v_add_u32 v16, v16, v18
    v_and_b32 v17, 7, v17
    v_lshl_add_u32 v16, v16, 3, v17
    v_lshlrev_b32 v16, 7, v16
    s_mov_b32 s20, 125698048
Lwd_66:
    buffer_load_dwordx2 v[18:19], v16, s[8:11], s20 offen offset:0 sc1
    s_sub_u32 s18, s18, 1
    s_cbranch_scc1 interleave_layers__memory_aug_recurrent_mem_tr__glu_gated_glu__prompt_kernel_exit
    s_waitcnt vmcnt(0)
    v_xor_b32 v18, s78, v18
    v_xor_b32 v19, s79, v19
    v_or_b32 v18, v18, v19
    v_cmp_ne_u32 vcc, 0, v18
    s_cbranch_vccz Lwdok_67
    s_sleep 2
    s_branch Lwd_66
Lwdok_67:
    v_and_b32 v7, 63, v0
    v_lshlrev_b32 v1, 4, v7
    s_mul_i32 s20, s12, 112
    v_add_u32 v2, s20, v7
    v_min_u32 v3, 47, v7
    s_add_u32 s20, s20, 64
    v_add_u32 v3, s20, v3
    v_lshlrev_b32 v2, 4, v2
    v_lshlrev_b32 v3, 4, v3
    v_and_b32 v8, 8, v7
    v_cmp_eq_u32 vcc, 0, v8
    v_mov_b32 v6, 0xeeee
    v_mov_b32 v8, 0x4444
    v_cndmask_b32 v6, v6, v8, vcc
    s_mul_i32 s20, s12, 28672
    s_add_u32 s20, s20, 16384
    s_mul_i32 s21, s12, 112
    s_lshl_b32 s28, s15, 1
    s_add_u32 s21, s21, s28
    s_mul_i32 s21, s21, 14336
    s_add_u32 s21, s21, 6422528
    s_mov_b32 s24, s20
    s_mov_b32 s25, s21
    s_add_u32 s28, s25, 1204224
    s_add_u32 m0, s24, 0
    s_nop 0
    buffer_load_dwordx4 v1, s[8:11], s28 offen offset:0 sc1 lds
    buffer_load_dwordx4 v1, s[8:11], s28 offen offset:1024 sc1 lds
    buffer_load_dwordx4 v1, s[8:11], s28 offen offset:2048 sc1 lds
    buffer_load_dwordx4 v1, s[8:11], s28 offen offset:3072 sc1 lds
    s_add_u32 s28, s25, 1218560
    s_add_u32 m0, s24, 14336
    s_nop 0
    buffer_load_dwordx4 v1, s[8:11], s28 offen offset:0 sc1 lds
    buffer_load_dwordx4 v1, s[8:11], s28 offen offset:1024 sc1 lds
    buffer_load_dwordx4 v1, s[8:11], s28 offen offset:2048 sc1 lds
    buffer_load_dwordx4 v1, s[8:11], s28 offen offset:3072 sc1 lds
    s_add_u32 s28, s25, 0
    buffer_load_dwordx4 a[0:3], v1, s[8:11], s28 offen offset:0 sc1
    buffer_load_dwordx4 a[4:7], v1, s[8:11], s28 offen offset:1024 sc1
    buffer_load_dwordx4 a[8:11], v1, s[8:11], s28 offen offset:2048 sc1
    buffer_load_dwordx4 a[12:15], v1, s[8:11], s28 offen offset:3072 sc1
    s_add_u32 s28, s25, 14336
    buffer_load_dwordx4 a[56:59], v1, s[8:11], s28 offen offset:0 sc1
    buffer_load_dwordx4 a[60:63], v1, s[8:11], s28 offen offset:1024 sc1
    buffer_load_dwordx4 a[64:67], v1, s[8:11], s28 offen offset:2048 sc1
    buffer_load_dwordx4 a[68:71], v1, s[8:11], s28 offen offset:3072 sc1
    s_mov_b32 s20, 125698048
    buffer_load_dwordx2 v[18:19], v16, s[8:11], s20 offen sc1
    s_add_u32 s28, s25, 401408
    buffer_load_dwordx4 a[112:115], v1, s[8:11], s28 offen offset:0 sc1
    buffer_load_dwordx4 a[116:119], v1, s[8:11], s28 offen offset:1024 sc1
    buffer_load_dwordx4 a[120:123], v1, s[8:11], s28 offen offset:2048 sc1
    buffer_load_dwordx4 a[124:127], v1, s[8:11], s28 offen offset:3072 sc1
    s_add_u32 s28, s25, 415744
    buffer_load_dwordx4 a[168:171], v1, s[8:11], s28 offen offset:0 sc1
    buffer_load_dwordx4 a[172:175], v1, s[8:11], s28 offen offset:1024 sc1
    buffer_load_dwordx4 a[176:179], v1, s[8:11], s28 offen offset:2048 sc1
    buffer_load_dwordx4 a[180:183], v1, s[8:11], s28 offen offset:3072 sc1
    s_add_u32 s28, s25, 802816
    buffer_load_dwordx4 a[224:227], v1, s[8:11], s28 offen offset:0 sc1
    buffer_load_dwordx4 a[228:231], v1, s[8:11], s28 offen offset:1024 sc1
    buffer_load_dwordx4 a[232:235], v1, s[8:11], s28 offen offset:2048 sc1
    buffer_load_dwordx4 a[236:239], v1, s[8:11], s28 offen offset:3072 sc1
    s_add_u32 s28, s25, 817152
    buffer_load_dwordx4 v[200:203], v1, s[8:11], s28 offen offset:0 sc1
    buffer_load_dwordx4 v[204:207], v1, s[8:11], s28 offen offset:1024 sc1
    buffer_load_dwordx4 v[208:211], v1, s[8:11], s28 offen offset:2048 sc1
    buffer_load_dwordx4 v[212:215], v1, s[8:11], s28 offen offset:3072 sc1
    s_waitcnt vmcnt(16)
    v_xor_b32 v18, s78, v18
    v_xor_b32 v19, s79, v19
    v_or_b32 v18, v18, v19
    v_cmp_ne_u32 vcc, 0, v18
    s_cbranch_vccz Lpk_68
    s_mov_b32 s20, 125698048
Lwd_69:
    buffer_load_dwordx2 v[18:19], v16, s[8:11], s20 offen offset:0 sc1
    s_sub_u32 s18, s18, 1
    s_cbranch_scc1 interleave_layers__memory_aug_recurrent_mem_tr__glu_gated_glu__prompt_kernel_exit
    s_waitcnt vmcnt(0)
    v_xor_b32 v18, s78, v18
    v_xor_b32 v19, s79, v19
    v_or_b32 v18, v18, v19
    v_cmp_ne_u32 vcc, 0, v18
    s_cbranch_vccz Lwdok_70
    s_sleep 2
    s_branch Lwd_69
Lwdok_70:
Lpk_68:
    s_add_u32 s28, s25, 1208320
    s_add_u32 m0, s24, 4096
    s_nop 0
    buffer_load_dwordx4 v1, s[8:11], s28 offen offset:0 sc1 lds
    buffer_load_dwordx4 v1, s[8:11], s28 offen offset:1024 sc1 lds
    buffer_load_dwordx4 v1, s[8:11], s28 offen offset:2048 sc1 lds
    buffer_load_dwordx4 v1, s[8:11], s28 offen offset:3072 sc1 lds
    s_add_u32 s28, s25, 1212416
    s_add_u32 m0, s24, 8192
    s_nop 0
    buffer_load_dwordx4 v1, s[8:11], s28 offen offset:0 sc1 lds
    buffer_load_dwordx4 v1, s[8:11], s28 offen offset:1024 sc1 lds
    buffer_load_dwordx4 v1, s[8:11], s28 offen offset:2048 sc1 lds
    buffer_load_dwordx4 v1, s[8:11], s28 offen offset:3072 sc1 lds
    s_add_u32 s28, s25, 1216512
    s_add_u32 m0, s24, 12288
    s_nop 0
    buffer_load_dwordx4 v1, s[8:11], s28 offen offset:0 sc1 lds
    buffer_load_dwordx4 v1, s[8:11], s28 offen offset:1024 sc1 lds
    s_add_u32 s28, s25, 1222656
    s_add_u32 m0, s24, 18432
    s_nop 0
    buffer_load_dwordx4 v1, s[8:11], s28 offen offset:0 sc1 lds
    buffer_load_dwordx4 v1, s[8:11], s28 offen offset:1024 sc1 lds
    buffer_load_dwordx4 v1, s[8:11], s28 offen offset:2048 sc1 lds
    buffer_load_dwordx4 v1, s[8:11], s28 offen offset:3072 sc1 lds
    s_add_u32 s28, s25, 1226752
    s_add_u32 m0, s24, 22528
    s_nop 0
    buffer_load_dwordx4 v1, s[8:11], s28 offen offset:0 sc1 lds
    buffer_load_dwordx4 v1, s[8:11], s28 offen offset:1024 sc1 lds
    buffer_load_dwordx4 v1, s[8:11], s28 offen offset:2048 sc1 lds
    buffer_load_dwordx4 v1, s[8:11], s28 offen offset:3072 sc1 lds
    s_add_u32 s28, s25, 1230848
    s_add_u32 m0, s24, 26624
    s_nop 0
    buffer_load_dwordx4 v1, s[8:11], s28 offen offset:0 sc1 lds
    buffer_load_dwordx4 v1, s[8:11], s28 offen offset:1024 sc1 lds
    s_add_u32 s28, s25, 4096
    buffer_load_dwordx4 a[16:19], v1, s[8:11], s28 offen offset:0 sc1
    buffer_load_dwordx4 a[20:23], v1, s[8:11], s28 offen offset:1024 sc1
    buffer_load_dwordx4 a[24:27], v1, s[8:11], s28 offen offset:2048 sc1
    buffer_load_dwordx4 a[28:31], v1, s[8:11], s28 offen offset:3072 sc1
    s_add_u32 s28, s25, 8192
    buffer_load_dwordx4 a[32:35], v1, s[8:11], s28 offen offset:0 sc1
    buffer_load_dwordx4 a[36:39], v1, s[8:11], s28 offen offset:1024 sc1
    buffer_load_dwordx4 a[40:43], v1, s[8:11], s28 offen offset:2048 sc1
    buffer_load_dwordx4 a[44:47], v1, s[8:11], s28 offen offset:3072 sc1
    s_add_u32 s28, s25, 12288
    buffer_load_dwordx4 a[48:51], v1, s[8:11], s28 offen offset:0 sc1
    buffer_load_dwordx4 a[52:55], v1, s[8:11], s28 offen offset:1024 sc1
    s_add_u32 s28, s25, 18432
    buffer_load_dwordx4 a[72:75], v1, s[8:11], s28 offen offset:0 sc1
    buffer_load_dwordx4 a[76:79], v1, s[8:11], s28 offen offset:1024 sc1
    buffer_load_dwordx4 a[80:83], v1, s[8:11], s28 offen offset:2048 sc1
    buffer_load_dwordx4 a[84:87], v1, s[8:11], s28 offen offset:3072 sc1
    s_add_u32 s28, s25, 22528
    buffer_load_dwordx4 a[88:91], v1, s[8:11], s28 offen offset:0 sc1
    buffer_load_dwordx4 a[92:95], v1, s[8:11], s28 offen offset:1024 sc1
    buffer_load_dwordx4 a[96:99], v1, s[8:11], s28 offen offset:2048 sc1
    buffer_load_dwordx4 a[100:103], v1, s[8:11], s28 offen offset:3072 sc1
    s_add_u32 s28, s25, 26624
    buffer_load_dwordx4 a[104:107], v1, s[8:11], s28 offen offset:0 sc1
    buffer_load_dwordx4 a[108:111], v1, s[8:11], s28 offen offset:1024 sc1
    s_add_u32 s28, s25, 405504
    buffer_load_dwordx4 a[128:131], v1, s[8:11], s28 offen offset:0 sc1
    buffer_load_dwordx4 a[132:135], v1, s[8:11], s28 offen offset:1024 sc1
    buffer_load_dwordx4 a[136:139], v1, s[8:11], s28 offen offset:2048 sc1
    buffer_load_dwordx4 a[140:143], v1, s[8:11], s28 offen offset:3072 sc1
    s_add_u32 s28, s25, 409600
    buffer_load_dwordx4 a[144:147], v1, s[8:11], s28 offen offset:0 sc1
    buffer_load_dwordx4 a[148:151], v1, s[8:11], s28 offen offset:1024 sc1
    buffer_load_dwordx4 a[152:155], v1, s[8:11], s28 offen offset:2048 sc1
    buffer_load_dwordx4 a[156:159], v1, s[8:11], s28 offen offset:3072 sc1
    s_waitcnt vmcnt(40)
    s_add_u32 s28, s25, 413696
    buffer_load_dwordx4 a[160:163], v1, s[8:11], s28 offen offset:0 sc1
    buffer_load_dwordx4 a[164:167], v1, s[8:11], s28 offen offset:1024 sc1
    s_add_u32 s28, s25, 419840
    buffer_load_dwordx4 a[184:187], v1, s[8:11], s28 offen offset:0 sc1
    buffer_load_dwordx4 a[188:191], v1, s[8:11], s28 offen offset:1024 sc1
    buffer_load_dwordx4 a[192:195], v1, s[8:11], s28 offen offset:2048 sc1
    buffer_load_dwordx4 a[196:199], v1, s[8:11], s28 offen offset:3072 sc1
    s_add_u32 s28, s25, 423936
    buffer_load_dwordx4 a[200:203], v1, s[8:11], s28 offen offset:0 sc1
    buffer_load_dwordx4 a[204:207], v1, s[8:11], s28 offen offset:1024 sc1
    s_waitcnt vmcnt(40)
    buffer_load_dwordx4 a[208:211], v1, s[8:11], s28 offen offset:2048 sc1
    buffer_load_dwordx4 a[212:215], v1, s[8:11], s28 offen offset:3072 sc1
    s_add_u32 s28, s25, 428032
    buffer_load_dwordx4 a[216:219], v1, s[8:11], s28 offen offset:0 sc1
    buffer_load_dwordx4 a[220:223], v1, s[8:11], s28 offen offset:1024 sc1
    s_add_u32 s28, s25, 806912
    buffer_load_dwordx4 a[240:243], v1, s[8:11], s28 offen offset:0 sc1
    buffer_load_dwordx4 a[244:247], v1, s[8:11], s28 offen offset:1024 sc1
    buffer_load_dwordx4 a[248:251], v1, s[8:11], s28 offen offset:2048 sc1
    buffer_load_dwordx4 a[252:255], v1, s[8:11], s28 offen offset:3072 sc1
    s_waitcnt vmcnt(40)
    s_add_u32 s28, s25, 811008
    buffer_load_dwordx4 v[176:179], v1, s[8:11], s28 offen offset:0 sc1
    buffer_load_dwordx4 v[180:183], v1, s[8:11], s28 offen offset:1024 sc1
    buffer_load_dwordx4 v[184:187], v1, s[8:11], s28 offen offset:2048 sc1
    buffer_load_dwordx4 v[188:191], v1, s[8:11], s28 offen offset:3072 sc1
    s_add_u32 s28, s25, 815104
    buffer_load_dwordx4 v[192:195], v1, s[8:11], s28 offen offset:0 sc1
    buffer_load_dwordx4 v[196:199], v1, s[8:11], s28 offen offset:1024 sc1
    s_add_u32 s28, s25, 821248
    buffer_load_dwordx4 v[216:219], v1, s[8:11], s28 offen offset:0 sc1
    buffer_load_dwordx4 v[220:223], v1, s[8:11], s28 offen offset:1024 sc1
    s_waitcnt vmcnt(40)
    buffer_load_dwordx4 v[224:227], v1, s[8:11], s28 offen offset:2048 sc1
    buffer_load_dwordx4 v[228:231], v1, s[8:11], s28 offen offset:3072 sc1
    s_add_u32 s28, s25, 825344
    buffer_load_dwordx4 v[232:235], v1, s[8:11], s28 offen offset:0 sc1
    buffer_load_dwordx4 v[236:239], v1, s[8:11], s28 offen offset:1024 sc1
    buffer_load_dwordx4 v[240:243], v1, s[8:11], s28 offen offset:2048 sc1
    buffer_load_dwordx4 v[244:247], v1, s[8:11], s28 offen offset:3072 sc1
    s_add_u32 s28, s25, 829440
    buffer_load_dwordx4 v[248:251], v1, s[8:11], s28 offen offset:0 sc1
    buffer_load_dwordx4 v[252:255], v1, s[8:11], s28 offen offset:1024 sc1
    s_waitcnt vmcnt(40)
    s_mov_b32 s20, s24
    v_mov_b32 v14, v7
    v_add_u32 v7, s20, v1
    v_and_b32 v15, 7, v14
    v_lshrrev_b32 v170, 4, v14
    v_bfe_u32 v171, v14, 3, 1
    v_lshrrev_b32 v172, 5, v14
    s_lshl_b32 s20, s12, 11
    v_add_u32 v8, s20, v1
    v_lshlrev_b32 v9, 7, v170
    v_lshl_add_u32 v9, v15, 4, v9
    v_lshl_add_u32 v10, v171, 9, v9
    s_lshl_b32 s20, s12, 10
    s_add_u32 s20, s20, 8192
    v_add_u32 v10, s20, v10
    s_lshl_b32 s21, s12, 9
    s_add_u32 s21, s21, 8192
    v_add_u32 v9, s21, v9
    v_and_b32 v11, 15, v14
    v_lshlrev_b32 v11, 4, v11
    v_lshl_add_u32 v11, v170, 10, v11
    s_lshl_b32 s20, s12, 8
    s_add_u32 s20, s20, 8192
    v_add_u32 v11, s20, v11
    v_lshlrev_b32 v12, 4, v15
    v_lshl_add_u32 v4, v171, 3, v12
    v_lshl_add_u32 v4, v172, 2, v4
    s_lshl_b32 s20, s15, 2
    s_add_u32 s20, s20, s12
    s_lshl_b32 s21, s20, 7
    v_add_u32 v4, s21, v4
    v_lshl_add_u32 v12, v172, 7, v12
    v_lshl_add_u32 v12, v171, 2, v12
    s_lshr_b32 s21, s20, 1
    s_lshl_b32 s21, s21, 8
    s_and_b32 s20, s20, 1
    s_lshl_b32 s20, s20, 3
    s_add_u32 s21, s21, s20
    v_add_u32 v12, s21, v12
    v_and_b32 v13, 3, v14
    s_lshl_b32 s20, s12, 2
    v_add_u32 v13, s20, v13
    v_lshlrev_b32 v13, 7, v13
    v_mov_b32 v5, -1
    v_cmp_eq_u32 vcc, 0, v0
    v_mov_b32 v14, 0x7f000000
    v_mov_b32 v15, 1
    v_cndmask_b32 v14, v14, 0, vcc
    s_lshl_b32 s32, s14, 15
    s_add_u32 s32, s32, 119013376
    s_lshl_b32 s33, s14, 16
    s_add_u32 s33, s33, 119078912
    s_lshl_b32 s20, s14, 6
    s_lshl_b32 s40, s20, 13
    s_add_u32 s40, s40, 119218176
    s_mov_b32 s29, 125566976
    s_mul_i32 s26, s20, 458752
    s_mul_i32 s21, s12, 112
    s_lshl_b32 s28, s15, 1
    s_add_u32 s21, s21, s28
    s_lshl_b32 s21, s21, 10
    s_add_u32 s26, s26, s21
    s_add_u32 s26, s26, 40370176
    s_mul_i32 s30, s20, 114688
    s_mul_i32 s21, s12, 28
    s_add_u32 s21, s21, s28
    s_lshl_b32 s21, s21, 10
    s_add_u32 s30, s30, s21
    s_add_u32 s41, s30, 99090432
    s_mov_b32 s30, 125566976
    s_mul_i32 s27, s20, 2048
    s_add_u32 s35, s27, 122753024
    s_add_u32 s27, s27, 121835520
    s_lshl_b32 s21, s15, 7
    s_add_u32 s35, s35, s21
    s_mov_b32 s31, 125566976
    s_mov_b32 s17, 0
    s_mov_b32 s24, s32
    s_mov_b32 s25, s33
    s_add_u32 s34, s32, 24576
    v_mov_b32 v168, 0
    v_lshlrev_b32 v16, 7, v0
    s_mov_b32 s20, 125698048
Lwd_71:
    buffer_load_dwordx2 v[18:19], v16, s[8:11], s20 offen offset:0 sc1
    s_sub_u32 s18, s18, 1
    s_cbranch_scc1 interleave_layers__memory_aug_recurrent_mem_tr__glu_gated_glu__prompt_kernel_exit
    s_waitcnt vmcnt(0)
    v_xor_b32 v18, s78, v18
    v_xor_b32 v19, s79, v19
    v_or_b32 v18, v18, v19
    v_cmp_ne_u32 vcc, 0, v18
    s_cbranch_vccz Lwdok_72
    s_sleep 2
    s_branch Lwd_71
Lwdok_72:
    s_barrier
    v_and_b32 v160, 7, v0
    v_lshlrev_b32 v160, 7, v160
    s_mov_b32 s21, 125730816
Lcm_73:
    buffer_load_dword v161, v160, s[8:11], s21 offen sc1
    s_sub_u32 s18, s18, 1
    s_cbranch_scc1 interleave_layers__memory_aug_recurrent_mem_tr__glu_gated_glu__prompt_kernel_exit
    s_waitcnt vmcnt(0)
    s_lshr_b32 s23, s13, 5
    s_nop 3
    v_readlane_b32 s22, v161, s23
    s_cmp_ge_u32 s22, 30
    s_cbranch_scc1 Lcmd_74
    s_mov_b32 s23, 0
    v_readlane_b32 s22, v161, 0
    s_add_u32 s23, s23, s22
    v_readlane_b32 s22, v161, 1
    s_add_u32 s23, s23, s22
    v_readlane_b32 s22, v161, 2
    s_add_u32 s23, s23, s22
    v_readlane_b32 s22, v161, 3
    s_add_u32 s23, s23, s22
    v_readlane_b32 s22, v161, 4
    s_add_u32 s23, s23, s22
    v_readlane_b32 s22, v161, 5
    s_add_u32 s23, s23, s22
    v_readlane_b32 s22, v161, 6
    s_add_u32 s23, s23, s22
    v_readlane_b32 s22, v161, 7
    s_add_u32 s23, s23, s22
    s_cmp_lt_u32 s23, 256
    s_cbranch_scc1 Lcm_73
    s_mov_b32 s16, 0
Lcmd_74:
    s_lshl_b32 s45, s14, 7
    s_add_u32 s45, s45, 121833472
    v_lshrrev_b32 v175, 5, v13
    s_mov_b32 s44, 125566976
    s_mov_b32 s43, 0
    s_mov_b32 s28, 0x7f000000
    s_mov_b32 s56, s4
    s_mov_b32 s57, s5
    s_mov_b32 s58, 0
    s_mov_b32 s59, 0x20000
    s_cmp_eq_u32 s16, 1
    s_cbranch_scc0 Lvslow_75
Lv_76:
    v_cmp_eq_u32 vcc, 0, v168
    s_mov_b32 s42, s27
    s_cbranch_vccz Lv_76_f
    buffer_load_dword v168, v13, s[8:11], s27 offen sc1
Lv_76_f:
    s_add_u32 s36, s26, 0
    s_add_u32 s37, s26, 28672
    s_add_u32 s38, s26, 57344
    s_add_u32 s39, s26, 86016
    v_mov_b64 v[44:45], 0
    v_mov_b64 v[46:47], 0
    v_mov_b64 v[48:49], 0
    v_mov_b64 v[50:51], 0
    v_mov_b64 v[52:53], 0
    v_mov_b64 v[54:55], 0
    v_mov_b64 v[56:57], 0
    v_mov_b64 v[58:59], 0
    v_mov_b64 v[60:61], 0
    v_mov_b64 v[62:63], 0
    v_mov_b64 v[64:65], 0
    v_mov_b64 v[66:67], 0
    v_mov_b64 v[68:69], 0
    v_mov_b64 v[70:71], 0
    v_mov_b64 v[72:73], 0
    v_mov_b64 v[74:75], 0
    buffer_load_dwordx4 v[160:163], v2, s[8:11], s24 offen sc1
    buffer_load_dwordx4 v[164:167], v3, s[8:11], s24 offen sc1
    s_sleep 2
Lpm_79:
    buffer_load_dwordx4 v[16:19], v2, s[8:11], s24 offen sc1
    buffer_load_dwordx4 v[20:23], v3, s[8:11], s24 offen sc1
    s_waitcnt vmcnt(2)
    v_max3_u32 v170, v160, v161, v162
    v_max3_u32 v171, v163, v164, v165
    v_max3_u32 v170, v170, v166, v167
    v_max_u32 v170, v170, v171
    v_cmp_eq_u32 vcc, -1, v170
    ds_write_b128 v2, v[160:163] offset:0
    ds_write_b128 v3, v[164:167] offset:0
    s_cbranch_vccz Lpmok_80
    buffer_load_dwordx4 v[160:163], v2, s[8:11], s24 offen sc1
    buffer_load_dwordx4 v[164:167], v3, s[8:11], s24 offen sc1
    s_sub_u32 s18, s18, 1
    s_cbranch_scc1 interleave_layers__memory_aug_recurrent_mem_tr__glu_gated_glu__prompt_kernel_exit
    s_waitcnt vmcnt(2)
    v_max3_u32 v170, v16, v17, v18
    v_max3_u32 v171, v19, v20, v21
    v_max3_u32 v170, v170, v22, v23
    v_max_u32 v170, v170, v171
    v_cmp_eq_u32 vcc, -1, v170
    ds_write_b128 v2, v[16:19] offset:0
    ds_write_b128 v3, v[20:23] offset:0
    s_cbranch_vccnz Lpm_79
Lpmok_80:
    v_cmp_eq_u32 vcc, 0, v168
    s_nop 0
    s_cmp_eq_u64 vcc, 0
    s_cselect_b32 s58, 0x10000000, 0
    buffer_load_dwordx4 v[92:95], v1, s[56:59], s36 offen offset:0 sc1
    buffer_load_dwordx4 v[96:99], v1, s[56:59], s36 offen offset:1024 sc1
    buffer_load_dwordx4 v[100:103], v1, s[56:59], s37 offen offset:0 sc1
    buffer_load_dwordx4 v[104:107], v1, s[56:59], s37 offen offset:1024 sc1
    buffer_store_dword v172, v4, s[8:11], s29 offen sc1
    buffer_store_dwordx4 v[136:139], v1, s[8:11], s30 offen sc1
    buffer_store_dwordx4 v[140:143], v1, s[8:11], s30 offen offset:1024 sc1
    s_cmp_eq_u64 vcc, 0
    s_cselect_b32 s58, 0x10000000, 0
    s_mov_b32 s30, s41
    s_add_u32 s41, s41, 114688
    s_add_u32 s26, s26, 458752
    s_add_u32 s27, s27, 2048
    s_waitcnt lgkmcnt(0)
    s_barrier
    s_waitcnt vmcnt(7)
    ds_read_b128 v[16:19], v1 offset:0
    ds_read_b128 v[20:23], v1 offset:1024
    ds_read_b128 v[24:27], v1 offset:2048
    ds_read_b128 v[28:31], v1 offset:3072
    ds_read_b128 v[32:35], v1 offset:4096
    ds_read_b128 v[36:39], v1 offset:5120
    ds_read_b128 v[40:43], v1 offset:6144
    ds_read_b128 v[76:79], v7 offset:0
    ds_read_b128 v[80:83], v7 offset:1024
    ds_read_b128 v[84:87], v7 offset:2048
    ds_read_b128 v[88:91], v7 offset:3072
    s_waitcnt lgkmcnt(4)
    v_smfmac_f32_16x16x64_bf16 v[44:47], v[16:19], a[0:7], v6
    v_smfmac_f32_16x16x64_bf16 v[44:47], v[20:23], a[8:15], v6
    v_smfmac_f32_16x16x64_bf16 v[44:47], v[24:27], a[16:23], v6
    s_waitcnt lgkmcnt(2)
    v_smfmac_f32_16x16x64_bf16 v[68:71], v[16:19], v[76:83], v6
    buffer_load_dword v168, v13, s[8:11], s27 offen sc1
    v_smfmac_f32_16x16x64_bf16 v[44:47], v[28:31], a[24:31], v6
    ds_read_b128 v[76:79], v7 offset:4096
    v_smfmac_f32_16x16x64_bf16 v[44:47], v[32:35], a[32:39], v6
    ds_read_b128 v[80:83], v7 offset:5120
    v_smfmac_f32_16x16x64_bf16 v[44:47], v[36:39], a[40:47], v6
    s_waitcnt lgkmcnt(2)
    v_smfmac_f32_16x16x64_bf16 v[68:71], v[20:23], v[84:91], v6
    buffer_load_dwordx4 v[108:111], v1, s[56:59], s38 offen offset:0 sc1
    v_smfmac_f32_16x16x64_bf16 v[44:47], v[40:43], a[48:55], v6
    ds_read_b128 v[84:87], v7 offset:6144
    v_smfmac_f32_16x16x64_bf16 v[48:51], v[16:19], a[56:63], v6
    ds_read_b128 v[88:91], v7 offset:7168
    v_smfmac_f32_16x16x64_bf16 v[48:51], v[20:23], a[64:71], v6
    s_waitcnt lgkmcnt(2)
    v_smfmac_f32_16x16x64_bf16 v[68:71], v[24:27], v[76:83], v6
    buffer_load_dwordx4 v[112:115], v1, s[56:59], s38 offen offset:1024 sc1
    v_smfmac_f32_16x16x64_bf16 v[48:51], v[24:27], a[72:79], v6
    ds_read_b128 v[76:79], v7 offset:8192
    v_smfmac_f32_16x16x64_bf16 v[48:51], v[28:31], a[80:87], v6
    ds_read_b128 v[80:83], v7 offset:9216
    v_smfmac_f32_16x16x64_bf16 v[48:51], v[32:35], a[88:95], v6
    s_waitcnt lgkmcnt(2)
    v_smfmac_f32_16x16x64_bf16 v[68:71], v[28:31], v[84:91], v6
    buffer_load_dwordx4 v[116:119], v1, s[56:59], s39 offen offset:0 sc1
    v_smfmac_f32_16x16x64_bf16 v[48:51], v[36:39], a[96:103], v6
    ds_read_b128 v[84:87], v7 offset:10240
    v_smfmac_f32_16x16x64_bf16 v[48:51], v[40:43], a[104:111], v6
    ds_read_b128 v[88:91], v7 offset:11264
    v_smfmac_f32_16x16x64_bf16 v[52:55], v[16:19], a[112:119], v6
    s_waitcnt lgkmcnt(2)
    v_smfmac_f32_16x16x64_bf16 v[68:71], v[32:35], v[76:83], v6
    buffer_load_dwordx4 v[120:123], v1, s[56:59], s39 offen offset:1024 sc1
    v_smfmac_f32_16x16x64_bf16 v[52:55], v[20:23], a[120:127], v6
    ds_read_b128 v[76:79], v7 offset:12288
    v_smfmac_f32_16x16x64_bf16 v[52:55], v[24:27], a[128:135], v6
    ds_read_b128 v[80:83], v7 offset:13312
    v_smfmac_f32_16x16x64_bf16 v[52:55], v[28:31], a[136:143], v6
    s_waitcnt lgkmcnt(2)
    v_smfmac_f32_16x16x64_bf16 v[68:71], v[36:39], v[84:91], v6
    buffer_store_dword v5, v12, s[8:11], s34 offen
    v_smfmac_f32_16x16x64_bf16 v[52:55], v[32:35], a[144:151], v6
    ds_read_b128 v[84:87], v7 offset:14336
    v_smfmac_f32_16x16x64_bf16 v[52:55], v[36:39], a[152:159], v6
    ds_read_b128 v[88:91], v7 offset:15360
    v_smfmac_f32_16x16x64_bf16 v[52:55], v[40:43], a[160:167], v6
    s_waitcnt lgkmcnt(2)
    v_smfmac_f32_16x16x64_bf16 v[68:71], v[40:43], v[76:83], v6
    v_smfmac_f32_16x16x64_bf16 v[56:59], v[16:19], a[168:175], v6
    ds_read_b128 v[76:79], v7 offset:16384
    v_smfmac_f32_16x16x64_bf16 v[56:59], v[20:23], a[176:183], v6
    ds_read_b128 v[80:83], v7 offset:17408
    v_smfmac_f32_16x16x64_bf16 v[56:59], v[24:27], a[184:191], v6
    s_waitcnt lgkmcnt(2)
    v_smfmac_f32_16x16x64_bf16 v[72:75], v[16:19], v[84:91], v6
    v_smfmac_f32_16x16x64_bf16 v[56:59], v[28:31], a[192:199], v6
    ds_read_b128 v[84:87], v7 offset:18432
    v_smfmac_f32_16x16x64_bf16 v[56:59], v[32:35], a[200:207], v6
    ds_read_b128 v[88:91], v7 offset:19456
    v_smfmac_f32_16x16x64_bf16 v[56:59], v[36:39], a[208:215], v6
    s_waitcnt lgkmcnt(2)
    v_smfmac_f32_16x16x64_bf16 v[72:75], v[20:23], v[76:83], v6
    v_smfmac_f32_16x16x64_bf16 v[56:59], v[40:43], a[216:223], v6
    ds_read_b128 v[76:79], v7 offset:20480
    v_smfmac_f32_16x16x64_bf16 v[60:63], v[16:19], a[224:231], v6
    ds_read_b128 v[80:83], v7 offset:21504
    v_smfmac_f32_16x16x64_bf16 v[60:63], v[20:23], a[232:239], v6
    s_waitcnt lgkmcnt(2)
    v_smfmac_f32_16x16x64_bf16 v[72:75], v[24:27], v[84:91], v6
    s_waitcnt vmcnt(6)
    s_barrier
    buffer_store_dword v15, v14, s[8:11], s31 offen sc1
    v_smfmac_f32_16x16x64_bf16 v[60:63], v[24:27], a[240:247], v6
    ds_read_b128 v[84:87], v7 offset:22528
    v_smfmac_f32_16x16x64_bf16 v[60:63], v[28:31], a[248:255], v6
    ds_read_b128 v[88:91], v7 offset:23552
    v_smfmac_f32_16x16x64_bf16 v[60:63], v[32:35], v[176:183], v6
    s_waitcnt lgkmcnt(2)
    v_smfmac_f32_16x16x64_bf16 v[72:75], v[28:31], v[76:83], v6
    v_smfmac_f32_16x16x64_bf16 v[60:63], v[36:39], v[184:191], v6
    ds_read_b128 v[76:79], v7 offset:24576
    v_smfmac_f32_16x16x64_bf16 v[60:63], v[40:43], v[192:199], v6
    ds_read_b128 v[80:83], v7 offset:25600
    v_smfmac_f32_16x16x64_bf16 v[64:67], v[16:19], v[200:207], v6
    s_waitcnt lgkmcnt(2)
    v_smfmac_f32_16x16x64_bf16 v[72:75], v[32:35], v[84:91], v6
    v_smfmac_f32_16x16x64_bf16 v[64:67], v[20:23], v[208:215], v6
    ds_read_b128 v[84:87], v7 offset:26624
    v_smfmac_f32_16x16x64_bf16 v[64:67], v[24:27], v[216:223], v6
    ds_read_b128 v[88:91], v7 offset:27648
    v_smfmac_f32_16x16x64_bf16 v[64:67], v[28:31], v[224:231], v6
    s_waitcnt lgkmcnt(2)
    v_smfmac_f32_16x16x64_bf16 v[72:75], v[36:39], v[76:83], v6
    v_smfmac_f32_16x16x64_bf16 v[64:67], v[32:35], v[232:239], v6
    v_smfmac_f32_16x16x64_bf16 v[64:67], v[36:39], v[240:247], v6
    v_smfmac_f32_16x16x64_bf16 v[64:67], v[40:43], v[248:255], v6
    s_waitcnt lgkmcnt(0)
    v_smfmac_f32_16x16x64_bf16 v[72:75], v[40:43], v[84:91], v6
    s_mov_b32 s34, s24
    s_mov_b32 s44, s31
    s_mov_b32 s31, s35
    s_add_u32 s35, s35, 2048
    s_nop 0
    s_add_u32 s24, s17, 1
    s_and_b32 s24, s24, 3
    s_lshl_b32 s24, s24, 13
    s_add_u32 s24, s24, s32
    v_permlane32_swap_b32 v44, v60
    v_permlane32_swap_b32 v45, v61
    v_permlane32_swap_b32 v46, v62
    v_permlane32_swap_b32 v47, v63
    v_add_f32 v44, v44, v60
    v_add_f32 v45, v45, v61
    v_add_f32 v46, v46, v62
    v_add_f32 v47, v47, v63
    v_cvt_pk_bf16_f32 v136, v44, v45
    v_cvt_pk_bf16_f32 v137, v46, v47
    v_permlane32_swap_b32 v52, v68
    v_permlane32_swap_b32 v53, v69
    v_permlane32_swap_b32 v54, v70
    v_permlane32_swap_b32 v55, v71
    v_add_f32 v52, v52, v68
    v_add_f32 v53, v53, v69
    v_add_f32 v54, v54, v70
    v_add_f32 v55, v55, v71
    v_cvt_pk_bf16_f32 v138, v52, v53
    v_cvt_pk_bf16_f32 v139, v54, v55
    v_permlane32_swap_b32 v48, v64
    v_permlane32_swap_b32 v49, v65
    v_permlane32_swap_b32 v50, v66
    v_permlane32_swap_b32 v51, v67
    v_add_f32 v48, v48, v64
    v_add_f32 v49, v49, v65
    v_add_f32 v50, v50, v66
    v_add_f32 v51, v51, v67
    v_cvt_pk_bf16_f32 v140, v48, v49
    v_cvt_pk_bf16_f32 v141, v50, v51
    v_permlane32_swap_b32 v56, v72
    v_permlane32_swap_b32 v57, v73
    v_permlane32_swap_b32 v58, v74
    v_permlane32_swap_b32 v59, v75
    v_add_f32 v56, v56, v72
    v_add_f32 v57, v57, v73
    v_add_f32 v58, v58, v74
    v_add_f32 v59, v59, v75
    v_cvt_pk_bf16_f32 v142, v56, v57
    v_cvt_pk_bf16_f32 v143, v58, v59
    s_cmp_ge_u32 s17, 63
    s_cbranch_scc1 Lvlast_77
    s_cmp_lg_u32 s58, 0
    s_cbranch_scc1 Lvf_78
Lwf_81:
    buffer_load_dword v173, v13, s[8:11], s42 offen sc1
    s_sub_u32 s18, s18, 1
    s_cbranch_scc1 interleave_layers__memory_aug_recurrent_mem_tr__glu_gated_glu__prompt_kernel_exit
    s_waitcnt vmcnt(0)
    v_cmp_eq_u32 vcc, 0, v173
    s_cbranch_vccz Lwfok_82
    s_sleep 2
    s_branch Lwf_81
Lwfok_82:
    buffer_load_dwordx4 v[92:95], v1, s[8:11], s36 offen offset:0 sc1
    buffer_load_dwordx4 v[96:99], v1, s[8:11], s36 offen offset:1024 sc1
    buffer_load_dwordx4 v[100:103], v1, s[8:11], s37 offen offset:0 sc1
    buffer_load_dwordx4 v[104:107], v1, s[8:11], s37 offen offset:1024 sc1
    buffer_load_dwordx4 v[108:111], v1, s[8:11], s38 offen offset:0 sc1
    buffer_load_dwordx4 v[112:115], v1, s[8:11], s38 offen offset:1024 sc1
    buffer_load_dwordx4 v[116:119], v1, s[8:11], s39 offen offset:0 sc1
    buffer_load_dwordx4 v[120:123], v1, s[8:11], s39 offen offset:1024 sc1
Lvf_78:
    s_sleep 2
    buffer_load_dwordx4 v[124:127], v8, s[8:11], s25 offen sc1
    buffer_load_dwordx4 v[128:131], v8, s[8:11], s25 offen offset:1024 sc1
    buffer_load_dwordx4 v[132:135], v9, s[8:11], s25 offen sc1
    s_sleep 2
Lpp_83:
    buffer_load_dwordx4 v[16:19], v8, s[8:11], s25 offen sc1
    buffer_load_dwordx4 v[20:23], v8, s[8:11], s25 offen offset:1024 sc1
    buffer_load_dwordx4 v[24:27], v9, s[8:11], s25 offen sc1
    s_waitcnt vmcnt(5)
    v_mfma_f32_16x16x32_bf16 v[144:147], v[92:95], v[124:127], 0
    v_max3_u32 v170, v124, v125, v126
    v_mfma_f32_16x16x32_bf16 v[148:151], v[100:103], v[124:127], 0
    v_mfma_f32_16x16x32_bf16 v[152:155], v[96:99], v[124:127], 0
    v_mfma_f32_16x16x32_bf16 v[156:159], v[104:107], v[124:127], 0
    s_waitcnt vmcnt(4)
    v_mfma_f32_16x16x32_bf16 v[148:151], v[116:119], v[128:131], v[148:151]
    v_max3_u32 v171, v127, v128, v129
    v_mfma_f32_16x16x32_bf16 v[156:159], v[120:123], v[128:131], v[156:159]
    v_max3_u32 v170, v170, v130, v131
    v_mfma_f32_16x16x32_bf16 v[144:147], v[108:111], v[128:131], v[144:147]
    v_mfma_f32_16x16x32_bf16 v[152:155], v[112:115], v[128:131], v[152:155]
    s_waitcnt vmcnt(3)
    v_max3_u32 v171, v171, v132, v133
    v_max3_u32 v170, v170, v134, v135
    v_max_u32 v170, v170, v171
    v_cmp_eq_u32 vcc, -1, v170
    v_mfma_f32_16x16x32_bf16 v[144:147], v[136:139], v[132:135], v[144:147]
    v_mfma_f32_16x16x32_bf16 v[152:155], v[140:143], v[132:135], v[152:155]
    s_cbranch_vccz LuJ_86
    buffer_load_dwordx4 v[124:127], v8, s[8:11], s25 offen sc1
    buffer_load_dwordx4 v[128:131], v8, s[8:11], s25 offen offset:1024 sc1
    buffer_load_dwordx4 v[132:135], v9, s[8:11], s25 offen sc1
    s_sub_u32 s18, s18, 1
    s_cbranch_scc1 interleave_layers__memory_aug_recurrent_mem_tr__glu_gated_glu__prompt_kernel_exit
    s_waitcnt vmcnt(5)
    v_mfma_f32_16x16x32_bf16 v[144:147], v[92:95], v[16:19], 0
    v_max3_u32 v170, v16, v17, v18
    v_mfma_f32_16x16x32_bf16 v[148:151], v[100:103], v[16:19], 0
    v_mfma_f32_16x16x32_bf16 v[152:155], v[96:99], v[16:19], 0
    v_mfma_f32_16x16x32_bf16 v[156:159], v[104:107], v[16:19], 0
    s_waitcnt vmcnt(4)
    v_mfma_f32_16x16x32_bf16 v[148:151], v[116:119], v[20:23], v[148:151]
    v_max3_u32 v171, v19, v20, v21
    v_mfma_f32_16x16x32_bf16 v[156:159], v[120:123], v[20:23], v[156:159]
    v_max3_u32 v170, v170, v22, v23
    v_mfma_f32_16x16x32_bf16 v[144:147], v[108:111], v[20:23], v[144:147]
    v_mfma_f32_16x16x32_bf16 v[152:155], v[112:115], v[20:23], v[152:155]
    s_waitcnt vmcnt(3)
    v_max3_u32 v171, v171, v24, v25
    v_max3_u32 v170, v170, v26, v27
    v_max_u32 v170, v170, v171
    v_cmp_eq_u32 vcc, -1, v170
    v_mfma_f32_16x16x32_bf16 v[144:147], v[136:139], v[24:27], v[144:147]
    v_mfma_f32_16x16x32_bf16 v[152:155], v[140:143], v[24:27], v[152:155]
    s_cbranch_vccnz Lpp_83
LuJ_86:
    s_nop 5
    v_add_f32_dpp v48, v148, v144 row_ror:8 row_mask:0xf bank_mask:0x3
    v_add_f32_dpp v49, v149, v145 row_ror:8 row_mask:0xf bank_mask:0x3
    v_add_f32_dpp v50, v150, v146 row_ror:8 row_mask:0xf bank_mask:0x3
    v_add_f32_dpp v51, v151, v147 row_ror:8 row_mask:0xf bank_mask:0x3
    v_add_f32_dpp v48, v152, v156 row_ror:8 row_mask:0xf bank_mask:0xc
    v_add_f32_dpp v49, v153, v157 row_ror:8 row_mask:0xf bank_mask:0xc
    v_add_f32_dpp v50, v154, v158 row_ror:8 row_mask:0xf bank_mask:0xc
    v_add_f32_dpp v51, v155, v159 row_ror:8 row_mask:0xf bank_mask:0xc
    ds_write_b128 v10, v[48:51]
    s_add_u32 s17, s17, 1
    s_waitcnt lgkmcnt(0)
    s_barrier
    ds_read_b128 v[44:47], v11
    s_waitcnt lgkmcnt(0)
    v_permlane32_swap_b32 v44, v46
    v_permlane32_swap_b32 v45, v47
    v_add_f32 v44, v44, v46
    v_add_f32 v45, v45, v47
    s_nop 1
    v_permlane16_swap_b32 v44, v45
    v_add_f32 v44, v44, v45
    v_mov_b32 v45, v44
    s_nop 1
    v_permlane16_swap_b32 v44, v45
    v_cvt_pk_bf16_f32 v172, v44, v45
    v_min_u32 v172, 0xfffffffe, v172
    buffer_store_dword v172, v12, s[8:11], s24 offen
    s_mov_b32 s29, s40
    s_add_u32 s40, s40, 8192
    s_add_u32 s25, s17, 0
    s_and_b32 s25, s25, 3
    s_lshl_b32 s25, s25, 14
    s_add_u32 s25, s25, s33
    s_branch Lv_76
Lvlast_77:
    buffer_store_dwordx4 v[136:139], v1, s[8:11], s30 offen sc1
    buffer_store_dwordx4 v[140:143], v1, s[8:11], s30 offen offset:1024 sc1
    s_waitcnt vmcnt(0)
    s_barrier
    buffer_store_dword v15, v14, s[8:11], s31 offen sc1
    buffer_store_dword v15, v14, s[8:11], s44 offen sc1
    s_branch Ldone_60
Lvslow_75:
Lv_87:
    v_cmp_eq_u32 vcc, 0, v168
    s_mov_b32 s42, s27
    s_cbranch_vccz Lv_87_f
    buffer_load_dword v168, v13, s[8:11], s27 offen sc1
Lv_87_f:
    s_add_u32 s36, s26, 0
    s_add_u32 s37, s26, 28672
    s_add_u32 s38, s26, 57344
    s_add_u32 s39, s26, 86016
    v_mov_b64 v[44:45], 0
    v_mov_b64 v[46:47], 0
    v_mov_b64 v[48:49], 0
    v_mov_b64 v[50:51], 0
    v_mov_b64 v[52:53], 0
    v_mov_b64 v[54:55], 0
    v_mov_b64 v[56:57], 0
    v_mov_b64 v[58:59], 0
    v_mov_b64 v[60:61], 0
    v_mov_b64 v[62:63], 0
    v_mov_b64 v[64:65], 0
    v_mov_b64 v[66:67], 0
    v_mov_b64 v[68:69], 0
    v_mov_b64 v[70:71], 0
    v_mov_b64 v[72:73], 0
    v_mov_b64 v[74:75], 0
    buffer_load_dwordx4 v[160:163], v2, s[8:11], s24 offen sc1
    buffer_load_dwordx4 v[164:167], v3, s[8:11], s24 offen sc1
    s_sleep 2
Lpm_90:
    buffer_load_dwordx4 v[16:19], v2, s[8:11], s24 offen sc1
    buffer_load_dwordx4 v[20:23], v3, s[8:11], s24 offen sc1
    s_waitcnt vmcnt(2)
    v_max3_u32 v170, v160, v161, v162
    v_max3_u32 v171, v163, v164, v165
    v_max3_u32 v170, v170, v166, v167
    v_max_u32 v170, v170, v171
    v_cmp_eq_u32 vcc, -1, v170
    ds_write_b128 v2, v[160:163] offset:0
    ds_write_b128 v3, v[164:167] offset:0
    s_cbranch_vccz Lpmok_91
    buffer_load_dwordx4 v[160:163], v2, s[8:11], s24 offen sc1
    buffer_load_dwordx4 v[164:167], v3, s[8:11], s24 offen sc1
    s_sub_u32 s18, s18, 1
    s_cbranch_scc1 interleave_layers__memory_aug_recurrent_mem_tr__glu_gated_glu__prompt_kernel_exit
    s_waitcnt vmcnt(2)
    v_max3_u32 v170, v16, v17, v18
    v_max3_u32 v171, v19, v20, v21
    v_max3_u32 v170, v170, v22, v23
    v_max_u32 v170, v170, v171
    v_cmp_eq_u32 vcc, -1, v170
    ds_write_b128 v2, v[16:19] offset:0
    ds_write_b128 v3, v[20:23] offset:0
    s_cbranch_vccnz Lpm_90
Lpmok_91:
    v_cmp_eq_u32 vcc, 0, v168
    s_nop 0
    s_cmp_eq_u64 vcc, 0
    s_cselect_b32 s58, 0x10000000, 0
    buffer_load_dwordx4 v[92:95], v1, s[56:59], s36 offen offset:0 sc1
    buffer_load_dwordx4 v[96:99], v1, s[56:59], s36 offen offset:1024 sc1
    buffer_load_dwordx4 v[100:103], v1, s[56:59], s37 offen offset:0 sc1
    buffer_load_dwordx4 v[104:107], v1, s[56:59], s37 offen offset:1024 sc1
    buffer_store_dword v172, v4, s[8:11], s29 offen sc1
    buffer_store_dwordx4 v[136:139], v1, s[8:11], s30 offen sc1
    buffer_store_dwordx4 v[140:143], v1, s[8:11], s30 offen offset:1024 sc1
    s_cmp_eq_u64 vcc, 0
    s_cselect_b32 s58, 0x10000000, 0
    s_mov_b32 s30, s41
    s_add_u32 s41, s41, 114688
    s_add_u32 s26, s26, 458752
    s_add_u32 s27, s27, 2048
    s_waitcnt lgkmcnt(0)
    s_barrier
    s_waitcnt vmcnt(7)
    ds_read_b128 v[16:19], v1 offset:0
    ds_read_b128 v[20:23], v1 offset:1024
    ds_read_b128 v[24:27], v1 offset:2048
    ds_read_b128 v[28:31], v1 offset:3072
    ds_read_b128 v[32:35], v1 offset:4096
    ds_read_b128 v[36:39], v1 offset:5120
    ds_read_b128 v[40:43], v1 offset:6144
    ds_read_b128 v[76:79], v7 offset:0
    ds_read_b128 v[80:83], v7 offset:1024
    ds_read_b128 v[84:87], v7 offset:2048
    ds_read_b128 v[88:91], v7 offset:3072
    s_waitcnt lgkmcnt(4)
    v_smfmac_f32_16x16x64_bf16 v[44:47], v[16:19], a[0:7], v6
    v_smfmac_f32_16x16x64_bf16 v[44:47], v[20:23], a[8:15], v6
    v_smfmac_f32_16x16x64_bf16 v[44:47], v[24:27], a[16:23], v6
    s_waitcnt lgkmcnt(2)
    v_smfmac_f32_16x16x64_bf16 v[68:71], v[16:19], v[76:83], v6
    buffer_load_dword v168, v13, s[8:11], s27 offen sc1
    v_smfmac_f32_16x16x64_bf16 v[44:47], v[28:31], a[24:31], v6
    ds_read_b128 v[76:79], v7 offset:4096
    v_smfmac_f32_16x16x64_bf16 v[44:47], v[32:35], a[32:39], v6
    ds_read_b128 v[80:83], v7 offset:5120
    v_smfmac_f32_16x16x64_bf16 v[44:47], v[36:39], a[40:47], v6
    s_waitcnt lgkmcnt(2)
    v_smfmac_f32_16x16x64_bf16 v[68:71], v[20:23], v[84:91], v6
    buffer_load_dwordx4 v[108:111], v1, s[56:59], s38 offen offset:0 sc1
    v_smfmac_f32_16x16x64_bf16 v[44:47], v[40:43], a[48:55], v6
    ds_read_b128 v[84:87], v7 offset:6144
    v_smfmac_f32_16x16x64_bf16 v[48:51], v[16:19], a[56:63], v6
    ds_read_b128 v[88:91], v7 offset:7168
    v_smfmac_f32_16x16x64_bf16 v[48:51], v[20:23], a[64:71], v6
    s_waitcnt lgkmcnt(2)
    v_smfmac_f32_16x16x64_bf16 v[68:71], v[24:27], v[76:83], v6
    buffer_load_dwordx4 v[112:115], v1, s[56:59], s38 offen offset:1024 sc1
    v_smfmac_f32_16x16x64_bf16 v[48:51], v[24:27], a[72:79], v6
    ds_read_b128 v[76:79], v7 offset:8192
    v_smfmac_f32_16x16x64_bf16 v[48:51], v[28:31], a[80:87], v6
    ds_read_b128 v[80:83], v7 offset:9216
    v_smfmac_f32_16x16x64_bf16 v[48:51], v[32:35], a[88:95], v6
    s_waitcnt lgkmcnt(2)
    v_smfmac_f32_16x16x64_bf16 v[68:71], v[28:31], v[84:91], v6
    buffer_load_dwordx4 v[116:119], v1, s[56:59], s39 offen offset:0 sc1
    v_smfmac_f32_16x16x64_bf16 v[48:51], v[36:39], a[96:103], v6
    ds_read_b128 v[84:87], v7 offset:10240
    v_smfmac_f32_16x16x64_bf16 v[48:51], v[40:43], a[104:111], v6
    ds_read_b128 v[88:91], v7 offset:11264
    v_smfmac_f32_16x16x64_bf16 v[52:55], v[16:19], a[112:119], v6
    s_waitcnt lgkmcnt(2)
    v_smfmac_f32_16x16x64_bf16 v[68:71], v[32:35], v[76:83], v6
    buffer_load_dwordx4 v[120:123], v1, s[56:59], s39 offen offset:1024 sc1
    v_smfmac_f32_16x16x64_bf16 v[52:55], v[20:23], a[120:127], v6
    ds_read_b128 v[76:79], v7 offset:12288
    v_smfmac_f32_16x16x64_bf16 v[52:55], v[24:27], a[128:135], v6
    ds_read_b128 v[80:83], v7 offset:13312
    v_smfmac_f32_16x16x64_bf16 v[52:55], v[28:31], a[136:143], v6
    s_waitcnt lgkmcnt(2)
    v_smfmac_f32_16x16x64_bf16 v[68:71], v[36:39], v[84:91], v6
    buffer_store_dword v5, v12, s[8:11], s34 offen sc1
    v_smfmac_f32_16x16x64_bf16 v[52:55], v[32:35], a[144:151], v6
    ds_read_b128 v[84:87], v7 offset:14336
    v_smfmac_f32_16x16x64_bf16 v[52:55], v[36:39], a[152:159], v6
    ds_read_b128 v[88:91], v7 offset:15360
    v_smfmac_f32_16x16x64_bf16 v[52:55], v[40:43], a[160:167], v6
    s_waitcnt lgkmcnt(2)
    v_smfmac_f32_16x16x64_bf16 v[68:71], v[40:43], v[76:83], v6
    v_smfmac_f32_16x16x64_bf16 v[56:59], v[16:19], a[168:175], v6
    ds_read_b128 v[76:79], v7 offset:16384
    v_smfmac_f32_16x16x64_bf16 v[56:59], v[20:23], a[176:183], v6
    ds_read_b128 v[80:83], v7 offset:17408
    v_smfmac_f32_16x16x64_bf16 v[56:59], v[24:27], a[184:191], v6
    s_waitcnt lgkmcnt(2)
    v_smfmac_f32_16x16x64_bf16 v[72:75], v[16:19], v[84:91], v6
    v_smfmac_f32_16x16x64_bf16 v[56:59], v[28:31], a[192:199], v6
    ds_read_b128 v[84:87], v7 offset:18432
    v_smfmac_f32_16x16x64_bf16 v[56:59], v[32:35], a[200:207], v6
    ds_read_b128 v[88:91], v7 offset:19456
    v_smfmac_f32_16x16x64_bf16 v[56:59], v[36:39], a[208:215], v6
    s_waitcnt lgkmcnt(2)
    v_smfmac_f32_16x16x64_bf16 v[72:75], v[20:23], v[76:83], v6
    v_smfmac_f32_16x16x64_bf16 v[56:59], v[40:43], a[216:223], v6
    ds_read_b128 v[76:79], v7 offset:20480
    v_smfmac_f32_16x16x64_bf16 v[60:63], v[16:19], a[224:231], v6
    ds_read_b128 v[80:83], v7 offset:21504
    v_smfmac_f32_16x16x64_bf16 v[60:63], v[20:23], a[232:239], v6
    s_waitcnt lgkmcnt(2)
    v_smfmac_f32_16x16x64_bf16 v[72:75], v[24:27], v[84:91], v6
    s_waitcnt vmcnt(6)
    s_barrier
    buffer_store_dword v15, v14, s[8:11], s31 offen sc1
    v_smfmac_f32_16x16x64_bf16 v[60:63], v[24:27], a[240:247], v6
    ds_read_b128 v[84:87], v7 offset:22528
    v_smfmac_f32_16x16x64_bf16 v[60:63], v[28:31], a[248:255], v6
    ds_read_b128 v[88:91], v7 offset:23552
    v_smfmac_f32_16x16x64_bf16 v[60:63], v[32:35], v[176:183], v6
    s_waitcnt lgkmcnt(2)
    v_smfmac_f32_16x16x64_bf16 v[72:75], v[28:31], v[76:83], v6
    v_smfmac_f32_16x16x64_bf16 v[60:63], v[36:39], v[184:191], v6
    ds_read_b128 v[76:79], v7 offset:24576
    v_smfmac_f32_16x16x64_bf16 v[60:63], v[40:43], v[192:199], v6
    ds_read_b128 v[80:83], v7 offset:25600
    v_smfmac_f32_16x16x64_bf16 v[64:67], v[16:19], v[200:207], v6
    s_waitcnt lgkmcnt(2)
    v_smfmac_f32_16x16x64_bf16 v[72:75], v[32:35], v[84:91], v6
    v_smfmac_f32_16x16x64_bf16 v[64:67], v[20:23], v[208:215], v6
    ds_read_b128 v[84:87], v7 offset:26624
    v_smfmac_f32_16x16x64_bf16 v[64:67], v[24:27], v[216:223], v6
    ds_read_b128 v[88:91], v7 offset:27648
    v_smfmac_f32_16x16x64_bf16 v[64:67], v[28:31], v[224:231], v6
    s_waitcnt lgkmcnt(2)
    v_smfmac_f32_16x16x64_bf16 v[72:75], v[36:39], v[76:83], v6
    v_smfmac_f32_16x16x64_bf16 v[64:67], v[32:35], v[232:239], v6
    v_smfmac_f32_16x16x64_bf16 v[64:67], v[36:39], v[240:247], v6
    v_smfmac_f32_16x16x64_bf16 v[64:67], v[40:43], v[248:255], v6
    s_waitcnt lgkmcnt(0)
    v_smfmac_f32_16x16x64_bf16 v[72:75], v[40:43], v[84:91], v6
    s_mov_b32 s34, s24
    s_mov_b32 s44, s31
    s_mov_b32 s31, s35
    s_add_u32 s35, s35, 2048
    s_nop 0
    s_add_u32 s24, s17, 1
    s_and_b32 s24, s24, 3
    s_lshl_b32 s24, s24, 13
    s_add_u32 s24, s24, s32
    v_permlane32_swap_b32 v44, v60
    v_permlane32_swap_b32 v45, v61
    v_permlane32_swap_b32 v46, v62
    v_permlane32_swap_b32 v47, v63
    v_add_f32 v44, v44, v60
    v_add_f32 v45, v45, v61
    v_add_f32 v46, v46, v62
    v_add_f32 v47, v47, v63
    v_cvt_pk_bf16_f32 v136, v44, v45
    v_cvt_pk_bf16_f32 v137, v46, v47
    v_permlane32_swap_b32 v52, v68
    v_permlane32_swap_b32 v53, v69
    v_permlane32_swap_b32 v54, v70
    v_permlane32_swap_b32 v55, v71
    v_add_f32 v52, v52, v68
    v_add_f32 v53, v53, v69
    v_add_f32 v54, v54, v70
    v_add_f32 v55, v55, v71
    v_cvt_pk_bf16_f32 v138, v52, v53
    v_cvt_pk_bf16_f32 v139, v54, v55
    v_permlane32_swap_b32 v48, v64
    v_permlane32_swap_b32 v49, v65
    v_permlane32_swap_b32 v50, v66
    v_permlane32_swap_b32 v51, v67
    v_add_f32 v48, v48, v64
    v_add_f32 v49, v49, v65
    v_add_f32 v50, v50, v66
    v_add_f32 v51, v51, v67
    v_cvt_pk_bf16_f32 v140, v48, v49
    v_cvt_pk_bf16_f32 v141, v50, v51
    v_permlane32_swap_b32 v56, v72
    v_permlane32_swap_b32 v57, v73
    v_permlane32_swap_b32 v58, v74
    v_permlane32_swap_b32 v59, v75
    v_add_f32 v56, v56, v72
    v_add_f32 v57, v57, v73
    v_add_f32 v58, v58, v74
    v_add_f32 v59, v59, v75
    v_cvt_pk_bf16_f32 v142, v56, v57
    v_cvt_pk_bf16_f32 v143, v58, v59
    s_cmp_ge_u32 s17, 63
    s_cbranch_scc1 Lvlast_88
    s_cmp_lg_u32 s58, 0
    s_cbranch_scc1 Lvf_89
Lwf_92:
    buffer_load_dword v173, v13, s[8:11], s42 offen sc1
    s_sub_u32 s18, s18, 1
    s_cbranch_scc1 interleave_layers__memory_aug_recurrent_mem_tr__glu_gated_glu__prompt_kernel_exit
    s_waitcnt vmcnt(0)
    v_cmp_eq_u32 vcc, 0, v173
    s_cbranch_vccz Lwfok_93
    s_sleep 2
    s_branch Lwf_92
Lwfok_93:
    buffer_load_dwordx4 v[92:95], v1, s[8:11], s36 offen offset:0 sc1
    buffer_load_dwordx4 v[96:99], v1, s[8:11], s36 offen offset:1024 sc1
    buffer_load_dwordx4 v[100:103], v1, s[8:11], s37 offen offset:0 sc1
    buffer_load_dwordx4 v[104:107], v1, s[8:11], s37 offen offset:1024 sc1
    buffer_load_dwordx4 v[108:111], v1, s[8:11], s38 offen offset:0 sc1
    buffer_load_dwordx4 v[112:115], v1, s[8:11], s38 offen offset:1024 sc1
    buffer_load_dwordx4 v[116:119], v1, s[8:11], s39 offen offset:0 sc1
    buffer_load_dwordx4 v[120:123], v1, s[8:11], s39 offen offset:1024 sc1
Lvf_89:
    s_sleep 2
    buffer_load_dwordx4 v[124:127], v8, s[8:11], s25 offen sc1
    buffer_load_dwordx4 v[128:131], v8, s[8:11], s25 offen offset:1024 sc1
    buffer_load_dwordx4 v[132:135], v9, s[8:11], s25 offen sc1
    s_sleep 2
Lpp_94:
    buffer_load_dwordx4 v[16:19], v8, s[8:11], s25 offen sc1
    buffer_load_dwordx4 v[20:23], v8, s[8:11], s25 offen offset:1024 sc1
    buffer_load_dwordx4 v[24:27], v9, s[8:11], s25 offen sc1
    s_waitcnt vmcnt(5)
    v_mfma_f32_16x16x32_bf16 v[144:147], v[92:95], v[124:127], 0
    v_max3_u32 v170, v124, v125, v126
    v_mfma_f32_16x16x32_bf16 v[148:151], v[100:103], v[124:127], 0
    v_mfma_f32_16x16x32_bf16 v[152:155], v[96:99], v[124:127], 0
    v_mfma_f32_16x16x32_bf16 v[156:159], v[104:107], v[124:127], 0
    s_waitcnt vmcnt(4)
    v_mfma_f32_16x16x32_bf16 v[148:151], v[116:119], v[128:131], v[148:151]
    v_max3_u32 v171, v127, v128, v129
    v_mfma_f32_16x16x32_bf16 v[156:159], v[120:123], v[128:131], v[156:159]
    v_max3_u32 v170, v170, v130, v131
    v_mfma_f32_16x16x32_bf16 v[144:147], v[108:111], v[128:131], v[144:147]
    v_mfma_f32_16x16x32_bf16 v[152:155], v[112:115], v[128:131], v[152:155]
    s_waitcnt vmcnt(3)
    v_max3_u32 v171, v171, v132, v133
    v_max3_u32 v170, v170, v134, v135
    v_max_u32 v170, v170, v171
    v_cmp_eq_u32 vcc, -1, v170
    v_mfma_f32_16x16x32_bf16 v[144:147], v[136:139], v[132:135], v[144:147]
    v_mfma_f32_16x16x32_bf16 v[152:155], v[140:143], v[132:135], v[152:155]
    s_cbranch_vccz LuJ_97
    buffer_load_dwordx4 v[124:127], v8, s[8:11], s25 offen sc1
    buffer_load_dwordx4 v[128:131], v8, s[8:11], s25 offen offset:1024 sc1
    buffer_load_dwordx4 v[132:135], v9, s[8:11], s25 offen sc1
    s_sub_u32 s18, s18, 1
    s_cbranch_scc1 interleave_layers__memory_aug_recurrent_mem_tr__glu_gated_glu__prompt_kernel_exit
    s_waitcnt vmcnt(5)
    v_mfma_f32_16x16x32_bf16 v[144:147], v[92:95], v[16:19], 0
    v_max3_u32 v170, v16, v17, v18
    v_mfma_f32_16x16x32_bf16 v[148:151], v[100:103], v[16:19], 0
    v_mfma_f32_16x16x32_bf16 v[152:155], v[96:99], v[16:19], 0
    v_mfma_f32_16x16x32_bf16 v[156:159], v[104:107], v[16:19], 0
    s_waitcnt vmcnt(4)
    v_mfma_f32_16x16x32_bf16 v[148:151], v[116:119], v[20:23], v[148:151]
    v_max3_u32 v171, v19, v20, v21
    v_mfma_f32_16x16x32_bf16 v[156:159], v[120:123], v[20:23], v[156:159]
    v_max3_u32 v170, v170, v22, v23
    v_mfma_f32_16x16x32_bf16 v[144:147], v[108:111], v[20:23], v[144:147]
    v_mfma_f32_16x16x32_bf16 v[152:155], v[112:115], v[20:23], v[152:155]
    s_waitcnt vmcnt(3)
    v_max3_u32 v171, v171, v24, v25
    v_max3_u32 v170, v170, v26, v27
    v_max_u32 v170, v170, v171
    v_cmp_eq_u32 vcc, -1, v170
    v_mfma_f32_16x16x32_bf16 v[144:147], v[136:139], v[24:27], v[144:147]
    v_mfma_f32_16x16x32_bf16 v[152:155], v[140:143], v[24:27], v[152:155]
    s_cbranch_vccnz Lpp_94
LuJ_97:
    s_nop 5
    v_add_f32_dpp v48, v148, v144 row_ror:8 row_mask:0xf bank_mask:0x3
    v_add_f32_dpp v49, v149, v145 row_ror:8 row_mask:0xf bank_mask:0x3
    v_add_f32_dpp v50, v150, v146 row_ror:8 row_mask:0xf bank_mask:0x3
    v_add_f32_dpp v51, v151, v147 row_ror:8 row_mask:0xf bank_mask:0x3
    v_add_f32_dpp v48, v152, v156 row_ror:8 row_mask:0xf bank_mask:0xc
    v_add_f32_dpp v49, v153, v157 row_ror:8 row_mask:0xf bank_mask:0xc
    v_add_f32_dpp v50, v154, v158 row_ror:8 row_mask:0xf bank_mask:0xc
    v_add_f32_dpp v51, v155, v159 row_ror:8 row_mask:0xf bank_mask:0xc
    ds_write_b128 v10, v[48:51]
    s_add_u32 s17, s17, 1
    s_waitcnt lgkmcnt(0)
    s_barrier
    ds_read_b128 v[44:47], v11
    s_waitcnt lgkmcnt(0)
    v_permlane32_swap_b32 v44, v46
    v_permlane32_swap_b32 v45, v47
    v_add_f32 v44, v44, v46
    v_add_f32 v45, v45, v47
    s_nop 1
    v_permlane16_swap_b32 v44, v45
    v_add_f32 v44, v44, v45
    v_mov_b32 v45, v44
    s_nop 1
    v_permlane16_swap_b32 v44, v45
    v_cvt_pk_bf16_f32 v172, v44, v45
    v_min_u32 v172, 0xfffffffe, v172
    buffer_store_dword v172, v12, s[8:11], s24 offen sc1
    s_mov_b32 s29, s40
    s_add_u32 s40, s40, 8192
    s_add_u32 s25, s17, 0
    s_and_b32 s25, s25, 3
    s_lshl_b32 s25, s25, 14
    s_add_u32 s25, s25, s33
    s_branch Lv_87
Lvlast_88:
    buffer_store_dwordx4 v[136:139], v1, s[8:11], s30 offen sc1
    buffer_store_dwordx4 v[140:143], v1, s[8:11], s30 offen offset:1024 sc1
    s_waitcnt vmcnt(0)
    s_barrier
    buffer_store_dword v15, v14, s[8:11], s31 offen sc1
    buffer_store_dword v15, v14, s[8:11], s44 offen sc1
    s_branch Ldone_60
Ldone_60:
    s_branch interleave_layers__memory_aug_recurrent_mem_tr__glu_gated_glu__prompt_kernel_exit
Lrole3_20:
    s_mov_b32 s23, 0
    s_branch Lpwd_98
Lp_from_k:
    s_mov_b32 s19, 3
    s_mov_b32 s23, 1
Lpwd_98:
    v_and_b32 v7, 63, v0
    v_lshlrev_b32 v1, 4, v7
    v_cmp_eq_u32 vcc, 0, v0
    v_mov_b32 v14, 2130706432
    v_mov_b32 v15, 1
    v_cndmask_b32 v14, v14, 0, vcc
    s_cmp_eq_u32 s19, 0
    s_cbranch_scc0 Lsn_100
    s_mov_b32 s70, 32
    s_mov_b32 s71, 0
    s_mov_b32 s72, 2
    s_mov_b32 s73, 0
    s_mov_b32 s74, 1
    s_mov_b32 s75, 4
    s_mov_b32 s76, 64
    s_branch Lsj_99
Lsn_100:
    s_cmp_eq_u32 s19, 1
    s_cbranch_scc0 Lsn_101
    s_mov_b32 s70, 32
    s_mov_b32 s71, 0
    s_mov_b32 s72, 2
    s_mov_b32 s73, 1
    s_mov_b32 s74, 1
    s_mov_b32 s75, 4
    s_mov_b32 s76, 64
    s_branch Lsj_99
Lsn_101:
    s_cmp_eq_u32 s19, 2
    s_cbranch_scc0 Lsn_102
    s_mov_b32 s70, 32
    s_mov_b32 s71, 1
    s_mov_b32 s72, 2
    s_mov_b32 s73, 0
    s_mov_b32 s74, 1
    s_mov_b32 s75, 4
    s_mov_b32 s76, 64
    s_branch Lsj_99
Lsn_102:
    s_mov_b32 s70, 32
    s_mov_b32 s71, 1
    s_mov_b32 s72, 2
    s_mov_b32 s73, 1
    s_mov_b32 s74, 1
    s_mov_b32 s75, 4
    s_mov_b32 s76, 64
Lsj_99:
    s_cmp_eq_u32 s23, 1
    s_cbranch_scc1 Lpwd_98_skip
    s_mul_i32 s20, s15, 7
    s_add_u32 s20, s20, 0
    v_and_b32 v16, 7, v0
    v_min_u32 v16, 6, v16
    v_add_u32 v16, s20, v16
    v_mul_u32_u24 v17, 9363, v16
    v_lshrrev_b32 v17, 16, v17
    v_mul_u32_u24 v18, 7, v17
    v_sub_u32 v16, v16, v18
    v_lshrrev_b32 v18, 3, v17
    v_mul_u32_u24 v18, 7, v18
    v_add_u32 v16, v16, v18
    v_and_b32 v17, 7, v17
    v_lshl_add_u32 v16, v16, 3, v17
    v_lshlrev_b32 v16, 7, v16
    s_mov_b32 s20, 125698048
Lwd_104:
    buffer_load_dwordx2 v[18:19], v16, s[8:11], s20 offen offset:0 sc1
    s_sub_u32 s18, s18, 1
    s_cbranch_scc1 interleave_layers__memory_aug_recurrent_mem_tr__glu_gated_glu__prompt_kernel_exit
    s_waitcnt vmcnt(0)
    v_xor_b32 v18, s78, v18
    v_xor_b32 v19, s79, v19
    v_or_b32 v18, v18, v19
    v_cmp_ne_u32 vcc, 0, v18
    s_cbranch_vccz Lwdok_105
    s_sleep 2
    s_branch Lwd_104
Lwdok_105:
    s_mul_i32 s20, s15, 28
    s_mul_i32 s21, s12, 7
    s_add_u32 s20, s20, s21
    s_and_b32 s22, s12, 1
    s_add_u32 s21, s20, s22
    s_mul_i32 s21, s21, 14336
    s_add_u32 s21, s21, 0
    s_xor_b32 s22, s22, 1
    s_mul_i32 s22, s22, 6
    s_add_u32 s20, s20, s22
    s_mul_i32 s20, s20, 14336
    s_add_u32 s20, s20, 0
    buffer_load_dwordx4 a[0:3], v1, s[8:11], s20 offen offset:0 sc1
    buffer_load_dwordx4 a[4:7], v1, s[8:11], s20 offen offset:1024 sc1
    buffer_load_dwordx4 a[8:11], v1, s[8:11], s20 offen offset:2048 sc1
    buffer_load_dwordx4 a[12:15], v1, s[8:11], s20 offen offset:3072 sc1
    s_add_u32 s20, s20, 4096
    buffer_load_dwordx4 a[16:19], v1, s[8:11], s20 offen offset:0 sc1
    buffer_load_dwordx4 a[20:23], v1, s[8:11], s20 offen offset:1024 sc1
    buffer_load_dwordx4 a[24:27], v1, s[8:11], s20 offen offset:2048 sc1
    buffer_load_dwordx4 a[28:31], v1, s[8:11], s20 offen offset:3072 sc1
    s_add_u32 s20, s20, 4096
    buffer_load_dwordx4 a[32:35], v1, s[8:11], s20 offen offset:0 sc1
    buffer_load_dwordx4 a[36:39], v1, s[8:11], s20 offen offset:1024 sc1
    buffer_load_dwordx4 a[40:43], v1, s[8:11], s20 offen offset:2048 sc1
    buffer_load_dwordx4 a[44:47], v1, s[8:11], s20 offen offset:3072 sc1
    s_add_u32 s20, s20, 4096
    buffer_load_dwordx4 a[48:51], v1, s[8:11], s20 offen offset:0 sc1
    buffer_load_dwordx4 a[52:55], v1, s[8:11], s20 offen offset:1024 sc1
    buffer_load_dwordx4 a[56:59], v1, s[8:11], s21 offen offset:0 sc1
    buffer_load_dwordx4 a[60:63], v1, s[8:11], s21 offen offset:1024 sc1
    buffer_load_dwordx4 a[64:67], v1, s[8:11], s21 offen offset:2048 sc1
    buffer_load_dwordx4 a[68:71], v1, s[8:11], s21 offen offset:3072 sc1
    s_add_u32 s21, s21, 4096
    buffer_load_dwordx4 a[72:75], v1, s[8:11], s21 offen offset:0 sc1
    buffer_load_dwordx4 a[76:79], v1, s[8:11], s21 offen offset:1024 sc1
    buffer_load_dwordx4 a[80:83], v1, s[8:11], s21 offen offset:2048 sc1
    buffer_load_dwordx4 a[84:87], v1, s[8:11], s21 offen offset:3072 sc1
    s_add_u32 s21, s21, 4096
    buffer_load_dwordx4 a[88:91], v1, s[8:11], s21 offen offset:0 sc1
    buffer_load_dwordx4 a[92:95], v1, s[8:11], s21 offen offset:1024 sc1
    buffer_load_dwordx4 a[96:99], v1, s[8:11], s21 offen offset:2048 sc1
    buffer_load_dwordx4 a[100:103], v1, s[8:11], s21 offen offset:3072 sc1
    s_add_u32 s21, s21, 4096
    buffer_load_dwordx4 a[104:107], v1, s[8:11], s21 offen offset:0 sc1
    buffer_load_dwordx4 a[108:111], v1, s[8:11], s21 offen offset:1024 sc1
    buffer_load_dwordx4 a[112:115], v1, s[8:11], s21 offen offset:2048 sc1
    buffer_load_dwordx4 a[116:119], v1, s[8:11], s21 offen offset:3072 sc1
    s_add_u32 s21, s21, 4096
    buffer_load_dwordx4 a[120:123], v1, s[8:11], s21 offen offset:0 sc1
    buffer_load_dwordx4 a[124:127], v1, s[8:11], s21 offen offset:1024 sc1
    buffer_load_dwordx4 a[128:131], v1, s[8:11], s21 offen offset:2048 sc1
    buffer_load_dwordx4 a[132:135], v1, s[8:11], s21 offen offset:3072 sc1
    s_add_u32 s21, s21, 4096
    buffer_load_dwordx4 a[136:139], v1, s[8:11], s21 offen offset:0 sc1
    buffer_load_dwordx4 a[140:143], v1, s[8:11], s21 offen offset:1024 sc1
    buffer_load_dwordx4 a[144:147], v1, s[8:11], s21 offen offset:2048 sc1
    buffer_load_dwordx4 a[148:151], v1, s[8:11], s21 offen offset:3072 sc1
    s_add_u32 s21, s21, 4096
    buffer_load_dwordx4 a[152:155], v1, s[8:11], s21 offen offset:0 sc1
    buffer_load_dwordx4 a[156:159], v1, s[8:11], s21 offen offset:1024 sc1
    buffer_load_dwordx4 a[160:163], v1, s[8:11], s21 offen offset:2048 sc1
    buffer_load_dwordx4 a[164:167], v1, s[8:11], s21 offen offset:3072 sc1
    s_add_u32 s21, s21, 4096
    buffer_load_dwordx4 a[168:171], v1, s[8:11], s21 offen offset:0 sc1
    buffer_load_dwordx4 a[172:175], v1, s[8:11], s21 offen offset:1024 sc1
    buffer_load_dwordx4 a[176:179], v1, s[8:11], s21 offen offset:2048 sc1
    buffer_load_dwordx4 a[180:183], v1, s[8:11], s21 offen offset:3072 sc1
    s_add_u32 s21, s21, 4096
    buffer_load_dwordx4 a[184:187], v1, s[8:11], s21 offen offset:0 sc1
    buffer_load_dwordx4 a[188:191], v1, s[8:11], s21 offen offset:1024 sc1
    s_waitcnt vmcnt(40)
    buffer_load_dwordx4 a[192:195], v1, s[8:11], s21 offen offset:2048 sc1
    buffer_load_dwordx4 a[196:199], v1, s[8:11], s21 offen offset:3072 sc1
    s_add_u32 s21, s21, 4096
    buffer_load_dwordx4 a[200:203], v1, s[8:11], s21 offen offset:0 sc1
    buffer_load_dwordx4 a[204:207], v1, s[8:11], s21 offen offset:1024 sc1
    buffer_load_dwordx4 a[208:211], v1, s[8:11], s21 offen offset:2048 sc1
    buffer_load_dwordx4 a[212:215], v1, s[8:11], s21 offen offset:3072 sc1
    s_add_u32 s21, s21, 4096
    buffer_load_dwordx4 a[216:219], v1, s[8:11], s21 offen offset:0 sc1
    buffer_load_dwordx4 a[220:223], v1, s[8:11], s21 offen offset:1024 sc1
    s_waitcnt vmcnt(40)
    buffer_load_dwordx4 a[224:227], v1, s[8:11], s21 offen offset:2048 sc1
    buffer_load_dwordx4 a[228:231], v1, s[8:11], s21 offen offset:3072 sc1
    s_add_u32 s21, s21, 4096
    buffer_load_dwordx4 a[232:235], v1, s[8:11], s21 offen offset:0 sc1
    buffer_load_dwordx4 a[236:239], v1, s[8:11], s21 offen offset:1024 sc1
    buffer_load_dwordx4 a[240:243], v1, s[8:11], s21 offen offset:2048 sc1
    buffer_load_dwordx4 a[244:247], v1, s[8:11], s21 offen offset:3072 sc1
    s_add_u32 s21, s21, 4096
    buffer_load_dwordx4 a[248:251], v1, s[8:11], s21 offen offset:0 sc1
    buffer_load_dwordx4 a[252:255], v1, s[8:11], s21 offen offset:1024 sc1
    s_waitcnt vmcnt(40)
    buffer_load_dwordx4 v[120:123], v1, s[8:11], s21 offen offset:2048 sc1
    buffer_load_dwordx4 v[124:127], v1, s[8:11], s21 offen offset:3072 sc1
    s_add_u32 s21, s21, 4096
    buffer_load_dwordx4 v[128:131], v1, s[8:11], s21 offen offset:0 sc1
    buffer_load_dwordx4 v[132:135], v1, s[8:11], s21 offen offset:1024 sc1
    buffer_load_dwordx4 v[136:139], v1, s[8:11], s21 offen offset:2048 sc1
    buffer_load_dwordx4 v[140:143], v1, s[8:11], s21 offen offset:3072 sc1
    s_add_u32 s21, s21, 4096
    buffer_load_dwordx4 v[144:147], v1, s[8:11], s21 offen offset:0 sc1
    buffer_load_dwordx4 v[148:151], v1, s[8:11], s21 offen offset:1024 sc1
    s_waitcnt vmcnt(40)
    buffer_load_dwordx4 v[152:155], v1, s[8:11], s21 offen offset:2048 sc1
    buffer_load_dwordx4 v[156:159], v1, s[8:11], s21 offen offset:3072 sc1
    s_add_u32 s21, s21, 4096
    buffer_load_dwordx4 v[160:163], v1, s[8:11], s21 offen offset:0 sc1
    buffer_load_dwordx4 v[164:167], v1, s[8:11], s21 offen offset:1024 sc1
    buffer_load_dwordx4 v[168:171], v1, s[8:11], s21 offen offset:2048 sc1
    buffer_load_dwordx4 v[172:175], v1, s[8:11], s21 offen offset:3072 sc1
    s_add_u32 s21, s21, 4096
    buffer_load_dwordx4 v[176:179], v1, s[8:11], s21 offen offset:0 sc1
    buffer_load_dwordx4 v[180:183], v1, s[8:11], s21 offen offset:1024 sc1
    s_waitcnt vmcnt(40)
    buffer_load_dwordx4 v[184:187], v1, s[8:11], s21 offen offset:2048 sc1
    buffer_load_dwordx4 v[188:191], v1, s[8:11], s21 offen offset:3072 sc1
    s_add_u32 s21, s21, 4096
    buffer_load_dwordx4 v[192:195], v1, s[8:11], s21 offen offset:0 sc1
    buffer_load_dwordx4 v[196:199], v1, s[8:11], s21 offen offset:1024 sc1
    buffer_load_dwordx4 v[200:203], v1, s[8:11], s21 offen offset:2048 sc1
    buffer_load_dwordx4 v[204:207], v1, s[8:11], s21 offen offset:3072 sc1
    s_add_u32 s21, s21, 4096
    buffer_load_dwordx4 v[208:211], v1, s[8:11], s21 offen offset:0 sc1
    buffer_load_dwordx4 v[212:215], v1, s[8:11], s21 offen offset:1024 sc1
    s_waitcnt vmcnt(40)
    buffer_load_dwordx4 v[216:219], v1, s[8:11], s21 offen offset:2048 sc1
    buffer_load_dwordx4 v[220:223], v1, s[8:11], s21 offen offset:3072 sc1
    s_add_u32 s21, s21, 4096
    buffer_load_dwordx4 v[224:227], v1, s[8:11], s21 offen offset:0 sc1
    buffer_load_dwordx4 v[228:231], v1, s[8:11], s21 offen offset:1024 sc1
    buffer_load_dwordx4 v[232:235], v1, s[8:11], s21 offen offset:2048 sc1
    buffer_load_dwordx4 v[236:239], v1, s[8:11], s21 offen offset:3072 sc1
    s_add_u32 s21, s21, 4096
    buffer_load_dwordx4 v[240:243], v1, s[8:11], s21 offen offset:0 sc1
    buffer_load_dwordx4 v[244:247], v1, s[8:11], s21 offen offset:1024 sc1
    s_waitcnt vmcnt(40)
    buffer_load_dwordx4 v[248:251], v1, s[8:11], s21 offen offset:2048 sc1
    buffer_load_dwordx4 v[252:255], v1, s[8:11], s21 offen offset:3072 sc1
    s_add_u32 s21, s21, 4096
Lpwd_98_skip:
    s_mul_i32 s20, s12, 7
    s_add_u32 s20, s20, 1
    s_lshr_b32 s20, s20, 1
    s_lshr_b32 s21, s12, 1
    s_mul_i32 s21, s21, 7
    s_add_u32 s21, s21, 3
    s_lshl_b32 s30, s20, 10
    s_lshl_b32 s31, s21, 10
    s_lshl_b32 s32, s20, 9
    s_lshl_b32 s33, s21, 9
    s_and_b32 s22, s12, 1
    s_lshl_b32 s34, s22, 3
    v_lshrrev_b32 v10, 4, v7
    v_and_b32 v11, 15, v7
    v_and_b32 v3, 7, v7
    v_min_u32 v8, 6, v3
    v_lshlrev_b32 v8, 7, v8
    v_lshlrev_b32 v3, 4, v3
    v_lshl_add_u32 v3, v10, 7, v3
    v_add_u32 v4, s34, v3
    v_mul_u32_u24 v5, 272, v10
    v_lshl_add_u32 v5, v11, 4, v5
    s_lshl_b32 s20, s12, 12
    s_add_u32 s20, s20, 65536
    v_add_u32 v5, s20, v5
    s_lshl_b32 s20, s12, 2
    v_add_u32 v12, s20, v10
    v_min_u32 v6, 11, v11
    v_mul_u32_u24 v6, 272, v6
    v_lshl_add_u32 v6, v12, 4, v6
    v_add_u32 v6, 65536, v6
    s_lshl_b32 s20, s15, 11
    v_and_b32 v13, 3, v11
    v_lshlrev_b32 v13, 8, v13
    v_lshl_add_u32 v13, v12, 4, v13
    v_lshrrev_b32 v9, 2, v11
    v_lshl_add_u32 v9, v9, 3, v13
    v_add_u32 v9, s20, v9
    s_lshr_b32 s20, s15, 2
    s_lshl_b32 s20, s20, 11
    s_add_u32 s20, s20, 32768
    s_and_b32 s21, s15, 2
    s_lshl_b32 s21, s21, 8
    s_add_u32 s20, s20, s21
    s_and_b32 s21, s15, 1
    s_lshl_b32 s21, s21, 3
    s_add_u32 s20, s20, s21
    v_add_u32 v13, s20, v13
    v_cmp_gt_u32 vcc, 8, v11
    v_cmp_gt_u32 s[22:23], 10, v11
    v_lshlrev_b32 v10, 2, v11
    v_cndmask_b32 v9, v13, v9, vcc
    v_mov_b32 v13, 2130706432
    v_cndmask_b32 v9, v13, v9, s[22:23]
    v_mov_b32 v13, 64
    v_cndmask_b32 v13, v13, 0, s[22:23]
    v_cndmask_b32 v10, v13, v10, vcc
    v_mov_b32 v117, 0xff800000
    v_add_u32 v13, 0, v10
    v_cndmask_b32 v13, v10, v13, vcc
    v_add_u32 v2, 0, v12
    v_cmp_le_u32 s[82:83], v13, v2
    v_add_u32 v13, 1, v10
    v_cndmask_b32 v13, v10, v13, vcc
    v_add_u32 v2, 0, v12
    v_cmp_le_u32 s[84:85], v13, v2
    v_add_u32 v13, 2, v10
    v_cndmask_b32 v13, v10, v13, vcc
    v_add_u32 v2, 0, v12
    v_cmp_le_u32 s[86:87], v13, v2
    v_add_u32 v13, 3, v10
    v_cndmask_b32 v13, v10, v13, vcc
    v_add_u32 v2, 0, v12
    v_cmp_le_u32 s[88:89], v13, v2
    v_add_u32 v13, 0, v10
    v_cndmask_b32 v13, v10, v13, vcc
    v_add_u32 v2, 16, v12
    v_cmp_le_u32 s[90:91], v13, v2
    v_add_u32 v13, 1, v10
    v_cndmask_b32 v13, v10, v13, vcc
    v_add_u32 v2, 16, v12
    v_cmp_le_u32 s[92:93], v13, v2
    v_add_u32 v13, 2, v10
    v_cndmask_b32 v13, v10, v13, vcc
    v_add_u32 v2, 16, v12
    v_cmp_le_u32 s[94:95], v13, v2
    v_add_u32 v13, 3, v10
    v_cndmask_b32 v13, v10, v13, vcc
    v_add_u32 v2, 16, v12
    v_cmp_le_u32 s[96:97], v13, v2
    s_lshl_b32 s20, s12, 2
    s_add_u32 s20, s20, 147392
    v_mov_b32 v10, s20
    v_mov_b32 v11, 147392
    s_mov_b32 s56, s4
    s_mov_b32 s57, s5
    s_mov_b32 s58, 0
    s_mov_b32 s59, 0x20000
    s_mov_b32 s52, 0
    s_mov_b32 s53, 125566976
    s_mov_b32 s54, 0
    s_mul_i32 s29, s12, 7168
    s_mov_b32 s42, 0
    v_lshlrev_b32 v16, 7, v0
    s_mov_b32 s20, 125698048
Lwd_106:
    buffer_load_dwordx2 v[18:19], v16, s[8:11], s20 offen offset:0 sc1
    s_sub_u32 s18, s18, 1
    s_cbranch_scc1 interleave_layers__memory_aug_recurrent_mem_tr__glu_gated_glu__prompt_kernel_exit
    s_waitcnt vmcnt(0)
    v_xor_b32 v18, s78, v18
    v_xor_b32 v19, s79, v19
    v_or_b32 v18, v18, v19
    v_cmp_ne_u32 vcc, 0, v18
    s_cbranch_vccz Lwdok_107
    s_sleep 2
    s_branch Lwd_106
Lwdok_107:
    s_barrier
    s_sub_u32 s20, s42, s70
    s_cselect_b32 s20, s42, s20
    s_cselect_b32 s14, s71, s74
    s_cselect_b32 s21, s72, s75
    s_cselect_b32 s43, s73, s76
    s_mul_i32 s20, s20, s21
    s_add_u32 s43, s43, s20
    s_lshl_b32 s44, s14, 6
    s_add_u32 s44, s44, s43
    s_cmp_ge_u32 s43, 64
    s_cbranch_scc1 interleave_layers__memory_aug_recurrent_mem_tr__glu_gated_glu__prompt_kernel_exit
    s_add_u32 s42, s42, 1
    s_mov_b32 s36, 121832576
    s_sub_u32 s20, s42, s70
    s_cselect_b32 s20, s42, s20
    s_cselect_b32 s45, s71, s74
    s_cselect_b32 s21, s72, s75
    s_cselect_b32 s46, s73, s76
    s_mul_i32 s20, s20, s21
    s_add_u32 s46, s46, s20
    s_lshl_b32 s47, s45, 6
    s_add_u32 s47, s47, s46
    s_cmp_ge_u32 s46, 64
    s_cbranch_scc1 Lnj_112
    s_mul_i32 s36, s47, 1024
    s_add_u32 s36, s36, 122097664
    s_cmp_eq_u32 s45, 0
    s_cselect_b32 s36, 120265728, s36
Lnj_112:
    buffer_load_dword v12, v8, s[8:11], s36 offen sc1
Lp_108:
    s_cmp_eq_u32 s52, 1
    s_cbranch_scc1 Lhv_110
    s_cmp_eq_u32 s14, 0
    s_cbranch_scc1 Lnw_109
    s_mul_i32 s22, s44, 1024
    s_add_u32 s22, s22, 122097664
Lwf_113:
    buffer_load_dword v118, v8, s[8:11], s22 offen sc1
    s_sub_u32 s18, s18, 1
    s_cbranch_scc1 interleave_layers__memory_aug_recurrent_mem_tr__glu_gated_glu__prompt_kernel_exit
    s_waitcnt vmcnt(0)
    v_cmp_eq_u32 vcc, 0, v118
    s_cbranch_vccz Lwfok_114
    s_sleep 2
    s_branch Lwf_113
Lwfok_114:
Lnw_109:
    s_mul_i32 s22, s44, 28672
    s_add_u32 s22, s22, s29
    s_add_u32 s22, s22, 12845056
    s_mov_b32 s23, s54
    s_add_u32 s23, s23, s29
    s_mov_b32 m0, s23
    s_add_u32 s23, s23, 4096
    buffer_load_dwordx4 v1, s[8:11], s22 offen offset:0 sc1 lds
    buffer_load_dwordx4 v1, s[8:11], s22 offen offset:1024 sc1 lds
    buffer_load_dwordx4 v1, s[8:11], s22 offen offset:2048 sc1 lds
    buffer_load_dwordx4 v1, s[8:11], s22 offen offset:3072 sc1 lds
    s_add_u32 s22, s22, 4096
    s_mov_b32 m0, s23
    s_add_u32 s23, s23, 4096
    buffer_load_dwordx4 v1, s[8:11], s22 offen offset:0 sc1 lds
    buffer_load_dwordx4 v1, s[8:11], s22 offen offset:1024 sc1 lds
    buffer_load_dwordx4 v1, s[8:11], s22 offen offset:2048 sc1 lds
    buffer_load_dword v12, v8, s[8:11], s36 offen sc1
    s_waitcnt vmcnt(0)
Lhv_110:
    v_add_u32 v13, s54, v1
    s_lshl_b32 s27, s44, 13
    s_add_u32 s27, s27, 119209984
    s_add_u32 s28, s27, s33
    s_add_u32 s27, s27, s32
    s_mul_i32 s24, s44, 40960
    s_add_u32 s24, s24, 113770496
    v_add_u32 v2, s30, v13
    v_add_u32 v7, s31, v13
    v_add_u32 v7, s34, v7
    s_mul_i32 s22, s47, 28672
    s_add_u32 s22, s22, s29
    s_add_u32 s22, s22, 12845056
    s_xor_b32 s23, s54, 32768
    s_add_u32 s23, s23, s29
    s_waitcnt vmcnt(3)
    v_cmp_eq_u32 vcc, 0, v12
    s_nop 1
    v_mov_b32 v118, vcc_lo
    v_or_b32 v118, vcc_hi, v118
    ds_write_b32 v10, v118
    s_waitcnt lgkmcnt(0)
    s_barrier
    ds_read_b32 v118, v11
    ds_read_b128 v[44:47], v13 offset:0
    ds_read_b128 v[48:51], v13 offset:1024
    s_waitcnt lgkmcnt(2)
    v_readfirstlane_b32 s20, v118
    s_cmp_eq_u32 s20, 0
    s_cselect_b32 s52, 1, 0
    s_cselect_b32 s58, 0x10000000, 0
    s_waitcnt lgkmcnt(1)
    v_mfma_f32_16x16x32_bf16 v[16:19], a[0:3], v[44:47], 0
    v_mfma_f32_16x16x32_bf16 v[20:23], a[56:59], v[44:47], 0
    v_mov_b32 v116, v44
    v_mfma_f32_16x16x32_bf16 v[24:27], a[112:115], v[44:47], 0
    ds_read_b64 v[84:85], v7 offset:0
    v_mfma_f32_16x16x32_bf16 v[28:31], a[168:171], v[44:47], 0
    v_mfma_f32_16x16x32_bf16 v[32:35], a[224:227], v[44:47], 0
    v_mfma_f32_16x16x32_bf16 v[36:39], v[144:147], v[44:47], 0
    ds_read_b128 v[52:55], v13 offset:2048
    v_mfma_f32_16x16x32_bf16 v[40:43], v[200:203], v[44:47], 0
    s_waitcnt lgkmcnt(1)
    v_mfma_f32_16x16x32_bf16 v[16:19], a[4:7], v[48:51], v[16:19]
    v_mfma_f32_16x16x32_bf16 v[20:23], a[60:63], v[48:51], v[20:23]
    v_max_u32 v116, v116, v48
    v_mfma_f32_16x16x32_bf16 v[24:27], a[116:119], v[48:51], v[24:27]
    ds_read_b128 v[88:91], v2 offset:0
    v_mfma_f32_16x16x32_bf16 v[28:31], a[172:175], v[48:51], v[28:31]
    s_mov_b32 m0, s23
    s_add_u32 s23, s23, 4096
    v_mfma_f32_16x16x32_bf16 v[32:35], a[228:231], v[48:51], v[32:35]
    v_mfma_f32_16x16x32_bf16 v[36:39], v[148:151], v[48:51], v[36:39]
    ds_read_b128 v[44:47], v13 offset:3072
    v_mfma_f32_16x16x32_bf16 v[40:43], v[204:207], v[48:51], v[40:43]
    s_waitcnt lgkmcnt(1)
    v_mfma_f32_16x16x32_bf16 v[16:19], a[8:11], v[52:55], v[16:19]
    v_mfma_f32_16x16x32_bf16 v[20:23], a[64:67], v[52:55], v[20:23]
    v_max_u32 v116, v116, v52
    v_mfma_f32_16x16x32_bf16 v[24:27], a[120:123], v[52:55], v[24:27]
    ds_read_b128 v[96:99], v2 offset:1024
    v_mfma_f32_16x16x32_bf16 v[28:31], a[176:179], v[52:55], v[28:31]
    buffer_load_dwordx4 v1, s[56:59], s22 offen offset:0 sc1 lds
    v_mfma_f32_16x16x32_bf16 v[32:35], a[232:235], v[52:55], v[32:35]
    v_mfma_f32_16x16x32_bf16 v[36:39], v[152:155], v[52:55], v[36:39]
    ds_read_b128 v[48:51], v13 offset:4096
    v_mfma_f32_16x16x32_bf16 v[40:43], v[208:211], v[52:55], v[40:43]
    s_waitcnt lgkmcnt(1)
    v_mfma_f32_16x16x32_bf16 v[16:19], a[12:15], v[44:47], v[16:19]
    v_mfma_f32_16x16x32_bf16 v[20:23], a[68:71], v[44:47], v[20:23]
    v_max_u32 v116, v116, v44
    v_mfma_f32_16x16x32_bf16 v[24:27], a[124:127], v[44:47], v[24:27]
    ds_read_b128 v[104:107], v2 offset:2048
    v_mfma_f32_16x16x32_bf16 v[28:31], a[180:183], v[44:47], v[28:31]
    v_mfma_f32_16x16x32_bf16 v[32:35], a[236:239], v[44:47], v[32:35]
    v_mfma_f32_16x16x32_bf16 v[36:39], v[156:159], v[44:47], v[36:39]
    ds_read_b128 v[52:55], v13 offset:5120
    v_mfma_f32_16x16x32_bf16 v[40:43], v[212:215], v[44:47], v[40:43]
    s_waitcnt lgkmcnt(1)
    v_mfma_f32_16x16x32_bf16 v[16:19], a[16:19], v[48:51], v[16:19]
    v_mfma_f32_16x16x32_bf16 v[20:23], a[72:75], v[48:51], v[20:23]
    v_max_u32 v116, v116, v48
    v_mfma_f32_16x16x32_bf16 v[24:27], a[128:131], v[48:51], v[24:27]
    ds_read_b64 v[86:87], v7 offset:14336
    v_mfma_f32_16x16x32_bf16 v[28:31], a[184:187], v[48:51], v[28:31]
    s_nop 0
    v_mfma_f32_16x16x32_bf16 v[32:35], a[240:243], v[48:51], v[32:35]
    v_mfma_f32_16x16x32_bf16 v[36:39], v[160:163], v[48:51], v[36:39]
    ds_read_b128 v[44:47], v13 offset:6144
    v_mfma_f32_16x16x32_bf16 v[40:43], v[216:219], v[48:51], v[40:43]
    s_waitcnt lgkmcnt(1)
    v_mfma_f32_16x16x32_bf16 v[16:19], a[20:23], v[52:55], v[16:19]
    v_mfma_f32_16x16x32_bf16 v[20:23], a[76:79], v[52:55], v[20:23]
    v_max_u32 v116, v116, v52
    v_mfma_f32_16x16x32_bf16 v[24:27], a[132:135], v[52:55], v[24:27]
    ds_read_b128 v[92:95], v2 offset:14336
    v_mfma_f32_16x16x32_bf16 v[28:31], a[188:191], v[52:55], v[28:31]
    buffer_load_dwordx4 v1, s[56:59], s22 offen offset:1024 sc1 lds
    v_mfma_f32_16x16x32_bf16 v[32:35], a[244:247], v[52:55], v[32:35]
    v_mfma_f32_16x16x32_bf16 v[36:39], v[164:167], v[52:55], v[36:39]
    ds_read_b128 v[48:51], v13 offset:7168
    v_mfma_f32_16x16x32_bf16 v[40:43], v[220:223], v[52:55], v[40:43]
    s_waitcnt lgkmcnt(1)
    v_mfma_f32_16x16x32_bf16 v[16:19], a[24:27], v[44:47], v[16:19]
    v_mfma_f32_16x16x32_bf16 v[20:23], a[80:83], v[44:47], v[20:23]
    v_max_u32 v116, v116, v44
    v_mfma_f32_16x16x32_bf16 v[24:27], a[136:139], v[44:47], v[24:27]
    ds_read_b128 v[100:103], v2 offset:15360
    v_mfma_f32_16x16x32_bf16 v[28:31], a[192:195], v[44:47], v[28:31]
    v_mfma_f32_16x16x32_bf16 v[32:35], a[248:251], v[44:47], v[32:35]
    v_mfma_f32_16x16x32_bf16 v[36:39], v[168:171], v[44:47], v[36:39]
    ds_read_b128 v[52:55], v13 offset:8192
    v_mfma_f32_16x16x32_bf16 v[40:43], v[224:227], v[44:47], v[40:43]
    s_waitcnt lgkmcnt(1)
    v_mfma_f32_16x16x32_bf16 v[16:19], a[28:31], v[48:51], v[16:19]
    v_mfma_f32_16x16x32_bf16 v[20:23], a[84:87], v[48:51], v[20:23]
    v_max_u32 v116, v116, v48
    v_mfma_f32_16x16x32_bf16 v[24:27], a[140:143], v[48:51], v[24:27]
    ds_read_b128 v[108:111], v2 offset:16384
    v_mfma_f32_16x16x32_bf16 v[28:31], a[196:199], v[48:51], v[28:31]
    s_nop 0
    v_mfma_f32_16x16x32_bf16 v[32:35], a[252:255], v[48:51], v[32:35]
    v_mfma_f32_16x16x32_bf16 v[36:39], v[172:175], v[48:51], v[36:39]
    ds_read_b128 v[44:47], v13 offset:9216
    v_mfma_f32_16x16x32_bf16 v[40:43], v[228:231], v[48:51], v[40:43]
    s_waitcnt lgkmcnt(1)
    v_mfma_f32_16x16x32_bf16 v[16:19], a[32:35], v[52:55], v[16:19]
    v_mfma_f32_16x16x32_bf16 v[20:23], a[88:91], v[52:55], v[20:23]
    v_max_u32 v116, v116, v52
    v_mfma_f32_16x16x32_bf16 v[24:27], a[144:147], v[52:55], v[24:27]
    v_mfma_f32_16x16x32_bf16 v[28:31], a[200:203], v[52:55], v[28:31]
    buffer_load_dwordx4 v1, s[56:59], s22 offen offset:2048 sc1 lds
    v_mfma_f32_16x16x32_bf16 v[32:35], v[120:123], v[52:55], v[32:35]
    v_mfma_f32_16x16x32_bf16 v[36:39], v[176:179], v[52:55], v[36:39]
    ds_read_b128 v[48:51], v13 offset:10240
    v_mfma_f32_16x16x32_bf16 v[40:43], v[232:235], v[52:55], v[40:43]
    s_waitcnt lgkmcnt(1)
    v_mfma_f32_16x16x32_bf16 v[16:19], a[36:39], v[44:47], v[16:19]
    v_mfma_f32_16x16x32_bf16 v[20:23], a[92:95], v[44:47], v[20:23]
    v_max_u32 v116, v116, v44
    v_mfma_f32_16x16x32_bf16 v[24:27], a[148:151], v[44:47], v[24:27]
    v_mfma_f32_16x16x32_bf16 v[28:31], a[204:207], v[44:47], v[28:31]
    v_mfma_f32_16x16x32_bf16 v[32:35], v[124:127], v[44:47], v[32:35]
    v_mfma_f32_16x16x32_bf16 v[36:39], v[180:183], v[44:47], v[36:39]
    ds_read_b128 v[52:55], v13 offset:11264
    v_mfma_f32_16x16x32_bf16 v[40:43], v[236:239], v[44:47], v[40:43]
    s_waitcnt lgkmcnt(1)
    v_mfma_f32_16x16x32_bf16 v[16:19], a[40:43], v[48:51], v[16:19]
    v_mfma_f32_16x16x32_bf16 v[20:23], a[96:99], v[48:51], v[20:23]
    v_max_u32 v116, v116, v48
    v_mfma_f32_16x16x32_bf16 v[24:27], a[152:155], v[48:51], v[24:27]
    v_mfma_f32_16x16x32_bf16 v[28:31], a[208:211], v[48:51], v[28:31]
    s_nop 0
    v_mfma_f32_16x16x32_bf16 v[32:35], v[128:131], v[48:51], v[32:35]
    v_mfma_f32_16x16x32_bf16 v[36:39], v[184:187], v[48:51], v[36:39]
    ds_read_b128 v[44:47], v13 offset:12288
    v_mfma_f32_16x16x32_bf16 v[40:43], v[240:243], v[48:51], v[40:43]
    s_waitcnt lgkmcnt(1)
    v_mfma_f32_16x16x32_bf16 v[16:19], a[44:47], v[52:55], v[16:19]
    v_mfma_f32_16x16x32_bf16 v[20:23], a[100:103], v[52:55], v[20:23]
    v_max_u32 v116, v116, v52
    v_mfma_f32_16x16x32_bf16 v[24:27], a[156:159], v[52:55], v[24:27]
    v_mfma_f32_16x16x32_bf16 v[28:31], a[212:215], v[52:55], v[28:31]
    buffer_load_dwordx4 v1, s[56:59], s22 offen offset:3072 sc1 lds
    v_mfma_f32_16x16x32_bf16 v[32:35], v[132:135], v[52:55], v[32:35]
    v_mfma_f32_16x16x32_bf16 v[36:39], v[188:191], v[52:55], v[36:39]
    ds_read_b128 v[48:51], v13 offset:13312
    v_mfma_f32_16x16x32_bf16 v[40:43], v[244:247], v[52:55], v[40:43]
    s_waitcnt lgkmcnt(1)
    v_mfma_f32_16x16x32_bf16 v[16:19], a[48:51], v[44:47], v[16:19]
    v_mfma_f32_16x16x32_bf16 v[20:23], a[104:107], v[44:47], v[20:23]
    v_max_u32 v116, v116, v44
    v_mfma_f32_16x16x32_bf16 v[24:27], a[160:163], v[44:47], v[24:27]
    v_mfma_f32_16x16x32_bf16 v[28:31], a[216:219], v[44:47], v[28:31]
    v_mfma_f32_16x16x32_bf16 v[32:35], v[136:139], v[44:47], v[32:35]
    v_mfma_f32_16x16x32_bf16 v[36:39], v[192:195], v[44:47], v[36:39]
    ds_read_b128 v[52:55], v13 offset:14336
    v_mfma_f32_16x16x32_bf16 v[40:43], v[248:251], v[44:47], v[40:43]
    s_waitcnt lgkmcnt(1)
    v_mfma_f32_16x16x32_bf16 v[16:19], a[52:55], v[48:51], v[16:19]
    v_mfma_f32_16x16x32_bf16 v[20:23], a[108:111], v[48:51], v[20:23]
    v_max_u32 v116, v116, v48
    v_mfma_f32_16x16x32_bf16 v[24:27], a[164:167], v[48:51], v[24:27]
    v_mfma_f32_16x16x32_bf16 v[28:31], a[220:223], v[48:51], v[28:31]
    v_mfma_f32_16x16x32_bf16 v[32:35], v[140:143], v[48:51], v[32:35]
    v_mfma_f32_16x16x32_bf16 v[36:39], v[196:199], v[48:51], v[36:39]
    ds_read_b128 v[44:47], v13 offset:15360
    v_mfma_f32_16x16x32_bf16 v[40:43], v[252:255], v[48:51], v[40:43]
    s_nop 0
    v_cvt_pk_bf16_f32 v56, v16, v17
    v_cvt_pk_bf16_f32 v57, v18, v19
    v_cvt_pk_bf16_f32 v58, v20, v21
    v_cvt_pk_bf16_f32 v59, v22, v23
    v_cvt_pk_bf16_f32 v60, v24, v25
    v_cvt_pk_bf16_f32 v61, v26, v27
    v_cvt_pk_bf16_f32 v62, v28, v29
    v_cvt_pk_bf16_f32 v63, v30, v31
    v_cvt_pk_bf16_f32 v64, v32, v33
    v_cvt_pk_bf16_f32 v65, v34, v35
    v_cvt_pk_bf16_f32 v66, v36, v37
    v_cvt_pk_bf16_f32 v67, v38, v39
    v_cvt_pk_bf16_f32 v68, v40, v41
    v_cvt_pk_bf16_f32 v69, v42, v43
    s_waitcnt lgkmcnt(1)
    v_mfma_f32_16x16x32_bf16 v[16:19], a[0:3], v[52:55], 0
    v_mfma_f32_16x16x32_bf16 v[20:23], a[56:59], v[52:55], 0
    v_max_u32 v116, v116, v52
    v_mfma_f32_16x16x32_bf16 v[24:27], a[112:115], v[52:55], 0
    v_mfma_f32_16x16x16_bf16 v[112:115], v[84:85], v[56:57], 0
    v_mfma_f32_16x16x32_bf16 v[28:31], a[168:171], v[52:55], 0
    v_mfma_f32_16x16x32_bf16 v[32:35], a[224:227], v[52:55], 0
    v_mfma_f32_16x16x32_bf16 v[36:39], v[144:147], v[52:55], 0
    ds_read_b128 v[48:51], v13 offset:16384
    v_mfma_f32_16x16x32_bf16 v[40:43], v[200:203], v[52:55], 0
    s_waitcnt lgkmcnt(1)
    v_mfma_f32_16x16x32_bf16 v[16:19], a[4:7], v[44:47], v[16:19]
    v_mfma_f32_16x16x32_bf16 v[20:23], a[60:63], v[44:47], v[20:23]
    v_max_u32 v116, v116, v44
    v_mfma_f32_16x16x32_bf16 v[24:27], a[116:119], v[44:47], v[24:27]
    v_mfma_f32_16x16x32_bf16 v[28:31], a[172:175], v[44:47], v[28:31]
    s_add_u32 s22, s22, 4096
    s_mov_b32 m0, s23
    s_add_u32 s23, s23, 4096
    v_mfma_f32_16x16x32_bf16 v[32:35], a[228:231], v[44:47], v[32:35]
    v_mfma_f32_16x16x32_bf16 v[36:39], v[148:151], v[44:47], v[36:39]
    ds_read_b128 v[52:55], v13 offset:17408
    v_mfma_f32_16x16x32_bf16 v[40:43], v[204:207], v[44:47], v[40:43]
    s_waitcnt lgkmcnt(1)
    v_mfma_f32_16x16x32_bf16 v[16:19], a[8:11], v[48:51], v[16:19]
    v_mfma_f32_16x16x32_bf16 v[20:23], a[64:67], v[48:51], v[20:23]
    v_max_u32 v116, v116, v48
    v_mfma_f32_16x16x32_bf16 v[24:27], a[120:123], v[48:51], v[24:27]
    v_mfma_f32_16x16x32_bf16 v[112:115], v[88:91], v[58:61], v[112:115]
    v_mfma_f32_16x16x32_bf16 v[28:31], a[176:179], v[48:51], v[28:31]
    v_mfma_f32_16x16x32_bf16 v[112:115], v[96:99], v[62:65], v[112:115]
    buffer_load_dwordx4 v1, s[56:59], s22 offen offset:0 sc1 lds
    v_mfma_f32_16x16x32_bf16 v[32:35], a[232:235], v[48:51], v[32:35]
    v_mfma_f32_16x16x32_bf16 v[112:115], v[104:107], v[66:69], v[112:115]
    v_mfma_f32_16x16x32_bf16 v[36:39], v[152:155], v[48:51], v[36:39]
    ds_read_b128 v[44:47], v13 offset:18432
    v_mfma_f32_16x16x32_bf16 v[40:43], v[208:211], v[48:51], v[40:43]
    s_waitcnt lgkmcnt(1)
    v_mfma_f32_16x16x32_bf16 v[16:19], a[12:15], v[52:55], v[16:19]
    v_mfma_f32_16x16x32_bf16 v[20:23], a[68:71], v[52:55], v[20:23]
    v_max_u32 v116, v116, v52
    v_mfma_f32_16x16x32_bf16 v[24:27], a[124:127], v[52:55], v[24:27]
    v_mfma_f32_16x16x32_bf16 v[28:31], a[180:183], v[52:55], v[28:31]
    v_mfma_f32_16x16x32_bf16 v[32:35], a[236:239], v[52:55], v[32:35]
    v_mfma_f32_16x16x32_bf16 v[36:39], v[156:159], v[52:55], v[36:39]
    ds_read_b128 v[48:51], v13 offset:19456
    v_mfma_f32_16x16x32_bf16 v[40:43], v[212:215], v[52:55], v[40:43]
    s_waitcnt lgkmcnt(1)
    v_mfma_f32_16x16x32_bf16 v[16:19], a[16:19], v[44:47], v[16:19]
    v_mfma_f32_16x16x32_bf16 v[20:23], a[72:75], v[44:47], v[20:23]
    v_max_u32 v116, v116, v44
    v_mfma_f32_16x16x32_bf16 v[24:27], a[128:131], v[44:47], v[24:27]
    ds_write_b128 v5, v[112:115]
    v_mfma_f32_16x16x32_bf16 v[28:31], a[184:187], v[44:47], v[28:31]
    s_nop 0
    v_mfma_f32_16x16x32_bf16 v[32:35], a[240:243], v[44:47], v[32:35]
    v_mfma_f32_16x16x32_bf16 v[36:39], v[160:163], v[44:47], v[36:39]
    ds_read_b128 v[52:55], v13 offset:20480
    v_mfma_f32_16x16x32_bf16 v[40:43], v[216:219], v[44:47], v[40:43]
    s_waitcnt lgkmcnt(1)
    v_mfma_f32_16x16x32_bf16 v[16:19], a[20:23], v[48:51], v[16:19]
    v_mfma_f32_16x16x32_bf16 v[20:23], a[76:79], v[48:51], v[20:23]
    v_max_u32 v116, v116, v48
    v_mfma_f32_16x16x32_bf16 v[24:27], a[132:135], v[48:51], v[24:27]
    v_mfma_f32_16x16x32_bf16 v[28:31], a[188:191], v[48:51], v[28:31]
    buffer_load_dwordx4 v1, s[56:59], s22 offen offset:1024 sc1 lds
    v_mfma_f32_16x16x32_bf16 v[32:35], a[244:247], v[48:51], v[32:35]
    v_mfma_f32_16x16x32_bf16 v[36:39], v[164:167], v[48:51], v[36:39]
    ds_read_b128 v[44:47], v13 offset:21504
    v_mfma_f32_16x16x32_bf16 v[40:43], v[220:223], v[48:51], v[40:43]
    s_waitcnt lgkmcnt(1)
    v_mfma_f32_16x16x32_bf16 v[16:19], a[24:27], v[52:55], v[16:19]
    v_mfma_f32_16x16x32_bf16 v[20:23], a[80:83], v[52:55], v[20:23]
    v_max_u32 v116, v116, v52
    v_mfma_f32_16x16x32_bf16 v[24:27], a[136:139], v[52:55], v[24:27]
    v_mfma_f32_16x16x32_bf16 v[28:31], a[192:195], v[52:55], v[28:31]
    v_mfma_f32_16x16x32_bf16 v[32:35], a[248:251], v[52:55], v[32:35]
    v_mfma_f32_16x16x32_bf16 v[36:39], v[168:171], v[52:55], v[36:39]
    ds_read_b128 v[48:51], v13 offset:22528
    v_mfma_f32_16x16x32_bf16 v[40:43], v[224:227], v[52:55], v[40:43]
    s_waitcnt lgkmcnt(1)
    v_mfma_f32_16x16x32_bf16 v[16:19], a[28:31], v[44:47], v[16:19]
    v_mfma_f32_16x16x32_bf16 v[20:23], a[84:87], v[44:47], v[20:23]
    v_max_u32 v116, v116, v44
    v_mfma_f32_16x16x32_bf16 v[24:27], a[140:143], v[44:47], v[24:27]
    v_mfma_f32_16x16x32_bf16 v[28:31], a[196:199], v[44:47], v[28:31]
    s_nop 0
    v_mfma_f32_16x16x32_bf16 v[32:35], a[252:255], v[44:47], v[32:35]
    v_mfma_f32_16x16x32_bf16 v[36:39], v[172:175], v[44:47], v[36:39]
    ds_read_b128 v[52:55], v13 offset:23552
    v_mfma_f32_16x16x32_bf16 v[40:43], v[228:231], v[44:47], v[40:43]
    s_waitcnt lgkmcnt(1)
    v_mfma_f32_16x16x32_bf16 v[16:19], a[32:35], v[48:51], v[16:19]
    v_mfma_f32_16x16x32_bf16 v[20:23], a[88:91], v[48:51], v[20:23]
    v_max_u32 v116, v116, v48
    v_mfma_f32_16x16x32_bf16 v[24:27], a[144:147], v[48:51], v[24:27]
    v_mfma_f32_16x16x32_bf16 v[28:31], a[200:203], v[48:51], v[28:31]
    buffer_load_dwordx4 v1, s[56:59], s22 offen offset:2048 sc1 lds
    v_mfma_f32_16x16x32_bf16 v[32:35], v[120:123], v[48:51], v[32:35]
    v_mfma_f32_16x16x32_bf16 v[36:39], v[176:179], v[48:51], v[36:39]
    ds_read_b128 v[44:47], v13 offset:24576
    v_mfma_f32_16x16x32_bf16 v[40:43], v[232:235], v[48:51], v[40:43]
    s_waitcnt lgkmcnt(1)
    v_mfma_f32_16x16x32_bf16 v[16:19], a[36:39], v[52:55], v[16:19]
    v_mfma_f32_16x16x32_bf16 v[20:23], a[92:95], v[52:55], v[20:23]
    v_max_u32 v116, v116, v52
    v_mfma_f32_16x16x32_bf16 v[24:27], a[148:151], v[52:55], v[24:27]
    v_mfma_f32_16x16x32_bf16 v[28:31], a[204:207], v[52:55], v[28:31]
    v_mfma_f32_16x16x32_bf16 v[32:35], v[124:127], v[52:55], v[32:35]
    v_mfma_f32_16x16x32_bf16 v[36:39], v[180:183], v[52:55], v[36:39]
    ds_read_b128 v[48:51], v13 offset:25600
    v_mfma_f32_16x16x32_bf16 v[40:43], v[236:239], v[52:55], v[40:43]
    s_waitcnt lgkmcnt(1)
    v_mfma_f32_16x16x32_bf16 v[16:19], a[40:43], v[44:47], v[16:19]
    v_mfma_f32_16x16x32_bf16 v[20:23], a[96:99], v[44:47], v[20:23]
    v_max_u32 v116, v116, v44
    v_mfma_f32_16x16x32_bf16 v[24:27], a[152:155], v[44:47], v[24:27]
    v_mfma_f32_16x16x32_bf16 v[28:31], a[208:211], v[44:47], v[28:31]
    v_mfma_f32_16x16x32_bf16 v[32:35], v[128:131], v[44:47], v[32:35]
    v_mfma_f32_16x16x32_bf16 v[36:39], v[184:187], v[44:47], v[36:39]
    ds_read_b128 v[52:55], v13 offset:26624
    v_mfma_f32_16x16x32_bf16 v[40:43], v[240:243], v[44:47], v[40:43]
    s_waitcnt lgkmcnt(1)
    v_mfma_f32_16x16x32_bf16 v[16:19], a[44:47], v[48:51], v[16:19]
    v_mfma_f32_16x16x32_bf16 v[20:23], a[100:103], v[48:51], v[20:23]
    v_max_u32 v116, v116, v48
    v_mfma_f32_16x16x32_bf16 v[24:27], a[156:159], v[48:51], v[24:27]
    v_mfma_f32_16x16x32_bf16 v[28:31], a[212:215], v[48:51], v[28:31]
    v_mfma_f32_16x16x32_bf16 v[32:35], v[132:135], v[48:51], v[32:35]
    v_mfma_f32_16x16x32_bf16 v[36:39], v[188:191], v[48:51], v[36:39]
    ds_read_b128 v[44:47], v13 offset:27648
    v_mfma_f32_16x16x32_bf16 v[40:43], v[244:247], v[48:51], v[40:43]
    s_waitcnt lgkmcnt(1)
    v_mfma_f32_16x16x32_bf16 v[16:19], a[48:51], v[52:55], v[16:19]
    v_mfma_f32_16x16x32_bf16 v[20:23], a[104:107], v[52:55], v[20:23]
    v_max_u32 v116, v116, v52
    v_mfma_f32_16x16x32_bf16 v[24:27], a[160:163], v[52:55], v[24:27]
    buffer_load_dwordx2 v[118:119], v4, s[8:11], s28 offen sc1
    v_mfma_f32_16x16x32_bf16 v[28:31], a[216:219], v[52:55], v[28:31]
    v_mfma_f32_16x16x32_bf16 v[32:35], v[136:139], v[52:55], v[32:35]
    buffer_load_dwordx4 v[48:51], v3, s[8:11], s27 offen offset:0 sc1
    v_mfma_f32_16x16x32_bf16 v[36:39], v[192:195], v[52:55], v[36:39]
    v_mfma_f32_16x16x32_bf16 v[40:43], v[248:251], v[52:55], v[40:43]
    s_waitcnt lgkmcnt(0)
    v_mfma_f32_16x16x32_bf16 v[16:19], a[52:55], v[44:47], v[16:19]
    v_mfma_f32_16x16x32_bf16 v[20:23], a[108:111], v[44:47], v[20:23]
    v_max_u32 v116, v116, v44
    v_mfma_f32_16x16x32_bf16 v[24:27], a[164:167], v[44:47], v[24:27]
    buffer_load_dwordx4 v[52:55], v3, s[8:11], s27 offen offset:512 sc1
    v_mfma_f32_16x16x32_bf16 v[28:31], a[220:223], v[44:47], v[28:31]
    v_mfma_f32_16x16x32_bf16 v[32:35], v[140:143], v[44:47], v[32:35]
    v_mfma_f32_16x16x32_bf16 v[36:39], v[196:199], v[44:47], v[36:39]
    v_mfma_f32_16x16x32_bf16 v[40:43], v[252:255], v[44:47], v[40:43]
    buffer_load_dwordx4 v[44:47], v3, s[8:11], s27 offen offset:1024 sc1
    v_cmp_eq_u32 vcc, -1, v116
    s_cbranch_vccnz Lredo_111
    v_cvt_pk_bf16_f32 v70, v16, v17
    v_cvt_pk_bf16_f32 v71, v18, v19
    v_cvt_pk_bf16_f32 v72, v20, v21
    v_cvt_pk_bf16_f32 v73, v22, v23
    v_cvt_pk_bf16_f32 v74, v24, v25
    v_cvt_pk_bf16_f32 v75, v26, v27
    v_cvt_pk_bf16_f32 v76, v28, v29
    v_cvt_pk_bf16_f32 v77, v30, v31
    v_cvt_pk_bf16_f32 v78, v32, v33
    v_cvt_pk_bf16_f32 v79, v34, v35
    v_cvt_pk_bf16_f32 v80, v36, v37
    v_cvt_pk_bf16_f32 v81, v38, v39
    v_cvt_pk_bf16_f32 v82, v40, v41
    v_cvt_pk_bf16_f32 v83, v42, v43
    v_mfma_f32_16x16x32_bf16 v[16:19], v[88:91], v[72:75], 0
    v_mfma_f32_16x16x32_bf16 v[20:23], v[92:95], v[72:75], 0
    v_mfma_f32_16x16x16_bf16 v[24:27], v[84:85], v[70:71], 0
    v_mfma_f32_16x16x16_bf16 v[28:31], v[86:87], v[70:71], 0
    v_mfma_f32_16x16x32_bf16 v[16:19], v[96:99], v[76:79], v[16:19]
    v_mfma_f32_16x16x32_bf16 v[20:23], v[100:103], v[76:79], v[20:23]
    v_mfma_f32_16x16x32_bf16 v[16:19], v[104:107], v[80:83], v[16:19]
    v_mfma_f32_16x16x32_bf16 v[20:23], v[108:111], v[80:83], v[20:23]
    s_mov_b32 s37, s44
    s_mov_b32 s14, s45
    s_mov_b32 s44, s47
    s_xor_b32 s54, s54, 32768
    s_mov_b32 s35, s46
    s_add_u32 s42, s42, 1
    s_mov_b32 s36, 121832576
    s_sub_u32 s20, s42, s70
    s_cselect_b32 s20, s42, s20
    s_cselect_b32 s45, s71, s74
    s_cselect_b32 s21, s72, s75
    s_cselect_b32 s46, s73, s76
    s_mul_i32 s20, s20, s21
    s_add_u32 s46, s46, s20
    s_lshl_b32 s47, s45, 6
    s_add_u32 s47, s47, s46
    s_cmp_ge_u32 s46, 64
    s_cbranch_scc1 Lnj_115
    s_mul_i32 s36, s47, 1024
    s_add_u32 s36, s36, 122097664
    s_cmp_eq_u32 s45, 0
    s_cselect_b32 s36, 120265728, s36
Lnj_115:
    buffer_load_dword v12, v8, s[8:11], s36 offen sc1
    v_add_f32 v16, v16, v24
    v_add_f32 v17, v17, v25
    v_add_f32 v18, v18, v26
    v_add_f32 v19, v19, v27
    ds_write_b128 v5, v[16:19] offset:16384
    v_add_f32 v20, v20, v28
    v_add_f32 v21, v21, v29
    v_add_f32 v22, v22, v30
    v_add_f32 v23, v23, v31
    ds_write_b128 v5, v[20:23] offset:17472
    s_waitcnt vmcnt(1)
    v_max3_u32 v112, v118, v119, v44
    v_max3_u32 v113, v45, v46, v47
    v_max3_u32 v112, v112, v48, v49
    v_max3_u32 v113, v113, v50, v51
    v_max3_u32 v112, v112, v52, v53
    v_max3_u32 v113, v113, v54, v55
    v_max_u32 v112, v112, v113
    v_cmp_eq_u32 vcc, -1, v112
    s_cbranch_vccz Lpc_117
Lpmk_116:
    s_sleep 4
    buffer_load_dwordx2 v[118:119], v4, s[8:11], s28 offen sc1
    buffer_load_dwordx4 v[48:51], v3, s[8:11], s27 offen offset:0 sc1
    buffer_load_dwordx4 v[52:55], v3, s[8:11], s27 offen offset:512 sc1
    buffer_load_dwordx4 v[44:47], v3, s[8:11], s27 offen offset:1024 sc1
    s_sub_u32 s18, s18, 1
    s_cbranch_scc1 interleave_layers__memory_aug_recurrent_mem_tr__glu_gated_glu__prompt_kernel_exit
    s_waitcnt vmcnt(0)
    v_max3_u32 v112, v118, v119, v44
    v_max3_u32 v113, v45, v46, v47
    v_max3_u32 v112, v112, v48, v49
    v_max3_u32 v113, v113, v50, v51
    v_max3_u32 v112, v112, v52, v53
    v_max3_u32 v113, v113, v54, v55
    v_max_u32 v112, v112, v113
    v_cmp_eq_u32 vcc, -1, v112
    s_cbranch_vccnz Lpmk_116
Lpc_117:
    v_mfma_f32_16x16x32_bf16 v[32:35], v[48:51], v[58:61], 0
    v_mfma_f32_16x16x32_bf16 v[36:39], v[48:51], v[72:75], 0
    v_mfma_f32_16x16x16_bf16 v[24:27], v[118:119], v[56:57], 0
    v_mfma_f32_16x16x16_bf16 v[28:31], v[118:119], v[70:71], 0
    v_mfma_f32_16x16x32_bf16 v[32:35], v[52:55], v[62:65], v[32:35]
    v_mfma_f32_16x16x32_bf16 v[36:39], v[52:55], v[76:79], v[36:39]
    v_mfma_f32_16x16x32_bf16 v[32:35], v[44:47], v[66:69], v[32:35]
    v_mfma_f32_16x16x32_bf16 v[36:39], v[44:47], v[80:83], v[36:39]
    s_mul_i32 s21, s37, 4096
    s_lshl_b32 s20, s15, 7
    s_add_u32 s21, s21, s20
    s_add_u32 s21, s21, 122228736
    s_nop 2
    v_add_f32 v32, v32, v24
    v_add_f32 v33, v33, v25
    v_add_f32 v34, v34, v26
    v_add_f32 v35, v35, v27
    ds_write_b128 v5, v[32:35] offset:2176
    v_add_f32 v36, v36, v28
    v_add_f32 v37, v37, v29
    v_add_f32 v38, v38, v30
    v_add_f32 v39, v39, v31
    ds_write_b128 v5, v[36:39] offset:18560
    s_waitcnt lgkmcnt(0)
    s_barrier
    ds_read_b128 v[56:59], v6 offset:0
    ds_read_b128 v[60:63], v6 offset:4096
    ds_read_b128 v[64:67], v6 offset:8192
    ds_read_b128 v[68:71], v6 offset:12288
    ds_read_b128 v[84:87], v6 offset:16384
    ds_read_b128 v[88:91], v6 offset:20480
    ds_read_b128 v[92:95], v6 offset:24576
    ds_read_b128 v[96:99], v6 offset:28672
    s_waitcnt lgkmcnt(4)
    v_pk_add_f32 v[56:57], v[56:57], v[60:61]
    v_pk_add_f32 v[58:59], v[58:59], v[62:63]
    v_pk_add_f32 v[64:65], v[64:65], v[68:69]
    v_pk_add_f32 v[66:67], v[66:67], v[70:71]
    v_pk_add_f32 v[56:57], v[56:57], v[64:65]
    v_pk_add_f32 v[58:59], v[58:59], v[66:67]
    v_cndmask_b32 v56, v117, v56, s[82:83]
    v_cndmask_b32 v57, v117, v57, s[84:85]
    v_cndmask_b32 v58, v117, v58, s[86:87]
    v_cndmask_b32 v59, v117, v59, s[88:89]
    s_waitcnt lgkmcnt(0)
    v_pk_add_f32 v[84:85], v[84:85], v[88:89]
    v_pk_add_f32 v[86:87], v[86:87], v[90:91]
    v_pk_add_f32 v[92:93], v[92:93], v[96:97]
    v_pk_add_f32 v[94:95], v[94:95], v[98:99]
    v_pk_add_f32 v[84:85], v[84:85], v[92:93]
    v_pk_add_f32 v[86:87], v[86:87], v[94:95]
    v_cndmask_b32 v84, v117, v84, s[90:91]
    v_cndmask_b32 v85, v117, v85, s[92:93]
    v_cndmask_b32 v86, v117, v86, s[94:95]
    v_cndmask_b32 v87, v117, v87, s[96:97]
    v_max3_f32 v60, v56, v57, v58
    v_max3_f32 v88, v84, v85, v86
    v_max_f32 v60, v60, v59
    v_max_f32 v88, v88, v87
    s_nop 0
    v_max_f32_dpp v60, v60, v60 row_ror:8 row_mask:0xf bank_mask:0xf
    v_max_f32_dpp v88, v88, v88 row_ror:8 row_mask:0xf bank_mask:0xf
    s_nop 0
    v_max_f32_dpp v60, v60, v60 row_ror:4 row_mask:0xf bank_mask:0xf
    v_max_f32_dpp v88, v88, v88 row_ror:4 row_mask:0xf bank_mask:0xf
    s_nop 0
    v_max_f32_dpp v60, v60, v60 row_ror:2 row_mask:0xf bank_mask:0xf
    v_max_f32_dpp v88, v88, v88 row_ror:2 row_mask:0xf bank_mask:0xf
    s_nop 0
    v_max_f32_dpp v60, v60, v60 row_ror:1 row_mask:0xf bank_mask:0xf
    v_max_f32_dpp v88, v88, v88 row_ror:1 row_mask:0xf bank_mask:0xf
    v_sub_f32 v56, v56, v60
    v_sub_f32 v84, v84, v88
    v_sub_f32 v57, v57, v60
    v_sub_f32 v85, v85, v88
    v_sub_f32 v58, v58, v60
    v_sub_f32 v86, v86, v88
    v_sub_f32 v59, v59, v60
    v_sub_f32 v87, v87, v88
    v_exp_f32 v56, v56
    v_exp_f32 v84, v84
    v_exp_f32 v57, v57
    v_exp_f32 v85, v85
    v_exp_f32 v58, v58
    v_exp_f32 v86, v86
    v_exp_f32 v59, v59
    v_exp_f32 v87, v87
    v_add_f32 v60, v56, v57
    v_add_f32 v88, v84, v85
    v_add_f32 v61, v58, v59
    v_add_f32 v89, v86, v87
    v_add_f32 v60, v60, v61
    v_add_f32 v88, v88, v89
    s_nop 0
    v_add_f32_dpp v60, v60, v60 row_ror:8 row_mask:0xf bank_mask:0xf
    v_add_f32_dpp v88, v88, v88 row_ror:8 row_mask:0xf bank_mask:0xf
    s_nop 0
    v_add_f32_dpp v60, v60, v60 row_ror:4 row_mask:0xf bank_mask:0xf
    v_add_f32_dpp v88, v88, v88 row_ror:4 row_mask:0xf bank_mask:0xf
    s_nop 0
    v_add_f32_dpp v60, v60, v60 row_ror:2 row_mask:0xf bank_mask:0xf
    v_add_f32_dpp v88, v88, v88 row_ror:2 row_mask:0xf bank_mask:0xf
    s_nop 0
    v_add_f32_dpp v60, v60, v60 row_ror:1 row_mask:0xf bank_mask:0xf
    v_add_f32_dpp v88, v88, v88 row_ror:1 row_mask:0xf bank_mask:0xf
    v_rcp_f32 v60, v60
    v_rcp_f32 v88, v88
    s_nop 0
    v_pk_mul_f32 v[56:57], v[60:61], v[56:57] op_sel_hi:[0,1]
    v_pk_mul_f32 v[58:59], v[60:61], v[58:59] op_sel_hi:[0,1]
    v_cvt_pk_bf16_f32 v112, v56, v57
    v_cvt_pk_bf16_f32 v113, v58, v59
    v_min_u32 v112, 0xfffffffe, v112
    buffer_store_dwordx2 v[112:113], v9, s[8:11], s24 offen offset:0 sc1
    v_pk_mul_f32 v[84:85], v[88:89], v[84:85] op_sel_hi:[0,1]
    v_pk_mul_f32 v[86:87], v[88:89], v[86:87] op_sel_hi:[0,1]
    v_cvt_pk_bf16_f32 v114, v84, v85
    v_cvt_pk_bf16_f32 v115, v86, v87
    v_min_u32 v114, 0xfffffffe, v114
    buffer_store_dwordx2 v[114:115], v9, s[8:11], s24 offen offset:1024 sc1
    s_barrier
    buffer_store_dword v15, v14, s[8:11], s21 offen sc1
    s_cmp_lt_u32 s35, 64
    s_cbranch_scc1 Lp_108
    s_branch interleave_layers__memory_aug_recurrent_mem_tr__glu_gated_glu__prompt_kernel_exit
Lredo_111:
    s_sub_u32 s18, s18, 64
    s_cbranch_scc1 interleave_layers__memory_aug_recurrent_mem_tr__glu_gated_glu__prompt_kernel_exit
    s_waitcnt lgkmcnt(0)
    s_barrier
    s_branch Lnw_109
Lrole4_21:
    v_and_b32 v7, 63, v0
    v_lshlrev_b32 v1, 4, v7
    v_cmp_eq_u32 vcc, 0, v0
    v_mov_b32 v14, 2130706432
    v_mov_b32 v15, 1
    v_cndmask_b32 v14, v14, 0, vcc
    s_cmp_eq_u32 s19, 0
    s_cbranch_scc0 Lsn_119
    s_mov_b32 s70, 7
    s_mov_b32 s71, 0
    s_mov_b32 s72, 3
    s_mov_b32 s73, 0
    s_mov_b32 s74, 1
    s_mov_b32 s75, 2
    s_mov_b32 s76, 0
    s_branch Lsj_118
Lsn_119:
    s_cmp_eq_u32 s19, 1
    s_cbranch_scc0 Lsn_120
    s_mov_b32 s70, 7
    s_mov_b32 s71, 0
    s_mov_b32 s72, 3
    s_mov_b32 s73, 1
    s_mov_b32 s74, 1
    s_mov_b32 s75, 2
    s_mov_b32 s76, 1
    s_branch Lsj_118
Lsn_120:
    s_mov_b32 s70, 7
    s_mov_b32 s71, 0
    s_mov_b32 s72, 3
    s_mov_b32 s73, 2
    s_mov_b32 s74, 0
    s_mov_b32 s75, 1
    s_mov_b32 s76, 21
Lsj_118:
    s_mul_i32 s20, s15, 7
    s_add_u32 s20, s20, 112
    v_and_b32 v16, 7, v0
    v_min_u32 v16, 6, v16
    v_add_u32 v16, s20, v16
    v_mul_u32_u24 v17, 9363, v16
    v_lshrrev_b32 v17, 16, v17
    v_mul_u32_u24 v18, 7, v17
    v_sub_u32 v16, v16, v18
    v_lshrrev_b32 v18, 3, v17
    v_mul_u32_u24 v18, 7, v18
    v_add_u32 v16, v16, v18
    v_and_b32 v17, 7, v17
    v_lshl_add_u32 v16, v16, 3, v17
    v_lshlrev_b32 v16, 7, v16
    s_mov_b32 s20, 125698048
Lwd_122:
    buffer_load_dwordx2 v[18:19], v16, s[8:11], s20 offen offset:0 sc1
    s_sub_u32 s18, s18, 1
    s_cbranch_scc1 interleave_layers__memory_aug_recurrent_mem_tr__glu_gated_glu__prompt_kernel_exit
    s_waitcnt vmcnt(0)
    v_xor_b32 v18, s78, v18
    v_xor_b32 v19, s79, v19
    v_or_b32 v18, v18, v19
    v_cmp_ne_u32 vcc, 0, v18
    s_cbranch_vccz Lwdok_123
    s_sleep 2
    s_branch Lwd_122
Lwdok_123:
    s_mul_i32 s20, s15, 28
    s_mul_i32 s21, s12, 7
    s_add_u32 s30, s20, s21
    s_mul_i32 s20, s30, 14336
    s_add_u32 s20, s20, 6422528
    buffer_load_dwordx4 a[0:3], v1, s[8:11], s20 offen offset:0 sc1
    buffer_load_dwordx4 a[4:7], v1, s[8:11], s20 offen offset:1024 sc1
    buffer_load_dwordx4 a[8:11], v1, s[8:11], s20 offen offset:2048 sc1
    buffer_load_dwordx4 a[12:15], v1, s[8:11], s20 offen offset:3072 sc1
    s_add_u32 s20, s20, 4096
    buffer_load_dwordx4 a[16:19], v1, s[8:11], s20 offen offset:0 sc1
    buffer_load_dwordx4 a[20:23], v1, s[8:11], s20 offen offset:1024 sc1
    buffer_load_dwordx4 a[24:27], v1, s[8:11], s20 offen offset:2048 sc1
    buffer_load_dwordx4 a[28:31], v1, s[8:11], s20 offen offset:3072 sc1
    s_add_u32 s20, s20, 4096
    buffer_load_dwordx4 a[32:35], v1, s[8:11], s20 offen offset:0 sc1
    buffer_load_dwordx4 a[36:39], v1, s[8:11], s20 offen offset:1024 sc1
    buffer_load_dwordx4 a[40:43], v1, s[8:11], s20 offen offset:2048 sc1
    buffer_load_dwordx4 a[44:47], v1, s[8:11], s20 offen offset:3072 sc1
    s_add_u32 s20, s20, 4096
    buffer_load_dwordx4 a[48:51], v1, s[8:11], s20 offen offset:0 sc1
    buffer_load_dwordx4 a[52:55], v1, s[8:11], s20 offen offset:1024 sc1
    buffer_load_dwordx4 a[56:59], v1, s[8:11], s20 offen offset:2048 sc1
    buffer_load_dwordx4 a[60:63], v1, s[8:11], s20 offen offset:3072 sc1
    s_add_u32 s20, s20, 4096
    buffer_load_dwordx4 a[64:67], v1, s[8:11], s20 offen offset:0 sc1
    buffer_load_dwordx4 a[68:71], v1, s[8:11], s20 offen offset:1024 sc1
    buffer_load_dwordx4 a[72:75], v1, s[8:11], s20 offen offset:2048 sc1
    buffer_load_dwordx4 a[76:79], v1, s[8:11], s20 offen offset:3072 sc1
    s_add_u32 s20, s20, 4096
    buffer_load_dwordx4 a[80:83], v1, s[8:11], s20 offen offset:0 sc1
    buffer_load_dwordx4 a[84:87], v1, s[8:11], s20 offen offset:1024 sc1
    buffer_load_dwordx4 a[88:91], v1, s[8:11], s20 offen offset:2048 sc1
    buffer_load_dwordx4 a[92:95], v1, s[8:11], s20 offen offset:3072 sc1
    s_add_u32 s20, s20, 4096
    buffer_load_dwordx4 a[96:99], v1, s[8:11], s20 offen offset:0 sc1
    buffer_load_dwordx4 a[100:103], v1, s[8:11], s20 offen offset:1024 sc1
    buffer_load_dwordx4 a[104:107], v1, s[8:11], s20 offen offset:2048 sc1
    buffer_load_dwordx4 a[108:111], v1, s[8:11], s20 offen offset:3072 sc1
    s_add_u32 s20, s20, 4096
    buffer_load_dwordx4 a[112:115], v1, s[8:11], s20 offen offset:0 sc1
    buffer_load_dwordx4 a[116:119], v1, s[8:11], s20 offen offset:1024 sc1
    buffer_load_dwordx4 a[120:123], v1, s[8:11], s20 offen offset:2048 sc1
    buffer_load_dwordx4 a[124:127], v1, s[8:11], s20 offen offset:3072 sc1
    s_add_u32 s20, s20, 4096
    buffer_load_dwordx4 a[128:131], v1, s[8:11], s20 offen offset:0 sc1
    buffer_load_dwordx4 a[132:135], v1, s[8:11], s20 offen offset:1024 sc1
    buffer_load_dwordx4 a[136:139], v1, s[8:11], s20 offen offset:2048 sc1
    buffer_load_dwordx4 a[140:143], v1, s[8:11], s20 offen offset:3072 sc1
    s_add_u32 s20, s20, 4096
    buffer_load_dwordx4 a[144:147], v1, s[8:11], s20 offen offset:0 sc1
    buffer_load_dwordx4 a[148:151], v1, s[8:11], s20 offen offset:1024 sc1
    buffer_load_dwordx4 a[152:155], v1, s[8:11], s20 offen offset:2048 sc1
    buffer_load_dwordx4 a[156:159], v1, s[8:11], s20 offen offset:3072 sc1
    s_add_u32 s20, s20, 4096
    buffer_load_dwordx4 a[160:163], v1, s[8:11], s20 offen offset:0 sc1
    buffer_load_dwordx4 a[164:167], v1, s[8:11], s20 offen offset:1024 sc1
    buffer_load_dwordx4 a[168:171], v1, s[8:11], s20 offen offset:2048 sc1
    buffer_load_dwordx4 a[172:175], v1, s[8:11], s20 offen offset:3072 sc1
    s_add_u32 s20, s20, 4096
    buffer_load_dwordx4 a[176:179], v1, s[8:11], s20 offen offset:0 sc1
    buffer_load_dwordx4 a[180:183], v1, s[8:11], s20 offen offset:1024 sc1
    buffer_load_dwordx4 a[184:187], v1, s[8:11], s20 offen offset:2048 sc1
    buffer_load_dwordx4 a[188:191], v1, s[8:11], s20 offen offset:3072 sc1
    s_add_u32 s20, s20, 4096
    s_waitcnt vmcnt(40)
    buffer_load_dwordx4 a[192:195], v1, s[8:11], s20 offen offset:0 sc1
    buffer_load_dwordx4 a[196:199], v1, s[8:11], s20 offen offset:1024 sc1
    buffer_load_dwordx4 a[200:203], v1, s[8:11], s20 offen offset:2048 sc1
    buffer_load_dwordx4 a[204:207], v1, s[8:11], s20 offen offset:3072 sc1
    s_add_u32 s20, s20, 4096
    buffer_load_dwordx4 a[208:211], v1, s[8:11], s20 offen offset:0 sc1
    buffer_load_dwordx4 a[212:215], v1, s[8:11], s20 offen offset:1024 sc1
    buffer_load_dwordx4 a[216:219], v1, s[8:11], s20 offen offset:2048 sc1
    buffer_load_dwordx4 a[220:223], v1, s[8:11], s20 offen offset:3072 sc1
    s_add_u32 s20, s20, 4096
    s_waitcnt vmcnt(40)
    buffer_load_dwordx4 a[224:227], v1, s[8:11], s20 offen offset:0 sc1
    buffer_load_dwordx4 a[228:231], v1, s[8:11], s20 offen offset:1024 sc1
    buffer_load_dwordx4 a[232:235], v1, s[8:11], s20 offen offset:2048 sc1
    buffer_load_dwordx4 a[236:239], v1, s[8:11], s20 offen offset:3072 sc1
    s_add_u32 s20, s20, 4096
    buffer_load_dwordx4 a[240:243], v1, s[8:11], s20 offen offset:0 sc1
    buffer_load_dwordx4 a[244:247], v1, s[8:11], s20 offen offset:1024 sc1
    buffer_load_dwordx4 a[248:251], v1, s[8:11], s20 offen offset:2048 sc1
    buffer_load_dwordx4 a[252:255], v1, s[8:11], s20 offen offset:3072 sc1
    s_add_u32 s20, s20, 4096
    s_waitcnt vmcnt(40)
    buffer_load_dwordx4 v[120:123], v1, s[8:11], s20 offen offset:0 sc1
    buffer_load_dwordx4 v[124:127], v1, s[8:11], s20 offen offset:1024 sc1
    buffer_load_dwordx4 v[128:131], v1, s[8:11], s20 offen offset:2048 sc1
    buffer_load_dwordx4 v[132:135], v1, s[8:11], s20 offen offset:3072 sc1
    s_add_u32 s20, s20, 4096
    buffer_load_dwordx4 v[136:139], v1, s[8:11], s20 offen offset:0 sc1
    buffer_load_dwordx4 v[140:143], v1, s[8:11], s20 offen offset:1024 sc1
    buffer_load_dwordx4 v[144:147], v1, s[8:11], s20 offen offset:2048 sc1
    buffer_load_dwordx4 v[148:151], v1, s[8:11], s20 offen offset:3072 sc1
    s_add_u32 s20, s20, 4096
    s_waitcnt vmcnt(40)
    buffer_load_dwordx4 v[152:155], v1, s[8:11], s20 offen offset:0 sc1
    buffer_load_dwordx4 v[156:159], v1, s[8:11], s20 offen offset:1024 sc1
    buffer_load_dwordx4 v[160:163], v1, s[8:11], s20 offen offset:2048 sc1
    buffer_load_dwordx4 v[164:167], v1, s[8:11], s20 offen offset:3072 sc1
    s_add_u32 s20, s20, 4096
    buffer_load_dwordx4 v[168:171], v1, s[8:11], s20 offen offset:0 sc1
    buffer_load_dwordx4 v[172:175], v1, s[8:11], s20 offen offset:1024 sc1
    buffer_load_dwordx4 v[176:179], v1, s[8:11], s20 offen offset:2048 sc1
    buffer_load_dwordx4 v[180:183], v1, s[8:11], s20 offen offset:3072 sc1
    s_add_u32 s20, s20, 4096
    s_waitcnt vmcnt(40)
    buffer_load_dwordx4 v[184:187], v1, s[8:11], s20 offen offset:0 sc1
    buffer_load_dwordx4 v[188:191], v1, s[8:11], s20 offen offset:1024 sc1
    buffer_load_dwordx4 v[192:195], v1, s[8:11], s20 offen offset:2048 sc1
    buffer_load_dwordx4 v[196:199], v1, s[8:11], s20 offen offset:3072 sc1
    s_add_u32 s20, s20, 4096
    buffer_load_dwordx4 v[200:203], v1, s[8:11], s20 offen offset:0 sc1
    buffer_load_dwordx4 v[204:207], v1, s[8:11], s20 offen offset:1024 sc1
    buffer_load_dwordx4 v[208:211], v1, s[8:11], s20 offen offset:2048 sc1
    buffer_load_dwordx4 v[212:215], v1, s[8:11], s20 offen offset:3072 sc1
    s_add_u32 s20, s20, 4096
    s_waitcnt vmcnt(40)
    buffer_load_dwordx4 v[216:219], v1, s[8:11], s20 offen offset:0 sc1
    buffer_load_dwordx4 v[220:223], v1, s[8:11], s20 offen offset:1024 sc1
    buffer_load_dwordx4 v[224:227], v1, s[8:11], s20 offen offset:2048 sc1
    buffer_load_dwordx4 v[228:231], v1, s[8:11], s20 offen offset:3072 sc1
    s_add_u32 s20, s20, 4096
    buffer_load_dwordx4 v[232:235], v1, s[8:11], s20 offen offset:0 sc1
    buffer_load_dwordx4 v[236:239], v1, s[8:11], s20 offen offset:1024 sc1
    buffer_load_dwordx4 v[240:243], v1, s[8:11], s20 offen offset:2048 sc1
    buffer_load_dwordx4 v[244:247], v1, s[8:11], s20 offen offset:3072 sc1
    s_add_u32 s20, s20, 4096
    s_waitcnt vmcnt(40)
    buffer_load_dwordx4 v[248:251], v1, s[8:11], s20 offen offset:0 sc1
    buffer_load_dwordx4 v[252:255], v1, s[8:11], s20 offen offset:1024 sc1
    s_lshl_b32 s30, s30, 10
    s_mul_i32 s31, s12, 7168
    v_and_b32 v8, 7, v7
    v_min_u32 v8, 6, v8
    v_lshlrev_b32 v8, 7, v8
    v_min_u32 v3, 55, v7
    v_lshlrev_b32 v3, 7, v3
    s_mov_b32 s42, 0
    v_lshlrev_b32 v16, 7, v0
    s_mov_b32 s20, 125698048
Lwd_124:
    buffer_load_dwordx2 v[18:19], v16, s[8:11], s20 offen offset:0 sc1
    s_sub_u32 s18, s18, 1
    s_cbranch_scc1 interleave_layers__memory_aug_recurrent_mem_tr__glu_gated_glu__prompt_kernel_exit
    s_waitcnt vmcnt(0)
    v_xor_b32 v18, s78, v18
    v_xor_b32 v19, s79, v19
    v_or_b32 v18, v18, v19
    v_cmp_ne_u32 vcc, 0, v18
    s_cbranch_vccz Lwdok_125
    s_sleep 2
    s_branch Lwd_124
Lwdok_125:
    s_barrier
    s_lshl_b32 s20, s12, 2
    s_add_u32 s20, s20, 147392
    v_mov_b32 v10, s20
    v_mov_b32 v11, 147392
    s_mov_b32 s56, s4
    s_mov_b32 s57, s5
    s_mov_b32 s58, 0
    s_mov_b32 s59, 0x20000
    s_mov_b32 s52, 0
    s_mov_b32 s53, 125566976
    s_mov_b32 s54, 0
    s_sub_u32 s20, s42, s70
    s_cselect_b32 s20, s42, s20
    s_cselect_b32 s14, s71, s74
    s_cselect_b32 s21, s72, s75
    s_cselect_b32 s43, s73, s76
    s_mul_i32 s20, s20, s21
    s_add_u32 s43, s43, s20
    s_lshl_b32 s44, s14, 6
    s_add_u32 s44, s44, s43
    s_cmp_ge_u32 s43, 64
    s_cbranch_scc1 interleave_layers__memory_aug_recurrent_mem_tr__glu_gated_glu__prompt_kernel_exit
    s_add_u32 s42, s42, 1
    s_mov_b32 s25, 121832576
    s_sub_u32 s20, s42, s70
    s_cselect_b32 s20, s42, s20
    s_cselect_b32 s45, s71, s74
    s_cselect_b32 s21, s72, s75
    s_cselect_b32 s46, s73, s76
    s_mul_i32 s20, s20, s21
    s_add_u32 s46, s46, s20
    s_lshl_b32 s47, s45, 6
    s_add_u32 s47, s47, s46
    s_cmp_ge_u32 s46, 64
    s_cbranch_scc1 Lnj_132
    s_mul_i32 s25, s47, 1024
    s_add_u32 s25, s25, 122097664
    s_cmp_eq_u32 s45, 0
    s_cselect_b32 s25, 120265728, s25
Lnj_132:
    buffer_load_dword v9, v8, s[8:11], s25 offen sc1
Lvx_126:
    s_cmp_eq_u32 s52, 1
    s_cbranch_scc1 Lhv_128
    s_waitcnt vmcnt(0)
    s_barrier
    buffer_store_dword v15, v14, s[8:11], s53 offen sc1
    s_mov_b32 s53, 125566976
    s_cmp_eq_u32 s14, 0
    s_cbranch_scc1 Lnw_127
    s_mul_i32 s22, s44, 1024
    s_add_u32 s22, s22, 122097664
Lwf_133:
    buffer_load_dword v12, v8, s[8:11], s22 offen sc1
    s_sub_u32 s18, s18, 1
    s_cbranch_scc1 interleave_layers__memory_aug_recurrent_mem_tr__glu_gated_glu__prompt_kernel_exit
    s_waitcnt vmcnt(0)
    v_cmp_eq_u32 vcc, 0, v12
    s_cbranch_vccz Lwfok_134
    s_sleep 2
    s_branch Lwf_133
Lwfok_134:
Lnw_127:
    s_mul_i32 s22, s44, 28672
    s_add_u32 s22, s22, s31
    s_add_u32 s22, s22, 12845056
    s_mov_b32 s23, s54
    s_add_u32 s23, s23, s31
    s_mov_b32 m0, s23
    s_add_u32 s23, s23, 4096
    buffer_load_dwordx4 v1, s[8:11], s22 offen offset:0 sc1 lds
    buffer_load_dwordx4 v1, s[8:11], s22 offen offset:1024 sc1 lds
    buffer_load_dwordx4 v1, s[8:11], s22 offen offset:2048 sc1 lds
    buffer_load_dwordx4 v1, s[8:11], s22 offen offset:3072 sc1 lds
    s_add_u32 s22, s22, 4096
    s_mov_b32 m0, s23
    s_add_u32 s23, s23, 4096
    buffer_load_dwordx4 v1, s[8:11], s22 offen offset:0 sc1 lds
    buffer_load_dwordx4 v1, s[8:11], s22 offen offset:1024 sc1 lds
    buffer_load_dwordx4 v1, s[8:11], s22 offen offset:2048 sc1 lds
Lnw_127_j:
    buffer_load_dword v9, v8, s[8:11], s25 offen sc1
    s_waitcnt vmcnt(0)
    s_branch Lgo_129
Lhv_128:
    s_waitcnt vmcnt(7)
Lgo_129:
    v_add_u32 v2, s54, v1
    s_mul_i32 s24, s44, 458752
    s_add_u32 s24, s24, s30
    s_add_u32 s24, s24, 40370176
Lrun_131:
    s_mul_i32 s22, s47, 28672
    s_add_u32 s22, s22, s31
    s_add_u32 s22, s22, 12845056
    s_xor_b32 s23, s54, 28672
    s_add_u32 s23, s23, s31
    v_cmp_eq_u32 vcc, 0, v9
    s_nop 1
    v_mov_b32 v12, vcc_lo
    v_or_b32 v12, vcc_hi, v12
    ds_write_b32 v10, v12
    s_waitcnt lgkmcnt(0)
    s_barrier
    ds_read_b32 v12, v11
    ds_read_b128 v[72:75], v2 offset:0
    ds_read_b128 v[76:79], v2 offset:14336
    ds_read_b128 v[80:83], v2 offset:1024
    ds_read_b128 v[84:87], v2 offset:15360
    s_waitcnt lgkmcnt(4)
    v_readfirstlane_b32 s20, v12
    s_cmp_eq_u32 s20, 0
    s_cselect_b32 s52, 1, 0
    s_cselect_b32 s58, 0x10000000, 0
    s_waitcnt lgkmcnt(2)
    v_mfma_f32_16x16x32_bf16 v[16:19], v[72:75], a[0:3], 0
    ds_read_b128 v[88:91], v2 offset:2048
    v_mfma_f32_16x16x32_bf16 v[44:47], v[76:79], a[0:3], 0
    v_max_u32 v106, v72, v76
    v_mfma_f32_16x16x32_bf16 v[20:23], v[72:75], a[56:59], 0
    v_mfma_f32_16x16x32_bf16 v[48:51], v[76:79], a[56:59], 0
    ds_read_b128 v[92:95], v2 offset:16384
    v_mfma_f32_16x16x32_bf16 v[24:27], v[72:75], a[112:115], 0
    v_mfma_f32_16x16x32_bf16 v[52:55], v[76:79], a[112:115], 0
    v_mfma_f32_16x16x32_bf16 v[28:31], v[72:75], a[168:171], 0
    s_mov_b32 m0, s23
    v_mfma_f32_16x16x32_bf16 v[56:59], v[76:79], a[168:171], 0
    s_add_u32 s23, s23, 4096
    v_mfma_f32_16x16x32_bf16 v[32:35], v[72:75], a[224:227], 0
    buffer_load_dwordx4 v1, s[56:59], s22 offen offset:0 sc1 lds
    v_mfma_f32_16x16x32_bf16 v[60:63], v[76:79], a[224:227], 0
    v_mfma_f32_16x16x32_bf16 v[36:39], v[72:75], v[144:147], 0
    v_mfma_f32_16x16x32_bf16 v[64:67], v[76:79], v[144:147], 0
    v_mfma_f32_16x16x32_bf16 v[40:43], v[72:75], v[200:203], 0
    v_mfma_f32_16x16x32_bf16 v[68:71], v[76:79], v[200:203], 0
    s_waitcnt lgkmcnt(2)
    v_mfma_f32_16x16x32_bf16 v[16:19], v[80:83], a[4:7], v[16:19]
    ds_read_b128 v[72:75], v2 offset:3072
    v_mfma_f32_16x16x32_bf16 v[44:47], v[84:87], a[4:7], v[44:47]
    v_max3_u32 v106, v106, v80, v84
    v_mfma_f32_16x16x32_bf16 v[20:23], v[80:83], a[60:63], v[20:23]
    v_mfma_f32_16x16x32_bf16 v[48:51], v[84:87], a[60:63], v[48:51]
    ds_read_b128 v[76:79], v2 offset:17408
    v_mfma_f32_16x16x32_bf16 v[24:27], v[80:83], a[116:119], v[24:27]
    v_mfma_f32_16x16x32_bf16 v[52:55], v[84:87], a[116:119], v[52:55]
    v_mfma_f32_16x16x32_bf16 v[28:31], v[80:83], a[172:175], v[28:31]
    buffer_load_dwordx4 v1, s[56:59], s22 offen offset:1024 sc1 lds
    v_mfma_f32_16x16x32_bf16 v[56:59], v[84:87], a[172:175], v[56:59]
    v_mfma_f32_16x16x32_bf16 v[32:35], v[80:83], a[228:231], v[32:35]
    v_mfma_f32_16x16x32_bf16 v[60:63], v[84:87], a[228:231], v[60:63]
    v_mfma_f32_16x16x32_bf16 v[36:39], v[80:83], v[148:151], v[36:39]
    v_mfma_f32_16x16x32_bf16 v[64:67], v[84:87], v[148:151], v[64:67]
    v_mfma_f32_16x16x32_bf16 v[40:43], v[80:83], v[204:207], v[40:43]
    v_mfma_f32_16x16x32_bf16 v[68:71], v[84:87], v[204:207], v[68:71]
    s_waitcnt lgkmcnt(2)
    v_mfma_f32_16x16x32_bf16 v[16:19], v[88:91], a[8:11], v[16:19]
    ds_read_b128 v[80:83], v2 offset:4096
    v_mfma_f32_16x16x32_bf16 v[44:47], v[92:95], a[8:11], v[44:47]
    v_max3_u32 v106, v106, v88, v92
    v_mfma_f32_16x16x32_bf16 v[20:23], v[88:91], a[64:67], v[20:23]
    v_mfma_f32_16x16x32_bf16 v[48:51], v[92:95], a[64:67], v[48:51]
    ds_read_b128 v[84:87], v2 offset:18432
    v_mfma_f32_16x16x32_bf16 v[24:27], v[88:91], a[120:123], v[24:27]
    v_mfma_f32_16x16x32_bf16 v[52:55], v[92:95], a[120:123], v[52:55]
    v_mfma_f32_16x16x32_bf16 v[28:31], v[88:91], a[176:179], v[28:31]
    buffer_load_dwordx4 v1, s[56:59], s22 offen offset:2048 sc1 lds
    v_mfma_f32_16x16x32_bf16 v[56:59], v[92:95], a[176:179], v[56:59]
    v_mfma_f32_16x16x32_bf16 v[32:35], v[88:91], a[232:235], v[32:35]
    v_mfma_f32_16x16x32_bf16 v[60:63], v[92:95], a[232:235], v[60:63]
    v_mfma_f32_16x16x32_bf16 v[36:39], v[88:91], v[152:155], v[36:39]
    v_mfma_f32_16x16x32_bf16 v[64:67], v[92:95], v[152:155], v[64:67]
    v_mfma_f32_16x16x32_bf16 v[40:43], v[88:91], v[208:211], v[40:43]
    v_mfma_f32_16x16x32_bf16 v[68:71], v[92:95], v[208:211], v[68:71]
    s_waitcnt lgkmcnt(2)
    v_mfma_f32_16x16x32_bf16 v[16:19], v[72:75], a[12:15], v[16:19]
    ds_read_b128 v[88:91], v2 offset:5120
    v_mfma_f32_16x16x32_bf16 v[44:47], v[76:79], a[12:15], v[44:47]
    v_max3_u32 v106, v106, v72, v76
    v_mfma_f32_16x16x32_bf16 v[20:23], v[72:75], a[68:71], v[20:23]
    v_mfma_f32_16x16x32_bf16 v[48:51], v[76:79], a[68:71], v[48:51]
    ds_read_b128 v[92:95], v2 offset:19456
    v_mfma_f32_16x16x32_bf16 v[24:27], v[72:75], a[124:127], v[24:27]
    v_mfma_f32_16x16x32_bf16 v[52:55], v[76:79], a[124:127], v[52:55]
    v_mfma_f32_16x16x32_bf16 v[28:31], v[72:75], a[180:183], v[28:31]
    buffer_load_dwordx4 v1, s[56:59], s22 offen offset:3072 sc1 lds
    v_mfma_f32_16x16x32_bf16 v[56:59], v[76:79], a[180:183], v[56:59]
    v_mfma_f32_16x16x32_bf16 v[32:35], v[72:75], a[236:239], v[32:35]
    v_mfma_f32_16x16x32_bf16 v[60:63], v[76:79], a[236:239], v[60:63]
    v_mfma_f32_16x16x32_bf16 v[36:39], v[72:75], v[156:159], v[36:39]
    v_mfma_f32_16x16x32_bf16 v[64:67], v[76:79], v[156:159], v[64:67]
    v_mfma_f32_16x16x32_bf16 v[40:43], v[72:75], v[212:215], v[40:43]
    v_mfma_f32_16x16x32_bf16 v[68:71], v[76:79], v[212:215], v[68:71]
    s_waitcnt lgkmcnt(2)
    v_mfma_f32_16x16x32_bf16 v[16:19], v[80:83], a[16:19], v[16:19]
    ds_read_b128 v[72:75], v2 offset:6144
    v_mfma_f32_16x16x32_bf16 v[44:47], v[84:87], a[16:19], v[44:47]
    v_max3_u32 v106, v106, v80, v84
    v_mfma_f32_16x16x32_bf16 v[20:23], v[80:83], a[72:75], v[20:23]
    v_mfma_f32_16x16x32_bf16 v[48:51], v[84:87], a[72:75], v[48:51]
    ds_read_b128 v[76:79], v2 offset:20480
    v_mfma_f32_16x16x32_bf16 v[24:27], v[80:83], a[128:131], v[24:27]
    v_mfma_f32_16x16x32_bf16 v[52:55], v[84:87], a[128:131], v[52:55]
    v_mfma_f32_16x16x32_bf16 v[28:31], v[80:83], a[184:187], v[28:31]
    s_add_u32 s22, s22, 4096
    v_mfma_f32_16x16x32_bf16 v[56:59], v[84:87], a[184:187], v[56:59]
    s_mov_b32 m0, s23
    v_mfma_f32_16x16x32_bf16 v[32:35], v[80:83], a[240:243], v[32:35]
    s_add_u32 s23, s23, 4096
    v_mfma_f32_16x16x32_bf16 v[60:63], v[84:87], a[240:243], v[60:63]
    buffer_load_dwordx4 v1, s[56:59], s22 offen offset:0 sc1 lds
    v_mfma_f32_16x16x32_bf16 v[36:39], v[80:83], v[160:163], v[36:39]
    v_mfma_f32_16x16x32_bf16 v[64:67], v[84:87], v[160:163], v[64:67]
    v_mfma_f32_16x16x32_bf16 v[40:43], v[80:83], v[216:219], v[40:43]
    v_mfma_f32_16x16x32_bf16 v[68:71], v[84:87], v[216:219], v[68:71]
    s_waitcnt lgkmcnt(2)
    v_mfma_f32_16x16x32_bf16 v[16:19], v[88:91], a[20:23], v[16:19]
    ds_read_b128 v[80:83], v2 offset:7168
    v_mfma_f32_16x16x32_bf16 v[44:47], v[92:95], a[20:23], v[44:47]
    v_max3_u32 v106, v106, v88, v92
    v_mfma_f32_16x16x32_bf16 v[20:23], v[88:91], a[76:79], v[20:23]
    v_mfma_f32_16x16x32_bf16 v[48:51], v[92:95], a[76:79], v[48:51]
    ds_read_b128 v[84:87], v2 offset:21504
    v_mfma_f32_16x16x32_bf16 v[24:27], v[88:91], a[132:135], v[24:27]
    s_waitcnt vmcnt(5)
    s_barrier
    v_mfma_f32_16x16x32_bf16 v[52:55], v[92:95], a[132:135], v[52:55]
    buffer_store_dword v15, v14, s[8:11], s53 offen sc1
    v_mfma_f32_16x16x32_bf16 v[28:31], v[88:91], a[188:191], v[28:31]
    buffer_load_dwordx4 v1, s[56:59], s22 offen offset:1024 sc1 lds
    s_mov_b32 s53, 125566976
    v_mfma_f32_16x16x32_bf16 v[56:59], v[92:95], a[188:191], v[56:59]
    v_mfma_f32_16x16x32_bf16 v[32:35], v[88:91], a[244:247], v[32:35]
    v_mfma_f32_16x16x32_bf16 v[60:63], v[92:95], a[244:247], v[60:63]
    v_mfma_f32_16x16x32_bf16 v[36:39], v[88:91], v[164:167], v[36:39]
    v_mfma_f32_16x16x32_bf16 v[64:67], v[92:95], v[164:167], v[64:67]
    v_mfma_f32_16x16x32_bf16 v[40:43], v[88:91], v[220:223], v[40:43]
    v_mfma_f32_16x16x32_bf16 v[68:71], v[92:95], v[220:223], v[68:71]
    s_waitcnt lgkmcnt(2)
    v_mfma_f32_16x16x32_bf16 v[16:19], v[72:75], a[24:27], v[16:19]
    ds_read_b128 v[88:91], v2 offset:8192
    v_mfma_f32_16x16x32_bf16 v[44:47], v[76:79], a[24:27], v[44:47]
    v_max3_u32 v106, v106, v72, v76
    v_mfma_f32_16x16x32_bf16 v[20:23], v[72:75], a[80:83], v[20:23]
    v_mfma_f32_16x16x32_bf16 v[48:51], v[76:79], a[80:83], v[48:51]
    ds_read_b128 v[92:95], v2 offset:22528
    v_mfma_f32_16x16x32_bf16 v[24:27], v[72:75], a[136:139], v[24:27]
    v_mfma_f32_16x16x32_bf16 v[52:55], v[76:79], a[136:139], v[52:55]
    v_mfma_f32_16x16x32_bf16 v[28:31], v[72:75], a[192:195], v[28:31]
    buffer_load_dwordx4 v1, s[56:59], s22 offen offset:2048 sc1 lds
    v_mfma_f32_16x16x32_bf16 v[56:59], v[76:79], a[192:195], v[56:59]
    v_mfma_f32_16x16x32_bf16 v[32:35], v[72:75], a[248:251], v[32:35]
    v_mfma_f32_16x16x32_bf16 v[60:63], v[76:79], a[248:251], v[60:63]
    v_mfma_f32_16x16x32_bf16 v[36:39], v[72:75], v[168:171], v[36:39]
    v_mfma_f32_16x16x32_bf16 v[64:67], v[76:79], v[168:171], v[64:67]
    v_mfma_f32_16x16x32_bf16 v[40:43], v[72:75], v[224:227], v[40:43]
    v_mfma_f32_16x16x32_bf16 v[68:71], v[76:79], v[224:227], v[68:71]
    s_waitcnt lgkmcnt(2)
    v_mfma_f32_16x16x32_bf16 v[16:19], v[80:83], a[28:31], v[16:19]
    ds_read_b128 v[72:75], v2 offset:9216
    v_mfma_f32_16x16x32_bf16 v[44:47], v[84:87], a[28:31], v[44:47]
    v_max3_u32 v106, v106, v80, v84
    v_mfma_f32_16x16x32_bf16 v[20:23], v[80:83], a[84:87], v[20:23]
    v_mfma_f32_16x16x32_bf16 v[48:51], v[84:87], a[84:87], v[48:51]
    ds_read_b128 v[76:79], v2 offset:23552
    v_mfma_f32_16x16x32_bf16 v[24:27], v[80:83], a[140:143], v[24:27]
    v_mfma_f32_16x16x32_bf16 v[52:55], v[84:87], a[140:143], v[52:55]
    v_mfma_f32_16x16x32_bf16 v[28:31], v[80:83], a[196:199], v[28:31]
    v_mfma_f32_16x16x32_bf16 v[56:59], v[84:87], a[196:199], v[56:59]
    v_mfma_f32_16x16x32_bf16 v[32:35], v[80:83], a[252:255], v[32:35]
    v_mfma_f32_16x16x32_bf16 v[60:63], v[84:87], a[252:255], v[60:63]
    v_mfma_f32_16x16x32_bf16 v[36:39], v[80:83], v[172:175], v[36:39]
    v_mfma_f32_16x16x32_bf16 v[64:67], v[84:87], v[172:175], v[64:67]
    v_mfma_f32_16x16x32_bf16 v[40:43], v[80:83], v[228:231], v[40:43]
    v_mfma_f32_16x16x32_bf16 v[68:71], v[84:87], v[228:231], v[68:71]
    s_waitcnt lgkmcnt(2)
    v_mfma_f32_16x16x32_bf16 v[16:19], v[88:91], a[32:35], v[16:19]
    ds_read_b128 v[80:83], v2 offset:10240
    v_mfma_f32_16x16x32_bf16 v[44:47], v[92:95], a[32:35], v[44:47]
    v_max3_u32 v106, v106, v88, v92
    v_mfma_f32_16x16x32_bf16 v[20:23], v[88:91], a[88:91], v[20:23]
    v_mfma_f32_16x16x32_bf16 v[48:51], v[92:95], a[88:91], v[48:51]
    ds_read_b128 v[84:87], v2 offset:24576
    v_mfma_f32_16x16x32_bf16 v[24:27], v[88:91], a[144:147], v[24:27]
    v_mfma_f32_16x16x32_bf16 v[52:55], v[92:95], a[144:147], v[52:55]
    v_mfma_f32_16x16x32_bf16 v[28:31], v[88:91], a[200:203], v[28:31]
    v_mfma_f32_16x16x32_bf16 v[56:59], v[92:95], a[200:203], v[56:59]
    v_mfma_f32_16x16x32_bf16 v[32:35], v[88:91], v[120:123], v[32:35]
    v_mfma_f32_16x16x32_bf16 v[60:63], v[92:95], v[120:123], v[60:63]
    v_mfma_f32_16x16x32_bf16 v[36:39], v[88:91], v[176:179], v[36:39]
    v_mfma_f32_16x16x32_bf16 v[64:67], v[92:95], v[176:179], v[64:67]
    v_mfma_f32_16x16x32_bf16 v[40:43], v[88:91], v[232:235], v[40:43]
    v_mfma_f32_16x16x32_bf16 v[68:71], v[92:95], v[232:235], v[68:71]
    s_waitcnt lgkmcnt(2)
    v_mfma_f32_16x16x32_bf16 v[16:19], v[72:75], a[36:39], v[16:19]
    ds_read_b128 v[88:91], v2 offset:11264
    v_mfma_f32_16x16x32_bf16 v[44:47], v[76:79], a[36:39], v[44:47]
    v_max3_u32 v106, v106, v72, v76
    v_mfma_f32_16x16x32_bf16 v[20:23], v[72:75], a[92:95], v[20:23]
    v_mfma_f32_16x16x32_bf16 v[48:51], v[76:79], a[92:95], v[48:51]
    ds_read_b128 v[92:95], v2 offset:25600
    v_mfma_f32_16x16x32_bf16 v[24:27], v[72:75], a[148:151], v[24:27]
    v_mfma_f32_16x16x32_bf16 v[52:55], v[76:79], a[148:151], v[52:55]
    v_mfma_f32_16x16x32_bf16 v[28:31], v[72:75], a[204:207], v[28:31]
    v_mfma_f32_16x16x32_bf16 v[56:59], v[76:79], a[204:207], v[56:59]
    v_mfma_f32_16x16x32_bf16 v[32:35], v[72:75], v[124:127], v[32:35]
    v_mfma_f32_16x16x32_bf16 v[60:63], v[76:79], v[124:127], v[60:63]
    v_mfma_f32_16x16x32_bf16 v[36:39], v[72:75], v[180:183], v[36:39]
    v_mfma_f32_16x16x32_bf16 v[64:67], v[76:79], v[180:183], v[64:67]
    v_mfma_f32_16x16x32_bf16 v[40:43], v[72:75], v[236:239], v[40:43]
    v_mfma_f32_16x16x32_bf16 v[68:71], v[76:79], v[236:239], v[68:71]
    s_waitcnt lgkmcnt(2)
    v_mfma_f32_16x16x32_bf16 v[16:19], v[80:83], a[40:43], v[16:19]
    ds_read_b128 v[72:75], v2 offset:12288
    v_mfma_f32_16x16x32_bf16 v[44:47], v[84:87], a[40:43], v[44:47]
    v_max3_u32 v106, v106, v80, v84
    v_mfma_f32_16x16x32_bf16 v[20:23], v[80:83], a[96:99], v[20:23]
    v_mfma_f32_16x16x32_bf16 v[48:51], v[84:87], a[96:99], v[48:51]
    ds_read_b128 v[76:79], v2 offset:26624
    v_mfma_f32_16x16x32_bf16 v[24:27], v[80:83], a[152:155], v[24:27]
    v_mfma_f32_16x16x32_bf16 v[52:55], v[84:87], a[152:155], v[52:55]
    v_mfma_f32_16x16x32_bf16 v[28:31], v[80:83], a[208:211], v[28:31]
    v_mfma_f32_16x16x32_bf16 v[56:59], v[84:87], a[208:211], v[56:59]
    v_mfma_f32_16x16x32_bf16 v[32:35], v[80:83], v[128:131], v[32:35]
    v_mfma_f32_16x16x32_bf16 v[60:63], v[84:87], v[128:131], v[60:63]
    v_mfma_f32_16x16x32_bf16 v[36:39], v[80:83], v[184:187], v[36:39]
    v_mfma_f32_16x16x32_bf16 v[64:67], v[84:87], v[184:187], v[64:67]
    v_mfma_f32_16x16x32_bf16 v[40:43], v[80:83], v[240:243], v[40:43]
    v_mfma_f32_16x16x32_bf16 v[68:71], v[84:87], v[240:243], v[68:71]
    s_waitcnt lgkmcnt(2)
    v_mfma_f32_16x16x32_bf16 v[16:19], v[88:91], a[44:47], v[16:19]
    ds_read_b128 v[80:83], v2 offset:13312
    v_mfma_f32_16x16x32_bf16 v[44:47], v[92:95], a[44:47], v[44:47]
    v_max3_u32 v106, v106, v88, v92
    v_mfma_f32_16x16x32_bf16 v[20:23], v[88:91], a[100:103], v[20:23]
    v_mfma_f32_16x16x32_bf16 v[48:51], v[92:95], a[100:103], v[48:51]
    ds_read_b128 v[84:87], v2 offset:27648
    v_mfma_f32_16x16x32_bf16 v[24:27], v[88:91], a[156:159], v[24:27]
    v_mfma_f32_16x16x32_bf16 v[52:55], v[92:95], a[156:159], v[52:55]
    v_mfma_f32_16x16x32_bf16 v[28:31], v[88:91], a[212:215], v[28:31]
    v_mfma_f32_16x16x32_bf16 v[56:59], v[92:95], a[212:215], v[56:59]
    v_mfma_f32_16x16x32_bf16 v[32:35], v[88:91], v[132:135], v[32:35]
    v_mfma_f32_16x16x32_bf16 v[60:63], v[92:95], v[132:135], v[60:63]
    v_mfma_f32_16x16x32_bf16 v[36:39], v[88:91], v[188:191], v[36:39]
    v_mfma_f32_16x16x32_bf16 v[64:67], v[92:95], v[188:191], v[64:67]
    v_mfma_f32_16x16x32_bf16 v[40:43], v[88:91], v[244:247], v[40:43]
    v_mfma_f32_16x16x32_bf16 v[68:71], v[92:95], v[244:247], v[68:71]
    s_waitcnt lgkmcnt(2)
    v_mfma_f32_16x16x32_bf16 v[16:19], v[72:75], a[48:51], v[16:19]
    v_mfma_f32_16x16x32_bf16 v[44:47], v[76:79], a[48:51], v[44:47]
    v_max3_u32 v106, v106, v72, v76
    v_mfma_f32_16x16x32_bf16 v[20:23], v[72:75], a[104:107], v[20:23]
    v_mfma_f32_16x16x32_bf16 v[48:51], v[76:79], a[104:107], v[48:51]
    v_mfma_f32_16x16x32_bf16 v[24:27], v[72:75], a[160:163], v[24:27]
    v_mfma_f32_16x16x32_bf16 v[52:55], v[76:79], a[160:163], v[52:55]
    v_mfma_f32_16x16x32_bf16 v[28:31], v[72:75], a[216:219], v[28:31]
    v_mfma_f32_16x16x32_bf16 v[56:59], v[76:79], a[216:219], v[56:59]
    v_mfma_f32_16x16x32_bf16 v[32:35], v[72:75], v[136:139], v[32:35]
    v_mfma_f32_16x16x32_bf16 v[60:63], v[76:79], v[136:139], v[60:63]
    v_mfma_f32_16x16x32_bf16 v[36:39], v[72:75], v[192:195], v[36:39]
    v_mfma_f32_16x16x32_bf16 v[64:67], v[76:79], v[192:195], v[64:67]
    v_mfma_f32_16x16x32_bf16 v[40:43], v[72:75], v[248:251], v[40:43]
    v_mfma_f32_16x16x32_bf16 v[68:71], v[76:79], v[248:251], v[68:71]
    s_waitcnt lgkmcnt(0)
    v_mfma_f32_16x16x32_bf16 v[16:19], v[80:83], a[52:55], v[16:19]
    v_mfma_f32_16x16x32_bf16 v[44:47], v[84:87], a[52:55], v[44:47]
    v_max3_u32 v106, v106, v80, v84
    v_mfma_f32_16x16x32_bf16 v[20:23], v[80:83], a[108:111], v[20:23]
    v_mfma_f32_16x16x32_bf16 v[48:51], v[84:87], a[108:111], v[48:51]
    v_mfma_f32_16x16x32_bf16 v[24:27], v[80:83], a[164:167], v[24:27]
    v_mfma_f32_16x16x32_bf16 v[52:55], v[84:87], a[164:167], v[52:55]
    v_mfma_f32_16x16x32_bf16 v[28:31], v[80:83], a[220:223], v[28:31]
    v_mfma_f32_16x16x32_bf16 v[56:59], v[84:87], a[220:223], v[56:59]
    v_mfma_f32_16x16x32_bf16 v[32:35], v[80:83], v[140:143], v[32:35]
    v_mfma_f32_16x16x32_bf16 v[60:63], v[84:87], v[140:143], v[60:63]
    v_mfma_f32_16x16x32_bf16 v[36:39], v[80:83], v[196:199], v[36:39]
    v_mfma_f32_16x16x32_bf16 v[64:67], v[84:87], v[196:199], v[64:67]
    v_mfma_f32_16x16x32_bf16 v[40:43], v[80:83], v[252:255], v[40:43]
    v_mfma_f32_16x16x32_bf16 v[68:71], v[84:87], v[252:255], v[68:71]
    v_cmp_eq_u32 vcc, -1, v106
    s_cbranch_vccnz Lredo_130
    s_mul_i32 s53, s44, 2048
    s_lshl_b32 s20, s15, 7
    s_add_u32 s53, s53, s20
    s_add_u32 s53, s53, 121835520
    s_mov_b32 s14, s45
    s_mov_b32 s43, s46
    s_mov_b32 s44, s47
    s_xor_b32 s54, s54, 28672
    s_mov_b32 s35, s46
    s_add_u32 s42, s42, 1
    s_mov_b32 s25, 121832576
    s_sub_u32 s20, s42, s70
    s_cselect_b32 s20, s42, s20
    s_cselect_b32 s45, s71, s74
    s_cselect_b32 s21, s72, s75
    s_cselect_b32 s46, s73, s76
    s_mul_i32 s20, s20, s21
    s_add_u32 s46, s46, s20
    s_lshl_b32 s47, s45, 6
    s_add_u32 s47, s47, s46
    s_cmp_ge_u32 s46, 64
    s_cbranch_scc1 Lnj_135
    s_mul_i32 s25, s47, 1024
    s_add_u32 s25, s25, 122097664
    s_cmp_eq_u32 s45, 0
    s_cselect_b32 s25, 120265728, s25
Lnj_135:
    buffer_load_dword v9, v8, s[8:11], s25 offen sc1
    v_cvt_pk_bf16_f32 v96, v16, v17
    v_cvt_pk_bf16_f32 v97, v18, v19
    v_cvt_pk_bf16_f32 v98, v44, v45
    v_cvt_pk_bf16_f32 v99, v46, v47
    buffer_store_dwordx4 v[96:99], v1, s[8:11], s24 offen offset:0 sc1
    v_cvt_pk_bf16_f32 v100, v20, v21
    v_cvt_pk_bf16_f32 v101, v22, v23
    v_cvt_pk_bf16_f32 v102, v48, v49
    v_cvt_pk_bf16_f32 v103, v50, v51
    buffer_store_dwordx4 v[100:103], v1, s[8:11], s24 offen offset:1024 sc1
    v_cvt_pk_bf16_f32 v96, v24, v25
    v_cvt_pk_bf16_f32 v97, v26, v27
    v_cvt_pk_bf16_f32 v98, v52, v53
    v_cvt_pk_bf16_f32 v99, v54, v55
    buffer_store_dwordx4 v[96:99], v1, s[8:11], s24 offen offset:2048 sc1
    v_cvt_pk_bf16_f32 v100, v28, v29
    v_cvt_pk_bf16_f32 v101, v30, v31
    v_cvt_pk_bf16_f32 v102, v56, v57
    v_cvt_pk_bf16_f32 v103, v58, v59
    buffer_store_dwordx4 v[100:103], v1, s[8:11], s24 offen offset:3072 sc1
    s_add_u32 s24, s24, 4096
    v_cvt_pk_bf16_f32 v96, v32, v33
    v_cvt_pk_bf16_f32 v97, v34, v35
    v_cvt_pk_bf16_f32 v98, v60, v61
    v_cvt_pk_bf16_f32 v99, v62, v63
    buffer_store_dwordx4 v[96:99], v1, s[8:11], s24 offen offset:0 sc1
    v_cvt_pk_bf16_f32 v100, v36, v37
    v_cvt_pk_bf16_f32 v101, v38, v39
    v_cvt_pk_bf16_f32 v102, v64, v65
    v_cvt_pk_bf16_f32 v103, v66, v67
    buffer_store_dwordx4 v[100:103], v1, s[8:11], s24 offen offset:1024 sc1
    v_cvt_pk_bf16_f32 v96, v40, v41
    v_cvt_pk_bf16_f32 v97, v42, v43
    v_cvt_pk_bf16_f32 v98, v68, v69
    v_cvt_pk_bf16_f32 v99, v70, v71
    buffer_store_dwordx4 v[96:99], v1, s[8:11], s24 offen offset:2048 sc1
    s_cmp_lt_u32 s35, 64
    s_cbranch_scc1 Lvx_126
    s_waitcnt vmcnt(0)
    s_barrier
    buffer_store_dword v15, v14, s[8:11], s53 offen sc1
    s_mov_b32 s53, 125566976
    s_branch interleave_layers__memory_aug_recurrent_mem_tr__glu_gated_glu__prompt_kernel_exit
Lredo_130:
    s_sub_u32 s18, s18, 64
    s_cbranch_scc1 interleave_layers__memory_aug_recurrent_mem_tr__glu_gated_glu__prompt_kernel_exit
    s_barrier
    s_mul_i32 s22, s44, 28672
    s_add_u32 s22, s22, s31
    s_add_u32 s22, s22, 12845056
    s_mov_b32 s23, s54
    s_add_u32 s23, s23, s31
    s_mov_b32 m0, s23
    s_add_u32 s23, s23, 4096
    buffer_load_dwordx4 v1, s[8:11], s22 offen offset:0 sc1 lds
    buffer_load_dwordx4 v1, s[8:11], s22 offen offset:1024 sc1 lds
    buffer_load_dwordx4 v1, s[8:11], s22 offen offset:2048 sc1 lds
    buffer_load_dwordx4 v1, s[8:11], s22 offen offset:3072 sc1 lds
    s_add_u32 s22, s22, 4096
    s_mov_b32 m0, s23
    s_add_u32 s23, s23, 4096
    buffer_load_dwordx4 v1, s[8:11], s22 offen offset:0 sc1 lds
    buffer_load_dwordx4 v1, s[8:11], s22 offen offset:1024 sc1 lds
    buffer_load_dwordx4 v1, s[8:11], s22 offen offset:2048 sc1 lds
    s_waitcnt vmcnt(0)
    s_branch Lrun_131
Lrole5_22:
    v_and_b32 v7, 63, v0
    v_lshlrev_b32 v1, 4, v7
    v_cmp_eq_u32 vcc, 0, v0
    v_mov_b32 v14, 2130706432
    v_mov_b32 v15, 1
    v_cndmask_b32 v14, v14, 0, vcc
    s_cmp_eq_u32 s19, 0
    s_cbranch_scc0 Lsn_137
    s_mov_b32 s70, 64
    s_mov_b32 s71, 0
    s_mov_b32 s72, 1
    s_mov_b32 s73, 0
    s_mov_b32 s74, 1
    s_mov_b32 s75, 1
    s_mov_b32 s76, 64
    s_branch Lsj_136
Lsn_137:
    s_mov_b32 s70, 64
    s_mov_b32 s71, 1
    s_mov_b32 s72, 1
    s_mov_b32 s73, 0
    s_mov_b32 s74, 1
    s_mov_b32 s75, 1
    s_mov_b32 s76, 64
Lsj_136:
    s_load_dwordx4 s[24:27], s[0:1], 64
    s_lshl_b32 s20, s15, 2
    s_add_u32 s30, s20, s12
    v_lshrrev_b32 v2, 2, v7
    v_mul_u32_u24 v2, 3584, v2
    v_and_b32 v3, 3, v7
    v_lshl_add_u32 v2, v3, 4, v2
    v_lshrrev_b32 v4, 4, v7
    v_lshlrev_b32 v5, 9, v4
    v_bfe_u32 v6, v7, 2, 2
    v_lshl_add_u32 v5, v6, 6, v5
    v_lshl_add_u32 v5, v3, 4, v5
    s_mul_i32 s31, s12, 28672
    v_add_u32 v5, s31, v5
    v_and_b32 v6, 15, v7
    v_lshlrev_b32 v13, 4, v6
    v_lshl_add_u32 v13, v4, 9, v13
    v_add_u32 v6, 256, v13
    v_cmp_gt_u32 vcc, 3, v4
    v_mov_b32 v4, 2130706432
    v_mov_b32 v3, v6
    v_cndmask_b32 v6, v4, v3, vcc
    s_waitcnt lgkmcnt(0)
    s_mov_b32 s36, s24
    s_mov_b32 s37, s25
    s_mov_b32 s38, 1605632
    s_mov_b32 s39, 0x20000
    s_mov_b32 s48, s26
    s_mov_b32 s49, s27
    s_mov_b32 s50, 1605632
    s_mov_b32 s51, 0x20000
    s_lshl_b32 s22, s30, 6
    s_mov_b32 s23, s31
    s_mov_b32 m0, s23
    s_add_u32 s21, s22, 0
    buffer_load_dwordx4 v2, s[36:39], s21 offen lds
    s_add_u32 s23, s23, 1024
    s_mov_b32 m0, s23
    s_add_u32 s21, s22, 57344
    buffer_load_dwordx4 v2, s[36:39], s21 offen lds
    s_add_u32 s23, s23, 1024
    s_mov_b32 m0, s23
    s_add_u32 s21, s22, 0
    buffer_load_dwordx4 v2, s[48:51], s21 offen lds
    s_add_u32 s23, s23, 1024
    s_mov_b32 m0, s23
    s_add_u32 s21, s22, 57344
    buffer_load_dwordx4 v2, s[48:51], s21 offen lds
    s_add_u32 s23, s23, 1024
    s_mov_b32 m0, s23
    s_add_u32 s21, s22, 114688
    buffer_load_dwordx4 v2, s[36:39], s21 offen lds
    s_add_u32 s23, s23, 1024
    s_mov_b32 m0, s23
    s_add_u32 s21, s22, 172032
    buffer_load_dwordx4 v2, s[36:39], s21 offen lds
    s_add_u32 s23, s23, 1024
    s_mov_b32 m0, s23
    s_add_u32 s21, s22, 114688
    buffer_load_dwordx4 v2, s[48:51], s21 offen lds
    s_add_u32 s23, s23, 1024
    s_mov_b32 m0, s23
    s_add_u32 s21, s22, 172032
    buffer_load_dwordx4 v2, s[48:51], s21 offen lds
    s_add_u32 s23, s23, 1024
    s_mov_b32 m0, s23
    s_add_u32 s21, s22, 229376
    buffer_load_dwordx4 v2, s[36:39], s21 offen lds
    s_add_u32 s23, s23, 1024
    s_mov_b32 m0, s23
    s_add_u32 s21, s22, 286720
    buffer_load_dwordx4 v2, s[36:39], s21 offen lds
    s_add_u32 s23, s23, 1024
    s_mov_b32 m0, s23
    s_add_u32 s21, s22, 229376
    buffer_load_dwordx4 v2, s[48:51], s21 offen lds
    s_add_u32 s23, s23, 1024
    s_mov_b32 m0, s23
    s_add_u32 s21, s22, 286720
    buffer_load_dwordx4 v2, s[48:51], s21 offen lds
    s_add_u32 s23, s23, 1024
    s_mov_b32 m0, s23
    s_add_u32 s21, s22, 344064
    buffer_load_dwordx4 v2, s[36:39], s21 offen lds
    s_add_u32 s23, s23, 1024
    s_mov_b32 m0, s23
    s_add_u32 s21, s22, 401408
    buffer_load_dwordx4 v2, s[36:39], s21 offen lds
    s_add_u32 s23, s23, 1024
    s_mov_b32 m0, s23
    s_add_u32 s21, s22, 344064
    buffer_load_dwordx4 v2, s[48:51], s21 offen lds
    s_add_u32 s23, s23, 1024
    s_mov_b32 m0, s23
    s_add_u32 s21, s22, 401408
    buffer_load_dwordx4 v2, s[48:51], s21 offen lds
    s_add_u32 s23, s23, 1024
    s_mov_b32 m0, s23
    s_add_u32 s21, s22, 458752
    buffer_load_dwordx4 v2, s[36:39], s21 offen lds
    s_add_u32 s23, s23, 1024
    s_mov_b32 m0, s23
    s_add_u32 s21, s22, 516096
    buffer_load_dwordx4 v2, s[36:39], s21 offen lds
    s_add_u32 s23, s23, 1024
    s_mov_b32 m0, s23
    s_add_u32 s21, s22, 458752
    buffer_load_dwordx4 v2, s[48:51], s21 offen lds
    s_add_u32 s23, s23, 1024
    s_mov_b32 m0, s23
    s_add_u32 s21, s22, 516096
    buffer_load_dwordx4 v2, s[48:51], s21 offen lds
    s_add_u32 s23, s23, 1024
    s_mov_b32 m0, s23
    s_add_u32 s21, s22, 573440
    buffer_load_dwordx4 v2, s[36:39], s21 offen lds
    s_add_u32 s23, s23, 1024
    s_mov_b32 m0, s23
    s_add_u32 s21, s22, 630784
    buffer_load_dwordx4 v2, s[36:39], s21 offen lds
    s_add_u32 s23, s23, 1024
    s_mov_b32 m0, s23
    s_add_u32 s21, s22, 573440
    buffer_load_dwordx4 v2, s[48:51], s21 offen lds
    s_add_u32 s23, s23, 1024
    s_mov_b32 m0, s23
    s_add_u32 s21, s22, 630784
    buffer_load_dwordx4 v2, s[48:51], s21 offen lds
    s_add_u32 s23, s23, 1024
    s_mov_b32 m0, s23
    s_add_u32 s21, s22, 688128
    buffer_load_dwordx4 v2, s[36:39], s21 offen lds
    s_add_u32 s23, s23, 1024
    s_mov_b32 m0, s23
    s_add_u32 s21, s22, 745472
    buffer_load_dwordx4 v2, s[36:39], s21 offen lds
    s_add_u32 s23, s23, 1024
    s_mov_b32 m0, s23
    s_add_u32 s21, s22, 688128
    buffer_load_dwordx4 v2, s[48:51], s21 offen lds
    s_add_u32 s23, s23, 1024
    s_mov_b32 m0, s23
    s_add_u32 s21, s22, 745472
    buffer_load_dwordx4 v2, s[48:51], s21 offen lds
    s_add_u32 s23, s23, 1024
    s_waitcnt vmcnt(24)
    ds_read_b64_tr_b16 a[0:1], v5 offset:0
    ds_read_b64_tr_b16 a[2:3], v5 offset:256
    ds_read_b64_tr_b16 a[56:57], v5 offset:8
    ds_read_b64_tr_b16 a[58:59], v5 offset:264
    ds_read_b64_tr_b16 a[112:113], v5 offset:2048
    ds_read_b64_tr_b16 a[114:115], v5 offset:2304
    ds_read_b64_tr_b16 a[168:169], v5 offset:2056
    ds_read_b64_tr_b16 a[170:171], v5 offset:2312
    s_waitcnt lgkmcnt(0)
    s_waitcnt vmcnt(20)
    ds_read_b64_tr_b16 a[4:5], v5 offset:4096
    ds_read_b64_tr_b16 a[6:7], v5 offset:4352
    ds_read_b64_tr_b16 a[60:61], v5 offset:4104
    ds_read_b64_tr_b16 a[62:63], v5 offset:4360
    ds_read_b64_tr_b16 a[116:117], v5 offset:6144
    ds_read_b64_tr_b16 a[118:119], v5 offset:6400
    ds_read_b64_tr_b16 a[172:173], v5 offset:6152
    ds_read_b64_tr_b16 a[174:175], v5 offset:6408
    s_waitcnt lgkmcnt(0)
    s_waitcnt vmcnt(16)
    ds_read_b64_tr_b16 a[8:9], v5 offset:8192
    ds_read_b64_tr_b16 a[10:11], v5 offset:8448
    ds_read_b64_tr_b16 a[64:65], v5 offset:8200
    ds_read_b64_tr_b16 a[66:67], v5 offset:8456
    ds_read_b64_tr_b16 a[120:121], v5 offset:10240
    ds_read_b64_tr_b16 a[122:123], v5 offset:10496
    ds_read_b64_tr_b16 a[176:177], v5 offset:10248
    ds_read_b64_tr_b16 a[178:179], v5 offset:10504
    s_waitcnt lgkmcnt(0)
    s_waitcnt vmcnt(12)
    ds_read_b64_tr_b16 a[12:13], v5 offset:12288
    ds_read_b64_tr_b16 a[14:15], v5 offset:12544
    ds_read_b64_tr_b16 a[68:69], v5 offset:12296
    ds_read_b64_tr_b16 a[70:71], v5 offset:12552
    ds_read_b64_tr_b16 a[124:125], v5 offset:14336
    ds_read_b64_tr_b16 a[126:127], v5 offset:14592
    ds_read_b64_tr_b16 a[180:181], v5 offset:14344
    ds_read_b64_tr_b16 a[182:183], v5 offset:14600
    s_waitcnt lgkmcnt(0)
    s_waitcnt vmcnt(8)
    ds_read_b64_tr_b16 a[16:17], v5 offset:16384
    ds_read_b64_tr_b16 a[18:19], v5 offset:16640
    ds_read_b64_tr_b16 a[72:73], v5 offset:16392
    ds_read_b64_tr_b16 a[74:75], v5 offset:16648
    ds_read_b64_tr_b16 a[128:129], v5 offset:18432
    ds_read_b64_tr_b16 a[130:131], v5 offset:18688
    ds_read_b64_tr_b16 a[184:185], v5 offset:18440
    ds_read_b64_tr_b16 a[186:187], v5 offset:18696
    s_waitcnt lgkmcnt(0)
    s_waitcnt vmcnt(4)
    ds_read_b64_tr_b16 a[20:21], v5 offset:20480
    ds_read_b64_tr_b16 a[22:23], v5 offset:20736
    ds_read_b64_tr_b16 a[76:77], v5 offset:20488
    ds_read_b64_tr_b16 a[78:79], v5 offset:20744
    ds_read_b64_tr_b16 a[132:133], v5 offset:22528
    ds_read_b64_tr_b16 a[134:135], v5 offset:22784
    ds_read_b64_tr_b16 a[188:189], v5 offset:22536
    ds_read_b64_tr_b16 a[190:191], v5 offset:22792
    s_waitcnt lgkmcnt(0)
    s_waitcnt vmcnt(0)
    ds_read_b64_tr_b16 a[24:25], v5 offset:24576
    ds_read_b64_tr_b16 a[26:27], v5 offset:24832
    ds_read_b64_tr_b16 a[80:81], v5 offset:24584
    ds_read_b64_tr_b16 a[82:83], v5 offset:24840
    ds_read_b64_tr_b16 a[136:137], v5 offset:26624
    ds_read_b64_tr_b16 a[138:139], v5 offset:26880
    ds_read_b64_tr_b16 a[192:193], v5 offset:26632
    ds_read_b64_tr_b16 a[194:195], v5 offset:26888
    s_waitcnt lgkmcnt(0)
    s_mov_b32 s23, s31
    s_mov_b32 m0, s23
    s_add_u32 s21, s22, 802816
    buffer_load_dwordx4 v2, s[36:39], s21 offen lds
    s_add_u32 s23, s23, 1024
    s_mov_b32 m0, s23
    s_add_u32 s21, s22, 860160
    buffer_load_dwordx4 v2, s[36:39], s21 offen lds
    s_add_u32 s23, s23, 1024
    s_mov_b32 m0, s23
    s_add_u32 s21, s22, 802816
    buffer_load_dwordx4 v2, s[48:51], s21 offen lds
    s_add_u32 s23, s23, 1024
    s_mov_b32 m0, s23
    s_add_u32 s21, s22, 860160
    buffer_load_dwordx4 v2, s[48:51], s21 offen lds
    s_add_u32 s23, s23, 1024
    s_mov_b32 m0, s23
    s_add_u32 s21, s22, 917504
    buffer_load_dwordx4 v2, s[36:39], s21 offen lds
    s_add_u32 s23, s23, 1024
    s_mov_b32 m0, s23
    s_add_u32 s21, s22, 974848
    buffer_load_dwordx4 v2, s[36:39], s21 offen lds
    s_add_u32 s23, s23, 1024
    s_mov_b32 m0, s23
    s_add_u32 s21, s22, 917504
    buffer_load_dwordx4 v2, s[48:51], s21 offen lds
    s_add_u32 s23, s23, 1024
    s_mov_b32 m0, s23
    s_add_u32 s21, s22, 974848
    buffer_load_dwordx4 v2, s[48:51], s21 offen lds
    s_add_u32 s23, s23, 1024
    s_mov_b32 m0, s23
    s_add_u32 s21, s22, 1032192
    buffer_load_dwordx4 v2, s[36:39], s21 offen lds
    s_add_u32 s23, s23, 1024
    s_mov_b32 m0, s23
    s_add_u32 s21, s22, 1089536
    buffer_load_dwordx4 v2, s[36:39], s21 offen lds
    s_add_u32 s23, s23, 1024
    s_mov_b32 m0, s23
    s_add_u32 s21, s22, 1032192
    buffer_load_dwordx4 v2, s[48:51], s21 offen lds
    s_add_u32 s23, s23, 1024
    s_mov_b32 m0, s23
    s_add_u32 s21, s22, 1089536
    buffer_load_dwordx4 v2, s[48:51], s21 offen lds
    s_add_u32 s23, s23, 1024
    s_mov_b32 m0, s23
    s_add_u32 s21, s22, 1146880
    buffer_load_dwordx4 v2, s[36:39], s21 offen lds
    s_add_u32 s23, s23, 1024
    s_mov_b32 m0, s23
    s_add_u32 s21, s22, 1204224
    buffer_load_dwordx4 v2, s[36:39], s21 offen lds
    s_add_u32 s23, s23, 1024
    s_mov_b32 m0, s23
    s_add_u32 s21, s22, 1146880
    buffer_load_dwordx4 v2, s[48:51], s21 offen lds
    s_add_u32 s23, s23, 1024
    s_mov_b32 m0, s23
    s_add_u32 s21, s22, 1204224
    buffer_load_dwordx4 v2, s[48:51], s21 offen lds
    s_add_u32 s23, s23, 1024
    s_mov_b32 m0, s23
    s_add_u32 s21, s22, 1261568
    buffer_load_dwordx4 v2, s[36:39], s21 offen lds
    s_add_u32 s23, s23, 1024
    s_mov_b32 m0, s23
    s_add_u32 s21, s22, 1318912
    buffer_load_dwordx4 v2, s[36:39], s21 offen lds
    s_add_u32 s23, s23, 1024
    s_mov_b32 m0, s23
    s_add_u32 s21, s22, 1261568
    buffer_load_dwordx4 v2, s[48:51], s21 offen lds
    s_add_u32 s23, s23, 1024
    s_mov_b32 m0, s23
    s_add_u32 s21, s22, 1318912
    buffer_load_dwordx4 v2, s[48:51], s21 offen lds
    s_add_u32 s23, s23, 1024
    s_mov_b32 m0, s23
    s_add_u32 s21, s22, 1376256
    buffer_load_dwordx4 v2, s[36:39], s21 offen lds
    s_add_u32 s23, s23, 1024
    s_mov_b32 m0, s23
    s_add_u32 s21, s22, 1433600
    buffer_load_dwordx4 v2, s[36:39], s21 offen lds
    s_add_u32 s23, s23, 1024
    s_mov_b32 m0, s23
    s_add_u32 s21, s22, 1376256
    buffer_load_dwordx4 v2, s[48:51], s21 offen lds
    s_add_u32 s23, s23, 1024
    s_mov_b32 m0, s23
    s_add_u32 s21, s22, 1433600
    buffer_load_dwordx4 v2, s[48:51], s21 offen lds
    s_add_u32 s23, s23, 1024
    s_mov_b32 m0, s23
    s_add_u32 s21, s22, 1490944
    buffer_load_dwordx4 v2, s[36:39], s21 offen lds
    s_add_u32 s23, s23, 1024
    s_mov_b32 m0, s23
    s_add_u32 s21, s22, 1548288
    buffer_load_dwordx4 v2, s[36:39], s21 offen lds
    s_add_u32 s23, s23, 1024
    s_mov_b32 m0, s23
    s_add_u32 s21, s22, 1490944
    buffer_load_dwordx4 v2, s[48:51], s21 offen lds
    s_add_u32 s23, s23, 1024
    s_mov_b32 m0, s23
    s_add_u32 s21, s22, 1548288
    buffer_load_dwordx4 v2, s[48:51], s21 offen lds
    s_add_u32 s23, s23, 1024
    s_waitcnt vmcnt(24)
    ds_read_b64_tr_b16 a[28:29], v5 offset:0
    ds_read_b64_tr_b16 a[30:31], v5 offset:256
    ds_read_b64_tr_b16 a[84:85], v5 offset:8
    ds_read_b64_tr_b16 a[86:87], v5 offset:264
    ds_read_b64_tr_b16 a[140:141], v5 offset:2048
    ds_read_b64_tr_b16 a[142:143], v5 offset:2304
    ds_read_b64_tr_b16 a[196:197], v5 offset:2056
    ds_read_b64_tr_b16 a[198:199], v5 offset:2312
    s_waitcnt lgkmcnt(0)
    s_waitcnt vmcnt(20)
    ds_read_b64_tr_b16 a[32:33], v5 offset:4096
    ds_read_b64_tr_b16 a[34:35], v5 offset:4352
    ds_read_b64_tr_b16 a[88:89], v5 offset:4104
    ds_read_b64_tr_b16 a[90:91], v5 offset:4360
    ds_read_b64_tr_b16 a[144:145], v5 offset:6144
    ds_read_b64_tr_b16 a[146:147], v5 offset:6400
    ds_read_b64_tr_b16 a[200:201], v5 offset:6152
    ds_read_b64_tr_b16 a[202:203], v5 offset:6408
    s_waitcnt lgkmcnt(0)
    s_waitcnt vmcnt(16)
    ds_read_b64_tr_b16 a[36:37], v5 offset:8192
    ds_read_b64_tr_b16 a[38:39], v5 offset:8448
    ds_read_b64_tr_b16 a[92:93], v5 offset:8200
    ds_read_b64_tr_b16 a[94:95], v5 offset:8456
    ds_read_b64_tr_b16 a[148:149], v5 offset:10240
    ds_read_b64_tr_b16 a[150:151], v5 offset:10496
    ds_read_b64_tr_b16 a[204:205], v5 offset:10248
    ds_read_b64_tr_b16 a[206:207], v5 offset:10504
    s_waitcnt lgkmcnt(0)
    s_waitcnt vmcnt(12)
    ds_read_b64_tr_b16 a[40:41], v5 offset:12288
    ds_read_b64_tr_b16 a[42:43], v5 offset:12544
    ds_read_b64_tr_b16 a[96:97], v5 offset:12296
    ds_read_b64_tr_b16 a[98:99], v5 offset:12552
    ds_read_b64_tr_b16 a[152:153], v5 offset:14336
    ds_read_b64_tr_b16 a[154:155], v5 offset:14592
    ds_read_b64_tr_b16 a[208:209], v5 offset:14344
    ds_read_b64_tr_b16 a[210:211], v5 offset:14600
    s_waitcnt lgkmcnt(0)
    s_waitcnt vmcnt(8)
    ds_read_b64_tr_b16 a[44:45], v5 offset:16384
    ds_read_b64_tr_b16 a[46:47], v5 offset:16640
    ds_read_b64_tr_b16 a[100:101], v5 offset:16392
    ds_read_b64_tr_b16 a[102:103], v5 offset:16648
    ds_read_b64_tr_b16 a[156:157], v5 offset:18432
    ds_read_b64_tr_b16 a[158:159], v5 offset:18688
    ds_read_b64_tr_b16 a[212:213], v5 offset:18440
    ds_read_b64_tr_b16 a[214:215], v5 offset:18696
    s_waitcnt lgkmcnt(0)
    s_waitcnt vmcnt(4)
    ds_read_b64_tr_b16 a[48:49], v5 offset:20480
    ds_read_b64_tr_b16 a[50:51], v5 offset:20736
    ds_read_b64_tr_b16 a[104:105], v5 offset:20488
    ds_read_b64_tr_b16 a[106:107], v5 offset:20744
    ds_read_b64_tr_b16 a[160:161], v5 offset:22528
    ds_read_b64_tr_b16 a[162:163], v5 offset:22784
    ds_read_b64_tr_b16 a[216:217], v5 offset:22536
    ds_read_b64_tr_b16 a[218:219], v5 offset:22792
    s_waitcnt lgkmcnt(0)
    s_waitcnt vmcnt(0)
    ds_read_b64_tr_b16 a[52:53], v5 offset:24576
    ds_read_b64_tr_b16 a[54:55], v5 offset:24832
    ds_read_b64_tr_b16 a[108:109], v5 offset:24584
    ds_read_b64_tr_b16 a[110:111], v5 offset:24840
    ds_read_b64_tr_b16 a[164:165], v5 offset:26624
    ds_read_b64_tr_b16 a[166:167], v5 offset:26880
    ds_read_b64_tr_b16 a[220:221], v5 offset:26632
    ds_read_b64_tr_b16 a[222:223], v5 offset:26888
    s_waitcnt lgkmcnt(0)
    s_barrier
    v_mov_b32 v16, 0x3f803f80
    v_mov_b32 v17, 0x3f803f80
    v_mov_b32 v18, 0x3f803f80
    v_mov_b32 v19, 0x3f803f80
    v_mov_b32 v176, -1
    v_mov_b32 v177, -1
    v_mov_b32 v178, -1
    v_mov_b32 v179, -1
    v_mfma_f32_16x16x32_bf16 v[80:83], a[0:3], v[16:19], 0
    v_mfma_f32_16x16x32_bf16 v[84:87], a[56:59], v[16:19], 0
    v_mfma_f32_16x16x32_bf16 v[88:91], a[112:115], v[16:19], 0
    v_mfma_f32_16x16x32_bf16 v[92:95], a[168:171], v[16:19], 0
    v_mfma_f32_16x16x32_bf16 v[80:83], a[4:7], v[16:19], v[80:83]
    v_mfma_f32_16x16x32_bf16 v[84:87], a[60:63], v[16:19], v[84:87]
    v_mfma_f32_16x16x32_bf16 v[88:91], a[116:119], v[16:19], v[88:91]
    v_mfma_f32_16x16x32_bf16 v[92:95], a[172:175], v[16:19], v[92:95]
    v_mfma_f32_16x16x32_bf16 v[80:83], a[8:11], v[16:19], v[80:83]
    v_mfma_f32_16x16x32_bf16 v[84:87], a[64:67], v[16:19], v[84:87]
    v_mfma_f32_16x16x32_bf16 v[88:91], a[120:123], v[16:19], v[88:91]
    v_mfma_f32_16x16x32_bf16 v[92:95], a[176:179], v[16:19], v[92:95]
    v_mfma_f32_16x16x32_bf16 v[80:83], a[12:15], v[16:19], v[80:83]
    v_mfma_f32_16x16x32_bf16 v[84:87], a[68:71], v[16:19], v[84:87]
    v_mfma_f32_16x16x32_bf16 v[88:91], a[124:127], v[16:19], v[88:91]
    v_mfma_f32_16x16x32_bf16 v[92:95], a[180:183], v[16:19], v[92:95]
    v_mfma_f32_16x16x32_bf16 v[80:83], a[16:19], v[16:19], v[80:83]
    v_mfma_f32_16x16x32_bf16 v[84:87], a[72:75], v[16:19], v[84:87]
    v_mfma_f32_16x16x32_bf16 v[88:91], a[128:131], v[16:19], v[88:91]
    v_mfma_f32_16x16x32_bf16 v[92:95], a[184:187], v[16:19], v[92:95]
    v_mfma_f32_16x16x32_bf16 v[80:83], a[20:23], v[16:19], v[80:83]
    v_mfma_f32_16x16x32_bf16 v[84:87], a[76:79], v[16:19], v[84:87]
    v_mfma_f32_16x16x32_bf16 v[88:91], a[132:135], v[16:19], v[88:91]
    v_mfma_f32_16x16x32_bf16 v[92:95], a[188:191], v[16:19], v[92:95]
    v_mfma_f32_16x16x32_bf16 v[80:83], a[24:27], v[16:19], v[80:83]
    v_mfma_f32_16x16x32_bf16 v[84:87], a[80:83], v[16:19], v[84:87]
    v_mfma_f32_16x16x32_bf16 v[88:91], a[136:139], v[16:19], v[88:91]
    v_mfma_f32_16x16x32_bf16 v[92:95], a[192:195], v[16:19], v[92:95]
    v_mfma_f32_16x16x32_bf16 v[80:83], a[28:31], v[16:19], v[80:83]
    v_mfma_f32_16x16x32_bf16 v[84:87], a[84:87], v[16:19], v[84:87]
    v_mfma_f32_16x16x32_bf16 v[88:91], a[140:143], v[16:19], v[88:91]
    v_mfma_f32_16x16x32_bf16 v[92:95], a[196:199], v[16:19], v[92:95]
    v_mfma_f32_16x16x32_bf16 v[80:83], a[32:35], v[16:19], v[80:83]
    v_mfma_f32_16x16x32_bf16 v[84:87], a[88:91], v[16:19], v[84:87]
    v_mfma_f32_16x16x32_bf16 v[88:91], a[144:147], v[16:19], v[88:91]
    v_mfma_f32_16x16x32_bf16 v[92:95], a[200:203], v[16:19], v[92:95]
    v_mfma_f32_16x16x32_bf16 v[80:83], a[36:39], v[16:19], v[80:83]
    v_mfma_f32_16x16x32_bf16 v[84:87], a[92:95], v[16:19], v[84:87]
    v_mfma_f32_16x16x32_bf16 v[88:91], a[148:151], v[16:19], v[88:91]
    v_mfma_f32_16x16x32_bf16 v[92:95], a[204:207], v[16:19], v[92:95]
    v_mfma_f32_16x16x32_bf16 v[80:83], a[40:43], v[16:19], v[80:83]
    v_mfma_f32_16x16x32_bf16 v[84:87], a[96:99], v[16:19], v[84:87]
    v_mfma_f32_16x16x32_bf16 v[88:91], a[152:155], v[16:19], v[88:91]
    v_mfma_f32_16x16x32_bf16 v[92:95], a[208:211], v[16:19], v[92:95]
    v_mfma_f32_16x16x32_bf16 v[80:83], a[44:47], v[16:19], v[80:83]
    v_mfma_f32_16x16x32_bf16 v[84:87], a[100:103], v[16:19], v[84:87]
    v_mfma_f32_16x16x32_bf16 v[88:91], a[156:159], v[16:19], v[88:91]
    v_mfma_f32_16x16x32_bf16 v[92:95], a[212:215], v[16:19], v[92:95]
    v_mfma_f32_16x16x32_bf16 v[80:83], a[48:51], v[16:19], v[80:83]
    v_mfma_f32_16x16x32_bf16 v[84:87], a[104:107], v[16:19], v[84:87]
    v_mfma_f32_16x16x32_bf16 v[88:91], a[160:163], v[16:19], v[88:91]
    v_mfma_f32_16x16x32_bf16 v[92:95], a[216:219], v[16:19], v[92:95]
    v_mfma_f32_16x16x32_bf16 v[80:83], a[52:55], v[16:19], v[80:83]
    v_mfma_f32_16x16x32_bf16 v[84:87], a[108:111], v[16:19], v[84:87]
    v_mfma_f32_16x16x32_bf16 v[88:91], a[164:167], v[16:19], v[88:91]
    v_mfma_f32_16x16x32_bf16 v[92:95], a[220:223], v[16:19], v[92:95]
    s_lshl_b32 s30, s30, 10
    s_mul_i32 s31, s12, 7168
    s_mov_b32 s33, 0xbfb8aa3b
    s_mov_b32 s34, 0x3b124925
    s_mov_b32 s35, 0x3727c5ac
    s_mov_b32 s42, 0
    v_lshlrev_b32 v16, 7, v0
    s_mov_b32 s20, 125698048
Lwd_139:
    buffer_load_dwordx2 v[18:19], v16, s[8:11], s20 offen offset:0 sc1
    s_sub_u32 s18, s18, 1
    s_cbranch_scc1 interleave_layers__memory_aug_recurrent_mem_tr__glu_gated_glu__prompt_kernel_exit
    s_waitcnt vmcnt(0)
    v_xor_b32 v18, s78, v18
    v_xor_b32 v19, s79, v19
    v_or_b32 v18, v18, v19
    v_cmp_ne_u32 vcc, 0, v18
    s_cbranch_vccz Lwdok_140
    s_sleep 2
    s_branch Lwd_139
Lwdok_140:
    s_barrier
    v_and_b32 v16, 7, v0
    v_lshlrev_b32 v16, 7, v16
    s_mov_b32 s21, 125730816
Lcm_141:
    buffer_load_dword v17, v16, s[8:11], s21 offen sc1
    s_sub_u32 s18, s18, 1
    s_cbranch_scc1 interleave_layers__memory_aug_recurrent_mem_tr__glu_gated_glu__prompt_kernel_exit
    s_waitcnt vmcnt(0)
    s_lshr_b32 s23, s13, 5
    s_nop 3
    v_readlane_b32 s22, v17, s23
    s_cmp_ge_u32 s22, 32
    s_cbranch_scc1 Lcmd_142
    s_mov_b32 s23, 0
    v_readlane_b32 s22, v17, 0
    s_add_u32 s23, s23, s22
    v_readlane_b32 s22, v17, 1
    s_add_u32 s23, s23, s22
    v_readlane_b32 s22, v17, 2
    s_add_u32 s23, s23, s22
    v_readlane_b32 s22, v17, 3
    s_add_u32 s23, s23, s22
    v_readlane_b32 s22, v17, 4
    s_add_u32 s23, s23, s22
    v_readlane_b32 s22, v17, 5
    s_add_u32 s23, s23, s22
    v_readlane_b32 s22, v17, 6
    s_add_u32 s23, s23, s22
    v_readlane_b32 s22, v17, 7
    s_add_u32 s23, s23, s22
    s_cmp_lt_u32 s23, 256
    s_cbranch_scc1 Lcm_141
    s_mov_b32 s16, 0
Lcmd_142:
    s_cmp_eq_u32 s16, 1
    s_cbranch_scc0 Lb1slow_143
Lpf_144:
    s_sub_u32 s20, s42, s70
    s_cselect_b32 s20, s42, s20
    s_cselect_b32 s14, s71, s74
    s_cselect_b32 s21, s72, s75
    s_cselect_b32 s43, s73, s76
    s_mul_i32 s20, s20, s21
    s_add_u32 s43, s43, s20
    s_lshl_b32 s44, s14, 6
    s_add_u32 s44, s44, s43
    s_cmp_ge_u32 s43, 64
    s_cbranch_scc1 Lpfd_145
    s_add_u32 s42, s42, 1
    s_mul_i32 s24, s44, 114688
    s_add_u32 s24, s24, s30
    s_add_u32 s24, s24, 25690112
    s_add_u32 s25, s24, 57344
    buffer_store_dwordx4 v[176:179], v1, s[8:11], s24 offen sc1
    buffer_store_dwordx4 v[176:179], v1, s[8:11], s25 offen sc1
    s_cmp_lt_u32 s42, 4
    s_cbranch_scc1 Lpf_144
Lpfd_145:
    s_mov_b32 s42, 0
    s_lshl_b32 s20, s12, 2
    s_add_u32 s20, s20, 147392
    v_mov_b32 v10, s20
    v_mov_b32 v11, 147392
    s_mov_b32 s56, s4
    s_mov_b32 s57, s5
    s_mov_b32 s58, 0
    s_mov_b32 s59, 0x20000
    s_mov_b32 s52, 0
    s_mov_b32 s53, 125566976
    s_mov_b32 s54, 0
    s_mov_b32 s54, 32768
    s_sub_u32 s20, s42, s70
    s_cselect_b32 s20, s42, s20
    s_cselect_b32 s45, s71, s74
    s_cselect_b32 s21, s72, s75
    s_cselect_b32 s46, s73, s76
    s_mul_i32 s20, s20, s21
    s_add_u32 s46, s46, s20
    s_lshl_b32 s47, s45, 6
    s_add_u32 s47, s47, s46
    s_lshl_b32 s27, s45, 6
    s_add_u32 s27, s27, s47
    s_lshl_b32 s27, s27, 13
    s_add_u32 s27, s27, 120258560
    s_mul_i32 s38, s47, 28672
    s_add_u32 s38, s38, s31
    s_add_u32 s38, s38, 16515072
Lb1_147:
    s_mov_b32 s44, s47
    s_mov_b32 s26, s27
    s_add_u32 s29, s54, s31
    s_add_u32 s27, s27, 8192
    s_add_u32 s38, s38, 28672
    s_mov_b32 s28, s38
    s_add_u32 s47, s47, 1
    s_add_u32 s46, s46, 1
    s_xor_b32 s54, s54, 32768
    s_mul_i32 s24, s44, 114688
    s_add_u32 s24, s24, s30
    s_add_u32 s24, s24, 25690112
    s_add_u32 s25, s24, 57344
    v_add_u32 v5, s54, v1
    s_add_u32 s37, s24, 458752
    s_cmp_lt_u32 s46, 61
    s_cselect_b32 s37, s37, 125566976
    s_add_u32 s36, s37, 57344
    s_cmp_lt_u32 s46, 64
    s_cselect_b32 s39, 0x10000000, 0
    s_cmp_eq_u32 s52, 1
    s_cbranch_scc1 Lhv_152
Lld_148:
    s_mul_i32 s22, s44, 28672
    s_add_u32 s22, s22, s31
    s_add_u32 s22, s22, 16515072
    s_add_u32 s23, s31, s54
Lsp_149:
    buffer_load_dwordx4 v[104:107], v13, s[8:11], s26 offen sc1
    buffer_load_dwordx4 v[108:111], v6, s[8:11], s26 offen sc1
    s_sub_u32 s18, s18, 1
    s_cbranch_scc1 interleave_layers__memory_aug_recurrent_mem_tr__glu_gated_glu__prompt_kernel_exit
    s_waitcnt vmcnt(0)
    v_max3_u32 v2, v104, v105, v106
    v_max3_u32 v2, v2, v107, v108
    v_max3_u32 v2, v2, v109, v110
    v_max_u32 v2, v2, v111
    v_cmp_eq_u32 vcc, -1, v2
    s_cbranch_vccz Lsok_150
    s_sleep 1
    s_branch Lsp_149
Lsok_150:
    s_mov_b32 m0, s23
    s_add_u32 s23, s23, 4096
    buffer_load_dwordx4 v1, s[8:11], s22 offen offset:0 sc1 lds
    buffer_load_dwordx4 v1, s[8:11], s22 offen offset:1024 sc1 lds
    buffer_load_dwordx4 v1, s[8:11], s22 offen offset:2048 sc1 lds
    buffer_load_dwordx4 v1, s[8:11], s22 offen offset:3072 sc1 lds
    s_add_u32 s22, s22, 4096
    s_mov_b32 m0, s23
    s_add_u32 s23, s23, 4096
    buffer_load_dwordx4 v1, s[8:11], s22 offen offset:0 sc1 lds
    buffer_load_dwordx4 v1, s[8:11], s22 offen offset:1024 sc1 lds
    buffer_load_dwordx4 v1, s[8:11], s22 offen offset:2048 sc1 lds
    s_mov_b32 s52, 0
Lhv_152:
    v_pk_add_f32 v[96:97], v[104:105], v[108:109]
    v_pk_add_f32 v[98:99], v[106:107], v[110:111]
    s_nop 1
    v_permlane32_swap_b32 v96, v98
    v_permlane32_swap_b32 v97, v99
    v_add_f32 v96, v96, v98
    v_add_f32 v97, v97, v99
    s_nop 1
    v_permlane16_swap_b32 v96, v97
    v_add_f32 v96, v96, v97
    v_mov_b32 v97, v96
    s_nop 1
    v_permlane16_swap_b32 v96, v97
    v_mov_b32 v98, v96
    v_mov_b32 v99, v97
    v_permlane32_swap_b32 v96, v98
    v_permlane32_swap_b32 v97, v99
    v_mul_f32 v96, s34, v96
    v_mul_f32 v97, s34, v97
    v_fma_f32 v97, -v96, v96, v97
    v_max_f32 v97, 0, v97
    v_add_f32 v97, s35, v97
    v_sqrt_f32 v156, v97
    v_rsq_f32 v97, v97
    v_mul_f32 v98, s34, v98
    v_mul_f32 v99, s34, v99
    v_fma_f32 v99, -v98, v98, v99
    v_max_f32 v99, 0, v99
    v_add_f32 v99, s35, v99
    v_sqrt_f32 v157, v99
    v_rsq_f32 v99, v99
    s_nop 0
    v_sub_f32 v160, 0, v96
    v_mul_f32 v162, s33, v97
    v_mov_b32 v164, v156
    v_pk_mul_f32 v[48:49], v[160:161], v[80:81] op_sel_hi:[0,1]
    v_pk_mul_f32 v[50:51], v[160:161], v[82:83] op_sel_hi:[0,1]
    v_pk_mul_f32 v[52:53], v[160:161], v[84:85] op_sel_hi:[0,1]
    v_pk_mul_f32 v[54:55], v[160:161], v[86:87] op_sel_hi:[0,1]
    v_pk_mul_f32 v[56:57], v[160:161], v[88:89] op_sel_hi:[0,1]
    v_pk_mul_f32 v[58:59], v[160:161], v[90:91] op_sel_hi:[0,1]
    v_pk_mul_f32 v[60:61], v[160:161], v[92:93] op_sel_hi:[0,1]
    v_pk_mul_f32 v[62:63], v[160:161], v[94:95] op_sel_hi:[0,1]
    v_sub_f32 v166, 0, v98
    v_mul_f32 v168, s33, v99
    v_mov_b32 v170, v157
    v_pk_mul_f32 v[64:65], v[166:167], v[80:81] op_sel_hi:[0,1]
    v_pk_mul_f32 v[66:67], v[166:167], v[82:83] op_sel_hi:[0,1]
    v_pk_mul_f32 v[68:69], v[166:167], v[84:85] op_sel_hi:[0,1]
    v_pk_mul_f32 v[70:71], v[166:167], v[86:87] op_sel_hi:[0,1]
    v_pk_mul_f32 v[72:73], v[166:167], v[88:89] op_sel_hi:[0,1]
    v_pk_mul_f32 v[74:75], v[166:167], v[90:91] op_sel_hi:[0,1]
    v_pk_mul_f32 v[76:77], v[166:167], v[92:93] op_sel_hi:[0,1]
    v_pk_mul_f32 v[78:79], v[166:167], v[94:95] op_sel_hi:[0,1]
    s_cmp_eq_u32 s52, 1
    s_cbranch_scc1 Lgo_153
    s_waitcnt vmcnt(0)
Lgo_153:
    s_waitcnt vmcnt(3)
    s_barrier
    ds_read_b128 v[16:19], v5 offset:0
    ds_read_b128 v[20:23], v5 offset:1024
    ds_read_b128 v[24:27], v5 offset:2048
    ds_read_b128 v[28:31], v5 offset:3072
    s_waitcnt lgkmcnt(2)
    v_mfma_f32_16x16x32_bf16 v[48:51], a[0:3], v[16:19], v[48:51]
    ds_read_b128 v[32:35], v5 offset:4096
    v_mfma_f32_16x16x32_bf16 v[52:55], a[56:59], v[16:19], v[52:55]
    s_mov_b32 s58, s39
    v_mfma_f32_16x16x32_bf16 v[56:59], a[112:115], v[16:19], v[56:59]
    buffer_load_dwordx4 v[104:107], v13, s[56:59], s27 offen sc1
    v_mfma_f32_16x16x32_bf16 v[60:63], a[168:171], v[16:19], v[60:63]
    v_max_u32 v158, v16, v20
    v_mfma_f32_16x16x32_bf16 v[48:51], a[4:7], v[20:23], v[48:51]
    ds_read_b128 v[36:39], v5 offset:5120
    v_mfma_f32_16x16x32_bf16 v[52:55], a[60:63], v[20:23], v[52:55]
    buffer_load_dwordx4 v[108:111], v6, s[56:59], s27 offen sc1
    v_mfma_f32_16x16x32_bf16 v[56:59], a[116:119], v[20:23], v[56:59]
    v_mfma_f32_16x16x32_bf16 v[60:63], a[172:175], v[20:23], v[60:63]
    s_waitcnt lgkmcnt(2)
    v_mfma_f32_16x16x32_bf16 v[48:51], a[8:11], v[24:27], v[48:51]
    ds_read_b128 v[16:19], v5 offset:6144
    v_mfma_f32_16x16x32_bf16 v[52:55], a[64:67], v[24:27], v[52:55]
    buffer_store_dwordx4 v[176:179], v1, s[8:11], s37 offen sc1
    v_mfma_f32_16x16x32_bf16 v[56:59], a[120:123], v[24:27], v[56:59]
    v_mfma_f32_16x16x32_bf16 v[60:63], a[176:179], v[24:27], v[60:63]
    v_max3_u32 v158, v158, v24, v28
    v_mfma_f32_16x16x32_bf16 v[48:51], a[12:15], v[28:31], v[48:51]
    ds_read_b128 v[20:23], v5 offset:7168
    v_mfma_f32_16x16x32_bf16 v[52:55], a[68:71], v[28:31], v[52:55]
    buffer_store_dwordx4 v[176:179], v1, s[8:11], s36 offen sc1
    v_mfma_f32_16x16x32_bf16 v[56:59], a[124:127], v[28:31], v[56:59]
    v_mfma_f32_16x16x32_bf16 v[60:63], a[180:183], v[28:31], v[60:63]
    s_waitcnt lgkmcnt(2)
    v_mfma_f32_16x16x32_bf16 v[48:51], a[16:19], v[32:35], v[48:51]
    ds_read_b128 v[24:27], v5 offset:8192
    v_mfma_f32_16x16x32_bf16 v[52:55], a[72:75], v[32:35], v[52:55]
    v_mfma_f32_16x16x32_bf16 v[56:59], a[128:131], v[32:35], v[56:59]
    v_mfma_f32_16x16x32_bf16 v[60:63], a[184:187], v[32:35], v[60:63]
    v_max3_u32 v158, v158, v32, v36
    v_mfma_f32_16x16x32_bf16 v[48:51], a[20:23], v[36:39], v[48:51]
    ds_read_b128 v[28:31], v5 offset:9216
    v_mfma_f32_16x16x32_bf16 v[52:55], a[76:79], v[36:39], v[52:55]
    v_mfma_f32_16x16x32_bf16 v[56:59], a[132:135], v[36:39], v[56:59]
    v_mfma_f32_16x16x32_bf16 v[60:63], a[188:191], v[36:39], v[60:63]
    s_waitcnt lgkmcnt(2)
    v_mfma_f32_16x16x32_bf16 v[48:51], a[24:27], v[16:19], v[48:51]
    ds_read_b128 v[32:35], v5 offset:10240
    v_mfma_f32_16x16x32_bf16 v[52:55], a[80:83], v[16:19], v[52:55]
    v_mfma_f32_16x16x32_bf16 v[56:59], a[136:139], v[16:19], v[56:59]
    v_mfma_f32_16x16x32_bf16 v[60:63], a[192:195], v[16:19], v[60:63]
    v_max3_u32 v158, v158, v16, v20
    v_mfma_f32_16x16x32_bf16 v[48:51], a[28:31], v[20:23], v[48:51]
    ds_read_b128 v[36:39], v5 offset:11264
    v_mfma_f32_16x16x32_bf16 v[52:55], a[84:87], v[20:23], v[52:55]
    v_mfma_f32_16x16x32_bf16 v[56:59], a[140:143], v[20:23], v[56:59]
    v_mfma_f32_16x16x32_bf16 v[60:63], a[196:199], v[20:23], v[60:63]
    s_waitcnt lgkmcnt(2)
    v_mfma_f32_16x16x32_bf16 v[48:51], a[32:35], v[24:27], v[48:51]
    ds_read_b128 v[16:19], v5 offset:12288
    v_mfma_f32_16x16x32_bf16 v[52:55], a[88:91], v[24:27], v[52:55]
    s_waitcnt vmcnt(2)
    v_max3_u32 v2, v104, v105, v106
    v_max3_u32 v2, v2, v107, v108
    v_max3_u32 v2, v2, v109, v110
    v_max_u32 v2, v2, v111
    v_mfma_f32_16x16x32_bf16 v[56:59], a[144:147], v[24:27], v[56:59]
    v_cmp_eq_u32 vcc, -1, v2
    v_mfma_f32_16x16x32_bf16 v[60:63], a[200:203], v[24:27], v[60:63]
    v_max3_u32 v158, v158, v24, v28
    v_mfma_f32_16x16x32_bf16 v[48:51], a[36:39], v[28:31], v[48:51]
    ds_read_b128 v[20:23], v5 offset:13312
    v_mfma_f32_16x16x32_bf16 v[52:55], a[92:95], v[28:31], v[52:55]
    s_cmp_eq_u64 vcc, 0
    s_cselect_b32 s58, s58, 0
    s_cmp_lg_u32 s58, 0
    s_cselect_b32 s52, 1, 0
    v_mfma_f32_16x16x32_bf16 v[56:59], a[148:151], v[28:31], v[56:59]
    s_mov_b32 m0, s29
    s_add_u32 s29, s29, 4096
    buffer_load_dwordx4 v1, s[56:59], s28 offen offset:0 sc1 lds
    v_mfma_f32_16x16x32_bf16 v[60:63], a[204:207], v[28:31], v[60:63]
    s_waitcnt lgkmcnt(2)
    v_mfma_f32_16x16x32_bf16 v[48:51], a[40:43], v[32:35], v[48:51]
    ds_read_b128 v[24:27], v5 offset:14336
    v_mfma_f32_16x16x32_bf16 v[52:55], a[96:99], v[32:35], v[52:55]
    v_mfma_f32_16x16x32_bf16 v[56:59], a[152:155], v[32:35], v[56:59]
    buffer_load_dwordx4 v1, s[56:59], s28 offen offset:1024 sc1 lds
    v_mfma_f32_16x16x32_bf16 v[60:63], a[208:211], v[32:35], v[60:63]
    v_max3_u32 v158, v158, v32, v36
    v_mfma_f32_16x16x32_bf16 v[48:51], a[44:47], v[36:39], v[48:51]
    ds_read_b128 v[28:31], v5 offset:15360
    v_mfma_f32_16x16x32_bf16 v[52:55], a[100:103], v[36:39], v[52:55]
    v_mfma_f32_16x16x32_bf16 v[56:59], a[156:159], v[36:39], v[56:59]
    buffer_load_dwordx4 v1, s[56:59], s28 offen offset:2048 sc1 lds
    v_mfma_f32_16x16x32_bf16 v[60:63], a[212:215], v[36:39], v[60:63]
    s_waitcnt lgkmcnt(2)
    v_mfma_f32_16x16x32_bf16 v[48:51], a[48:51], v[16:19], v[48:51]
    ds_read_b128 v[32:35], v5 offset:16384
    v_mfma_f32_16x16x32_bf16 v[52:55], a[104:107], v[16:19], v[52:55]
    v_mfma_f32_16x16x32_bf16 v[56:59], a[160:163], v[16:19], v[56:59]
    buffer_load_dwordx4 v1, s[56:59], s28 offen offset:3072 sc1 lds
    v_mfma_f32_16x16x32_bf16 v[60:63], a[216:219], v[16:19], v[60:63]
    v_max3_u32 v158, v158, v16, v20
    v_mfma_f32_16x16x32_bf16 v[48:51], a[52:55], v[20:23], v[48:51]
    ds_read_b128 v[36:39], v5 offset:17408
    v_mfma_f32_16x16x32_bf16 v[52:55], a[108:111], v[20:23], v[52:55]
    v_mfma_f32_16x16x32_bf16 v[56:59], a[164:167], v[20:23], v[56:59]
    s_add_u32 s28, s28, 4096
    s_mov_b32 m0, s29
    s_add_u32 s29, s29, 4096
    buffer_load_dwordx4 v1, s[56:59], s28 offen offset:0 sc1 lds
    v_mfma_f32_16x16x32_bf16 v[60:63], a[220:223], v[20:23], v[60:63]
    s_waitcnt lgkmcnt(2)
    v_mfma_f32_16x16x32_bf16 v[64:67], a[0:3], v[24:27], v[64:67]
    ds_read_b128 v[16:19], v5 offset:18432
    v_mfma_f32_16x16x32_bf16 v[68:71], a[56:59], v[24:27], v[68:71]
    v_mfma_f32_16x16x32_bf16 v[72:75], a[112:115], v[24:27], v[72:75]
    buffer_load_dwordx4 v1, s[56:59], s28 offen offset:1024 sc1 lds
    v_mfma_f32_16x16x32_bf16 v[76:79], a[168:171], v[24:27], v[76:79]
    v_max3_u32 v158, v158, v24, v28
    v_mfma_f32_16x16x32_bf16 v[64:67], a[4:7], v[28:31], v[64:67]
    ds_read_b128 v[20:23], v5 offset:19456
    v_mfma_f32_16x16x32_bf16 v[68:71], a[60:63], v[28:31], v[68:71]
    v_mfma_f32_16x16x32_bf16 v[72:75], a[116:119], v[28:31], v[72:75]
    buffer_load_dwordx4 v1, s[56:59], s28 offen offset:2048 sc1 lds
    v_mfma_f32_16x16x32_bf16 v[76:79], a[172:175], v[28:31], v[76:79]
    s_waitcnt lgkmcnt(2)
    v_mul_f32 v48, v162, v48
    v_mfma_f32_16x16x32_bf16 v[64:67], a[8:11], v[32:35], v[64:67]
    ds_read_b128 v[24:27], v5 offset:20480
    v_mfma_f32_16x16x32_bf16 v[68:71], a[64:67], v[32:35], v[68:71]
    v_mul_f32 v49, v162, v49
    v_mfma_f32_16x16x32_bf16 v[72:75], a[120:123], v[32:35], v[72:75]
    v_mul_f32 v50, v162, v50
    v_mfma_f32_16x16x32_bf16 v[76:79], a[176:179], v[32:35], v[76:79]
    v_max3_u32 v158, v158, v32, v36
    v_mul_f32 v51, v162, v51
    v_mfma_f32_16x16x32_bf16 v[64:67], a[12:15], v[36:39], v[64:67]
    ds_read_b128 v[28:31], v5 offset:21504
    v_mfma_f32_16x16x32_bf16 v[68:71], a[68:71], v[36:39], v[68:71]
    v_mul_f32 v52, v162, v52
    v_mfma_f32_16x16x32_bf16 v[72:75], a[124:127], v[36:39], v[72:75]
    v_mul_f32 v53, v162, v53
    v_mfma_f32_16x16x32_bf16 v[76:79], a[180:183], v[36:39], v[76:79]
    s_waitcnt lgkmcnt(2)
    v_mul_f32 v54, v162, v54
    v_mfma_f32_16x16x32_bf16 v[64:67], a[16:19], v[16:19], v[64:67]
    ds_read_b128 v[32:35], v5 offset:22528
    v_mfma_f32_16x16x32_bf16 v[68:71], a[72:75], v[16:19], v[68:71]
    v_mul_f32 v55, v162, v55
    v_mfma_f32_16x16x32_bf16 v[72:75], a[128:131], v[16:19], v[72:75]
    v_exp_f32 v48, v48
    v_mfma_f32_16x16x32_bf16 v[76:79], a[184:187], v[16:19], v[76:79]
    v_max3_u32 v158, v158, v16, v20
    v_exp_f32 v49, v49
    v_mfma_f32_16x16x32_bf16 v[64:67], a[20:23], v[20:23], v[64:67]
    ds_read_b128 v[36:39], v5 offset:23552
    v_mfma_f32_16x16x32_bf16 v[68:71], a[76:79], v[20:23], v[68:71]
    v_exp_f32 v50, v50
    v_mfma_f32_16x16x32_bf16 v[72:75], a[132:135], v[20:23], v[72:75]
    v_exp_f32 v51, v51
    v_mfma_f32_16x16x32_bf16 v[76:79], a[188:191], v[20:23], v[76:79]
    s_waitcnt lgkmcnt(2)
    v_exp_f32 v52, v52
    v_mfma_f32_16x16x32_bf16 v[64:67], a[24:27], v[24:27], v[64:67]
    ds_read_b128 v[16:19], v5 offset:24576
    v_mfma_f32_16x16x32_bf16 v[68:71], a[80:83], v[24:27], v[68:71]
    v_exp_f32 v53, v53
    v_mfma_f32_16x16x32_bf16 v[72:75], a[136:139], v[24:27], v[72:75]
    v_exp_f32 v54, v54
    v_mfma_f32_16x16x32_bf16 v[76:79], a[192:195], v[24:27], v[76:79]
    v_max3_u32 v158, v158, v24, v28
    v_exp_f32 v55, v55
    v_mfma_f32_16x16x32_bf16 v[64:67], a[28:31], v[28:31], v[64:67]
    ds_read_b128 v[20:23], v5 offset:25600
    v_mfma_f32_16x16x32_bf16 v[68:71], a[84:87], v[28:31], v[68:71]
    v_fma_f32 v48, v48, v164, v164
    v_mfma_f32_16x16x32_bf16 v[72:75], a[140:143], v[28:31], v[72:75]
    v_fma_f32 v49, v49, v164, v164
    v_mfma_f32_16x16x32_bf16 v[76:79], a[196:199], v[28:31], v[76:79]
    s_waitcnt lgkmcnt(2)
    v_fma_f32 v50, v50, v164, v164
    v_mfma_f32_16x16x32_bf16 v[64:67], a[32:35], v[32:35], v[64:67]
    ds_read_b128 v[24:27], v5 offset:26624
    v_mfma_f32_16x16x32_bf16 v[68:71], a[88:91], v[32:35], v[68:71]
    v_fma_f32 v51, v51, v164, v164
    v_mfma_f32_16x16x32_bf16 v[72:75], a[144:147], v[32:35], v[72:75]
    v_fma_f32 v52, v52, v164, v164
    v_mfma_f32_16x16x32_bf16 v[76:79], a[200:203], v[32:35], v[76:79]
    v_max3_u32 v158, v158, v32, v36
    v_fma_f32 v53, v53, v164, v164
    v_mfma_f32_16x16x32_bf16 v[64:67], a[36:39], v[36:39], v[64:67]
    ds_read_b128 v[28:31], v5 offset:27648
    v_mfma_f32_16x16x32_bf16 v[68:71], a[92:95], v[36:39], v[68:71]
    v_fma_f32 v54, v54, v164, v164
    v_mfma_f32_16x16x32_bf16 v[72:75], a[148:151], v[36:39], v[72:75]
    v_fma_f32 v55, v55, v164, v164
    v_mfma_f32_16x16x32_bf16 v[76:79], a[204:207], v[36:39], v[76:79]
    s_waitcnt lgkmcnt(2)
    v_rcp_f32 v48, v48
    v_mfma_f32_16x16x32_bf16 v[64:67], a[40:43], v[16:19], v[64:67]
    v_rcp_f32 v49, v49
    v_mfma_f32_16x16x32_bf16 v[68:71], a[96:99], v[16:19], v[68:71]
    v_rcp_f32 v50, v50
    v_mfma_f32_16x16x32_bf16 v[72:75], a[152:155], v[16:19], v[72:75]
    v_rcp_f32 v51, v51
    v_mfma_f32_16x16x32_bf16 v[76:79], a[208:211], v[16:19], v[76:79]
    v_max3_u32 v158, v158, v16, v20
    v_rcp_f32 v52, v52
    v_mfma_f32_16x16x32_bf16 v[64:67], a[44:47], v[20:23], v[64:67]
    v_rcp_f32 v53, v53
    v_mfma_f32_16x16x32_bf16 v[68:71], a[100:103], v[20:23], v[68:71]
    v_rcp_f32 v54, v54
    v_mfma_f32_16x16x32_bf16 v[72:75], a[156:159], v[20:23], v[72:75]
    v_rcp_f32 v55, v55
    v_mfma_f32_16x16x32_bf16 v[76:79], a[212:215], v[20:23], v[76:79]
    s_waitcnt lgkmcnt(0)
    v_mul_f32 v48, v48, v56
    v_mfma_f32_16x16x32_bf16 v[64:67], a[48:51], v[24:27], v[64:67]
    v_mul_f32 v49, v49, v57
    v_mfma_f32_16x16x32_bf16 v[68:71], a[104:107], v[24:27], v[68:71]
    v_mul_f32 v50, v50, v58
    v_mfma_f32_16x16x32_bf16 v[72:75], a[160:163], v[24:27], v[72:75]
    v_mul_f32 v51, v51, v59
    v_mfma_f32_16x16x32_bf16 v[76:79], a[216:219], v[24:27], v[76:79]
    v_max3_u32 v158, v158, v24, v28
    v_mul_f32 v52, v52, v60
    v_mfma_f32_16x16x32_bf16 v[64:67], a[52:55], v[28:31], v[64:67]
    v_mul_f32 v53, v53, v61
    v_mfma_f32_16x16x32_bf16 v[68:71], a[108:111], v[28:31], v[68:71]
    v_mul_f32 v54, v54, v62
    v_mfma_f32_16x16x32_bf16 v[72:75], a[164:167], v[28:31], v[72:75]
    v_mul_f32 v55, v55, v63
    v_mfma_f32_16x16x32_bf16 v[76:79], a[220:223], v[28:31], v[76:79]
    v_cvt_pk_bf16_f32 v40, v48, v49
    v_cvt_pk_bf16_f32 v41, v50, v51
    v_cvt_pk_bf16_f32 v42, v52, v53
    v_cvt_pk_bf16_f32 v43, v54, v55
    v_min_u32 v40, 0xfffffffe, v40
    v_cmp_eq_u32 vcc, -1, v158
    s_cbranch_vccnz Lredo_151
    buffer_store_dwordx4 v[40:43], v1, s[8:11], s24 offen sc1
    s_nop 3
    v_pk_mul_f32 v[64:65], v[168:169], v[64:65] op_sel_hi:[0,1]
    v_pk_mul_f32 v[66:67], v[168:169], v[66:67] op_sel_hi:[0,1]
    v_pk_mul_f32 v[68:69], v[168:169], v[68:69] op_sel_hi:[0,1]
    v_pk_mul_f32 v[70:71], v[168:169], v[70:71] op_sel_hi:[0,1]
    v_exp_f32 v64, v64
    v_exp_f32 v65, v65
    v_exp_f32 v66, v66
    v_exp_f32 v67, v67
    v_exp_f32 v68, v68
    v_exp_f32 v69, v69
    v_exp_f32 v70, v70
    v_exp_f32 v71, v71
    v_pk_fma_f32 v[64:65], v[64:65], v[170:171], v[170:171] op_sel_hi:[1,0,0]
    v_pk_fma_f32 v[66:67], v[66:67], v[170:171], v[170:171] op_sel_hi:[1,0,0]
    v_pk_fma_f32 v[68:69], v[68:69], v[170:171], v[170:171] op_sel_hi:[1,0,0]
    v_pk_fma_f32 v[70:71], v[70:71], v[170:171], v[170:171] op_sel_hi:[1,0,0]
    v_rcp_f32 v64, v64
    v_rcp_f32 v65, v65
    v_rcp_f32 v66, v66
    v_rcp_f32 v67, v67
    v_rcp_f32 v68, v68
    v_rcp_f32 v69, v69
    v_rcp_f32 v70, v70
    v_rcp_f32 v71, v71
    v_pk_mul_f32 v[64:65], v[64:65], v[72:73]
    v_pk_mul_f32 v[66:67], v[66:67], v[74:75]
    v_pk_mul_f32 v[68:69], v[68:69], v[76:77]
    v_pk_mul_f32 v[70:71], v[70:71], v[78:79]
    v_cvt_pk_bf16_f32 v44, v64, v65
    v_cvt_pk_bf16_f32 v45, v66, v67
    v_cvt_pk_bf16_f32 v46, v68, v69
    v_cvt_pk_bf16_f32 v47, v70, v71
    v_min_u32 v44, 0xfffffffe, v44
    buffer_store_dwordx4 v[44:47], v1, s[8:11], s25 offen sc1
    s_mul_i32 s21, s44, 2048
    s_lshl_b32 s20, s15, 7
    s_add_u32 s21, s21, s20
    s_add_u32 s21, s21, 123146240
    s_barrier
    buffer_store_dword v15, v14, s[8:11], s21 offen sc1
    s_cmp_lt_u32 s46, 64
    s_cbranch_scc1 Lb1_147
Ldone_146:
    s_branch interleave_layers__memory_aug_recurrent_mem_tr__glu_gated_glu__prompt_kernel_exit
Lredo_151:
    s_sub_u32 s18, s18, 64
    s_cbranch_scc1 interleave_layers__memory_aug_recurrent_mem_tr__glu_gated_glu__prompt_kernel_exit
    s_mov_b32 s28, s38
    s_xor_b32 s29, s54, 32768
    s_add_u32 s29, s29, s31
    s_waitcnt vmcnt(0)
    s_barrier
    s_branch Lld_148
Lb1slow_143:
Lpf_154:
    s_sub_u32 s20, s42, s70
    s_cselect_b32 s20, s42, s20
    s_cselect_b32 s14, s71, s74
    s_cselect_b32 s21, s72, s75
    s_cselect_b32 s43, s73, s76
    s_mul_i32 s20, s20, s21
    s_add_u32 s43, s43, s20
    s_lshl_b32 s44, s14, 6
    s_add_u32 s44, s44, s43
    s_cmp_ge_u32 s43, 64
    s_cbranch_scc1 Lpfd_155
    s_add_u32 s42, s42, 1
    s_mul_i32 s24, s44, 114688
    s_add_u32 s24, s24, s30
    s_add_u32 s24, s24, 25690112
    s_add_u32 s25, s24, 57344
    buffer_store_dwordx4 v[176:179], v1, s[8:11], s24 offen sc1
    buffer_store_dwordx4 v[176:179], v1, s[8:11], s25 offen sc1
    s_cmp_lt_u32 s42, 4
    s_cbranch_scc1 Lpf_154
Lpfd_155:
    s_mov_b32 s42, 0
    s_lshl_b32 s20, s12, 2
    s_add_u32 s20, s20, 147392
    v_mov_b32 v10, s20
    v_mov_b32 v11, 147392
    s_mov_b32 s56, s4
    s_mov_b32 s57, s5
    s_mov_b32 s58, 0
    s_mov_b32 s59, 0x20000
    s_mov_b32 s52, 0
    s_mov_b32 s53, 125566976
    s_mov_b32 s54, 0
    s_mov_b32 s54, 32768
    s_sub_u32 s20, s42, s70
    s_cselect_b32 s20, s42, s20
    s_cselect_b32 s45, s71, s74
    s_cselect_b32 s21, s72, s75
    s_cselect_b32 s46, s73, s76
    s_mul_i32 s20, s20, s21
    s_add_u32 s46, s46, s20
    s_lshl_b32 s47, s45, 6
    s_add_u32 s47, s47, s46
    s_lshl_b32 s27, s45, 6
    s_add_u32 s27, s27, s47
    s_lshl_b32 s27, s27, 13
    s_add_u32 s27, s27, 120258560
    s_mul_i32 s38, s47, 28672
    s_add_u32 s38, s38, s31
    s_add_u32 s38, s38, 16515072
Lb1_157:
    s_mov_b32 s44, s47
    s_mov_b32 s26, s27
    s_add_u32 s29, s54, s31
    s_add_u32 s27, s27, 8192
    s_add_u32 s38, s38, 28672
    s_mov_b32 s28, s38
    s_add_u32 s47, s47, 1
    s_add_u32 s46, s46, 1
    s_xor_b32 s54, s54, 32768
    s_mul_i32 s24, s44, 114688
    s_add_u32 s24, s24, s30
    s_add_u32 s24, s24, 25690112
    s_add_u32 s25, s24, 57344
    v_add_u32 v5, s54, v1
    s_add_u32 s37, s24, 458752
    s_cmp_lt_u32 s46, 61
    s_cselect_b32 s37, s37, 125566976
    s_add_u32 s36, s37, 57344
    s_cmp_lt_u32 s46, 64
    s_cselect_b32 s39, 0x10000000, 0
    s_cmp_eq_u32 s52, 1
    s_cbranch_scc1 Lhv_162
Lld_158:
    s_mul_i32 s22, s44, 28672
    s_add_u32 s22, s22, s31
    s_add_u32 s22, s22, 16515072
    s_add_u32 s23, s31, s54
Lsp_159:
    buffer_load_dwordx4 v[104:107], v13, s[8:11], s26 offen sc1
    buffer_load_dwordx4 v[108:111], v6, s[8:11], s26 offen sc1
    s_sub_u32 s18, s18, 1
    s_cbranch_scc1 interleave_layers__memory_aug_recurrent_mem_tr__glu_gated_glu__prompt_kernel_exit
    s_waitcnt vmcnt(0)
    v_max3_u32 v2, v104, v105, v106
    v_max3_u32 v2, v2, v107, v108
    v_max3_u32 v2, v2, v109, v110
    v_max_u32 v2, v2, v111
    v_cmp_eq_u32 vcc, -1, v2
    s_cbranch_vccz Lsok_160
    s_sleep 1
    s_branch Lsp_159
Lsok_160:
    s_mov_b32 m0, s23
    s_add_u32 s23, s23, 4096
    buffer_load_dwordx4 v1, s[8:11], s22 offen offset:0 sc1 lds
    buffer_load_dwordx4 v1, s[8:11], s22 offen offset:1024 sc1 lds
    buffer_load_dwordx4 v1, s[8:11], s22 offen offset:2048 sc1 lds
    buffer_load_dwordx4 v1, s[8:11], s22 offen offset:3072 sc1 lds
    s_add_u32 s22, s22, 4096
    s_mov_b32 m0, s23
    s_add_u32 s23, s23, 4096
    buffer_load_dwordx4 v1, s[8:11], s22 offen offset:0 sc1 lds
    buffer_load_dwordx4 v1, s[8:11], s22 offen offset:1024 sc1 lds
    buffer_load_dwordx4 v1, s[8:11], s22 offen offset:2048 sc1 lds
    s_mov_b32 s52, 0
Lhv_162:
    v_pk_add_f32 v[96:97], v[104:105], v[108:109]
    v_pk_add_f32 v[98:99], v[106:107], v[110:111]
    s_nop 1
    v_permlane32_swap_b32 v96, v98
    v_permlane32_swap_b32 v97, v99
    v_add_f32 v96, v96, v98
    v_add_f32 v97, v97, v99
    s_nop 1
    v_permlane16_swap_b32 v96, v97
    v_add_f32 v96, v96, v97
    v_mov_b32 v97, v96
    s_nop 1
    v_permlane16_swap_b32 v96, v97
    v_mov_b32 v98, v96
    v_mov_b32 v99, v97
    v_permlane32_swap_b32 v96, v98
    v_permlane32_swap_b32 v97, v99
    v_mul_f32 v96, s34, v96
    v_mul_f32 v97, s34, v97
    v_fma_f32 v97, -v96, v96, v97
    v_max_f32 v97, 0, v97
    v_add_f32 v97, s35, v97
    v_sqrt_f32 v156, v97
    v_rsq_f32 v97, v97
    v_mul_f32 v98, s34, v98
    v_mul_f32 v99, s34, v99
    v_fma_f32 v99, -v98, v98, v99
    v_max_f32 v99, 0, v99
    v_add_f32 v99, s35, v99
    v_sqrt_f32 v157, v99
    v_rsq_f32 v99, v99
    s_nop 0
    v_sub_f32 v160, 0, v96
    v_mul_f32 v162, s33, v97
    v_mov_b32 v164, v156
    v_pk_mul_f32 v[48:49], v[160:161], v[80:81] op_sel_hi:[0,1]
    v_pk_mul_f32 v[50:51], v[160:161], v[82:83] op_sel_hi:[0,1]
    v_pk_mul_f32 v[52:53], v[160:161], v[84:85] op_sel_hi:[0,1]
    v_pk_mul_f32 v[54:55], v[160:161], v[86:87] op_sel_hi:[0,1]
    v_pk_mul_f32 v[56:57], v[160:161], v[88:89] op_sel_hi:[0,1]
    v_pk_mul_f32 v[58:59], v[160:161], v[90:91] op_sel_hi:[0,1]
    v_pk_mul_f32 v[60:61], v[160:161], v[92:93] op_sel_hi:[0,1]
    v_pk_mul_f32 v[62:63], v[160:161], v[94:95] op_sel_hi:[0,1]
    v_sub_f32 v166, 0, v98
    v_mul_f32 v168, s33, v99
    v_mov_b32 v170, v157
    v_pk_mul_f32 v[64:65], v[166:167], v[80:81] op_sel_hi:[0,1]
    v_pk_mul_f32 v[66:67], v[166:167], v[82:83] op_sel_hi:[0,1]
    v_pk_mul_f32 v[68:69], v[166:167], v[84:85] op_sel_hi:[0,1]
    v_pk_mul_f32 v[70:71], v[166:167], v[86:87] op_sel_hi:[0,1]
    v_pk_mul_f32 v[72:73], v[166:167], v[88:89] op_sel_hi:[0,1]
    v_pk_mul_f32 v[74:75], v[166:167], v[90:91] op_sel_hi:[0,1]
    v_pk_mul_f32 v[76:77], v[166:167], v[92:93] op_sel_hi:[0,1]
    v_pk_mul_f32 v[78:79], v[166:167], v[94:95] op_sel_hi:[0,1]
    s_cmp_eq_u32 s52, 1
    s_cbranch_scc1 Lgo_163
    s_waitcnt vmcnt(0)
Lgo_163:
    s_waitcnt vmcnt(3)
    s_barrier
    ds_read_b128 v[16:19], v5 offset:0
    ds_read_b128 v[20:23], v5 offset:1024
    ds_read_b128 v[24:27], v5 offset:2048
    ds_read_b128 v[28:31], v5 offset:3072
    s_waitcnt lgkmcnt(2)
    v_mfma_f32_16x16x32_bf16 v[48:51], a[0:3], v[16:19], v[48:51]
    ds_read_b128 v[32:35], v5 offset:4096
    v_mfma_f32_16x16x32_bf16 v[52:55], a[56:59], v[16:19], v[52:55]
    s_mov_b32 s58, s39
    v_mfma_f32_16x16x32_bf16 v[56:59], a[112:115], v[16:19], v[56:59]
    buffer_load_dwordx4 v[104:107], v13, s[56:59], s27 offen sc1
    v_mfma_f32_16x16x32_bf16 v[60:63], a[168:171], v[16:19], v[60:63]
    v_max_u32 v158, v16, v20
    v_mfma_f32_16x16x32_bf16 v[48:51], a[4:7], v[20:23], v[48:51]
    ds_read_b128 v[36:39], v5 offset:5120
    v_mfma_f32_16x16x32_bf16 v[52:55], a[60:63], v[20:23], v[52:55]
    buffer_load_dwordx4 v[108:111], v6, s[56:59], s27 offen sc1
    v_mfma_f32_16x16x32_bf16 v[56:59], a[116:119], v[20:23], v[56:59]
    v_mfma_f32_16x16x32_bf16 v[60:63], a[172:175], v[20:23], v[60:63]
    s_waitcnt lgkmcnt(2)
    v_mfma_f32_16x16x32_bf16 v[48:51], a[8:11], v[24:27], v[48:51]
    ds_read_b128 v[16:19], v5 offset:6144
    v_mfma_f32_16x16x32_bf16 v[52:55], a[64:67], v[24:27], v[52:55]
    buffer_store_dwordx4 v[176:179], v1, s[8:11], s37 offen sc1
    v_mfma_f32_16x16x32_bf16 v[56:59], a[120:123], v[24:27], v[56:59]
    v_mfma_f32_16x16x32_bf16 v[60:63], a[176:179], v[24:27], v[60:63]
    v_max3_u32 v158, v158, v24, v28
    v_mfma_f32_16x16x32_bf16 v[48:51], a[12:15], v[28:31], v[48:51]
    ds_read_b128 v[20:23], v5 offset:7168
    v_mfma_f32_16x16x32_bf16 v[52:55], a[68:71], v[28:31], v[52:55]
    buffer_store_dwordx4 v[176:179], v1, s[8:11], s36 offen sc1
    v_mfma_f32_16x16x32_bf16 v[56:59], a[124:127], v[28:31], v[56:59]
    v_mfma_f32_16x16x32_bf16 v[60:63], a[180:183], v[28:31], v[60:63]
    s_waitcnt lgkmcnt(2)
    v_mfma_f32_16x16x32_bf16 v[48:51], a[16:19], v[32:35], v[48:51]
    ds_read_b128 v[24:27], v5 offset:8192
    v_mfma_f32_16x16x32_bf16 v[52:55], a[72:75], v[32:35], v[52:55]
    v_mfma_f32_16x16x32_bf16 v[56:59], a[128:131], v[32:35], v[56:59]
    v_mfma_f32_16x16x32_bf16 v[60:63], a[184:187], v[32:35], v[60:63]
    v_max3_u32 v158, v158, v32, v36
    v_mfma_f32_16x16x32_bf16 v[48:51], a[20:23], v[36:39], v[48:51]
    ds_read_b128 v[28:31], v5 offset:9216
    v_mfma_f32_16x16x32_bf16 v[52:55], a[76:79], v[36:39], v[52:55]
    v_mfma_f32_16x16x32_bf16 v[56:59], a[132:135], v[36:39], v[56:59]
    v_mfma_f32_16x16x32_bf16 v[60:63], a[188:191], v[36:39], v[60:63]
    s_waitcnt lgkmcnt(2)
    v_mfma_f32_16x16x32_bf16 v[48:51], a[24:27], v[16:19], v[48:51]
    ds_read_b128 v[32:35], v5 offset:10240
    v_mfma_f32_16x16x32_bf16 v[52:55], a[80:83], v[16:19], v[52:55]
    v_mfma_f32_16x16x32_bf16 v[56:59], a[136:139], v[16:19], v[56:59]
    v_mfma_f32_16x16x32_bf16 v[60:63], a[192:195], v[16:19], v[60:63]
    v_max3_u32 v158, v158, v16, v20
    v_mfma_f32_16x16x32_bf16 v[48:51], a[28:31], v[20:23], v[48:51]
    ds_read_b128 v[36:39], v5 offset:11264
    v_mfma_f32_16x16x32_bf16 v[52:55], a[84:87], v[20:23], v[52:55]
    v_mfma_f32_16x16x32_bf16 v[56:59], a[140:143], v[20:23], v[56:59]
    v_mfma_f32_16x16x32_bf16 v[60:63], a[196:199], v[20:23], v[60:63]
    s_waitcnt lgkmcnt(2)
    v_mfma_f32_16x16x32_bf16 v[48:51], a[32:35], v[24:27], v[48:51]
    ds_read_b128 v[16:19], v5 offset:12288
    v_mfma_f32_16x16x32_bf16 v[52:55], a[88:91], v[24:27], v[52:55]
    s_waitcnt vmcnt(2)
    v_max3_u32 v2, v104, v105, v106
    v_max3_u32 v2, v2, v107, v108
    v_max3_u32 v2, v2, v109, v110
    v_max_u32 v2, v2, v111
    v_mfma_f32_16x16x32_bf16 v[56:59], a[144:147], v[24:27], v[56:59]
    v_cmp_eq_u32 vcc, -1, v2
    v_mfma_f32_16x16x32_bf16 v[60:63], a[200:203], v[24:27], v[60:63]
    v_max3_u32 v158, v158, v24, v28
    v_mfma_f32_16x16x32_bf16 v[48:51], a[36:39], v[28:31], v[48:51]
    ds_read_b128 v[20:23], v5 offset:13312
    v_mfma_f32_16x16x32_bf16 v[52:55], a[92:95], v[28:31], v[52:55]
    s_cmp_eq_u64 vcc, 0
    s_cselect_b32 s58, s58, 0
    s_cmp_lg_u32 s58, 0
    s_cselect_b32 s52, 1, 0
    v_mfma_f32_16x16x32_bf16 v[56:59], a[148:151], v[28:31], v[56:59]
    s_mov_b32 m0, s29
    s_add_u32 s29, s29, 4096
    buffer_load_dwordx4 v1, s[56:59], s28 offen offset:0 sc1 lds
    v_mfma_f32_16x16x32_bf16 v[60:63], a[204:207], v[28:31], v[60:63]
    s_waitcnt lgkmcnt(2)
    v_mfma_f32_16x16x32_bf16 v[48:51], a[40:43], v[32:35], v[48:51]
    ds_read_b128 v[24:27], v5 offset:14336
    v_mfma_f32_16x16x32_bf16 v[52:55], a[96:99], v[32:35], v[52:55]
    v_mfma_f32_16x16x32_bf16 v[56:59], a[152:155], v[32:35], v[56:59]
    buffer_load_dwordx4 v1, s[56:59], s28 offen offset:1024 sc1 lds
    v_mfma_f32_16x16x32_bf16 v[60:63], a[208:211], v[32:35], v[60:63]
    v_max3_u32 v158, v158, v32, v36
    v_mfma_f32_16x16x32_bf16 v[48:51], a[44:47], v[36:39], v[48:51]
    ds_read_b128 v[28:31], v5 offset:15360
    v_mfma_f32_16x16x32_bf16 v[52:55], a[100:103], v[36:39], v[52:55]
    v_mfma_f32_16x16x32_bf16 v[56:59], a[156:159], v[36:39], v[56:59]
    buffer_load_dwordx4 v1, s[56:59], s28 offen offset:2048 sc1 lds
    v_mfma_f32_16x16x32_bf16 v[60:63], a[212:215], v[36:39], v[60:63]
    s_waitcnt lgkmcnt(2)
    v_mfma_f32_16x16x32_bf16 v[48:51], a[48:51], v[16:19], v[48:51]
    ds_read_b128 v[32:35], v5 offset:16384
    v_mfma_f32_16x16x32_bf16 v[52:55], a[104:107], v[16:19], v[52:55]
    v_mfma_f32_16x16x32_bf16 v[56:59], a[160:163], v[16:19], v[56:59]
    buffer_load_dwordx4 v1, s[56:59], s28 offen offset:3072 sc1 lds
    v_mfma_f32_16x16x32_bf16 v[60:63], a[216:219], v[16:19], v[60:63]
    v_max3_u32 v158, v158, v16, v20
    v_mfma_f32_16x16x32_bf16 v[48:51], a[52:55], v[20:23], v[48:51]
    ds_read_b128 v[36:39], v5 offset:17408
    v_mfma_f32_16x16x32_bf16 v[52:55], a[108:111], v[20:23], v[52:55]
    v_mfma_f32_16x16x32_bf16 v[56:59], a[164:167], v[20:23], v[56:59]
    s_add_u32 s28, s28, 4096
    s_mov_b32 m0, s29
    s_add_u32 s29, s29, 4096
    buffer_load_dwordx4 v1, s[56:59], s28 offen offset:0 sc1 lds
    v_mfma_f32_16x16x32_bf16 v[60:63], a[220:223], v[20:23], v[60:63]
    s_waitcnt lgkmcnt(2)
    v_mfma_f32_16x16x32_bf16 v[64:67], a[0:3], v[24:27], v[64:67]
    ds_read_b128 v[16:19], v5 offset:18432
    v_mfma_f32_16x16x32_bf16 v[68:71], a[56:59], v[24:27], v[68:71]
    v_mfma_f32_16x16x32_bf16 v[72:75], a[112:115], v[24:27], v[72:75]
    buffer_load_dwordx4 v1, s[56:59], s28 offen offset:1024 sc1 lds
    v_mfma_f32_16x16x32_bf16 v[76:79], a[168:171], v[24:27], v[76:79]
    v_max3_u32 v158, v158, v24, v28
    v_mfma_f32_16x16x32_bf16 v[64:67], a[4:7], v[28:31], v[64:67]
    ds_read_b128 v[20:23], v5 offset:19456
    v_mfma_f32_16x16x32_bf16 v[68:71], a[60:63], v[28:31], v[68:71]
    v_mfma_f32_16x16x32_bf16 v[72:75], a[116:119], v[28:31], v[72:75]
    buffer_load_dwordx4 v1, s[56:59], s28 offen offset:2048 sc1 lds
    v_mfma_f32_16x16x32_bf16 v[76:79], a[172:175], v[28:31], v[76:79]
    s_waitcnt lgkmcnt(2)
    v_mul_f32 v48, v162, v48
    v_mfma_f32_16x16x32_bf16 v[64:67], a[8:11], v[32:35], v[64:67]
    ds_read_b128 v[24:27], v5 offset:20480
    v_mfma_f32_16x16x32_bf16 v[68:71], a[64:67], v[32:35], v[68:71]
    v_mul_f32 v49, v162, v49
    v_mfma_f32_16x16x32_bf16 v[72:75], a[120:123], v[32:35], v[72:75]
    v_mul_f32 v50, v162, v50
    v_mfma_f32_16x16x32_bf16 v[76:79], a[176:179], v[32:35], v[76:79]
    v_max3_u32 v158, v158, v32, v36
    v_mul_f32 v51, v162, v51
    v_mfma_f32_16x16x32_bf16 v[64:67], a[12:15], v[36:39], v[64:67]
    ds_read_b128 v[28:31], v5 offset:21504
    v_mfma_f32_16x16x32_bf16 v[68:71], a[68:71], v[36:39], v[68:71]
    v_mul_f32 v52, v162, v52
    v_mfma_f32_16x16x32_bf16 v[72:75], a[124:127], v[36:39], v[72:75]
    v_mul_f32 v53, v162, v53
    v_mfma_f32_16x16x32_bf16 v[76:79], a[180:183], v[36:39], v[76:79]
    s_waitcnt lgkmcnt(2)
    v_mul_f32 v54, v162, v54
    v_mfma_f32_16x16x32_bf16 v[64:67], a[16:19], v[16:19], v[64:67]
    ds_read_b128 v[32:35], v5 offset:22528
    v_mfma_f32_16x16x32_bf16 v[68:71], a[72:75], v[16:19], v[68:71]
    v_mul_f32 v55, v162, v55
    v_mfma_f32_16x16x32_bf16 v[72:75], a[128:131], v[16:19], v[72:75]
    v_exp_f32 v48, v48
    v_mfma_f32_16x16x32_bf16 v[76:79], a[184:187], v[16:19], v[76:79]
    v_max3_u32 v158, v158, v16, v20
    v_exp_f32 v49, v49
    v_mfma_f32_16x16x32_bf16 v[64:67], a[20:23], v[20:23], v[64:67]
    ds_read_b128 v[36:39], v5 offset:23552
    v_mfma_f32_16x16x32_bf16 v[68:71], a[76:79], v[20:23], v[68:71]
    v_exp_f32 v50, v50
    v_mfma_f32_16x16x32_bf16 v[72:75], a[132:135], v[20:23], v[72:75]
    v_exp_f32 v51, v51
    v_mfma_f32_16x16x32_bf16 v[76:79], a[188:191], v[20:23], v[76:79]
    s_waitcnt lgkmcnt(2)
    v_exp_f32 v52, v52
    v_mfma_f32_16x16x32_bf16 v[64:67], a[24:27], v[24:27], v[64:67]
    ds_read_b128 v[16:19], v5 offset:24576
    v_mfma_f32_16x16x32_bf16 v[68:71], a[80:83], v[24:27], v[68:71]
    v_exp_f32 v53, v53
    v_mfma_f32_16x16x32_bf16 v[72:75], a[136:139], v[24:27], v[72:75]
    v_exp_f32 v54, v54
    v_mfma_f32_16x16x32_bf16 v[76:79], a[192:195], v[24:27], v[76:79]
    v_max3_u32 v158, v158, v24, v28
    v_exp_f32 v55, v55
    v_mfma_f32_16x16x32_bf16 v[64:67], a[28:31], v[28:31], v[64:67]
    ds_read_b128 v[20:23], v5 offset:25600
    v_mfma_f32_16x16x32_bf16 v[68:71], a[84:87], v[28:31], v[68:71]
    v_fma_f32 v48, v48, v164, v164
    v_mfma_f32_16x16x32_bf16 v[72:75], a[140:143], v[28:31], v[72:75]
    v_fma_f32 v49, v49, v164, v164
    v_mfma_f32_16x16x32_bf16 v[76:79], a[196:199], v[28:31], v[76:79]
    s_waitcnt lgkmcnt(2)
    v_fma_f32 v50, v50, v164, v164
    v_mfma_f32_16x16x32_bf16 v[64:67], a[32:35], v[32:35], v[64:67]
    ds_read_b128 v[24:27], v5 offset:26624
    v_mfma_f32_16x16x32_bf16 v[68:71], a[88:91], v[32:35], v[68:71]
    v_fma_f32 v51, v51, v164, v164
    v_mfma_f32_16x16x32_bf16 v[72:75], a[144:147], v[32:35], v[72:75]
    v_fma_f32 v52, v52, v164, v164
    v_mfma_f32_16x16x32_bf16 v[76:79], a[200:203], v[32:35], v[76:79]
    v_max3_u32 v158, v158, v32, v36
    v_fma_f32 v53, v53, v164, v164
    v_mfma_f32_16x16x32_bf16 v[64:67], a[36:39], v[36:39], v[64:67]
    ds_read_b128 v[28:31], v5 offset:27648
    v_mfma_f32_16x16x32_bf16 v[68:71], a[92:95], v[36:39], v[68:71]
    v_fma_f32 v54, v54, v164, v164
    v_mfma_f32_16x16x32_bf16 v[72:75], a[148:151], v[36:39], v[72:75]
    v_fma_f32 v55, v55, v164, v164
    v_mfma_f32_16x16x32_bf16 v[76:79], a[204:207], v[36:39], v[76:79]
    s_waitcnt lgkmcnt(2)
    v_rcp_f32 v48, v48
    v_mfma_f32_16x16x32_bf16 v[64:67], a[40:43], v[16:19], v[64:67]
    v_rcp_f32 v49, v49
    v_mfma_f32_16x16x32_bf16 v[68:71], a[96:99], v[16:19], v[68:71]
    v_rcp_f32 v50, v50
    v_mfma_f32_16x16x32_bf16 v[72:75], a[152:155], v[16:19], v[72:75]
    v_rcp_f32 v51, v51
    v_mfma_f32_16x16x32_bf16 v[76:79], a[208:211], v[16:19], v[76:79]
    v_max3_u32 v158, v158, v16, v20
    v_rcp_f32 v52, v52
    v_mfma_f32_16x16x32_bf16 v[64:67], a[44:47], v[20:23], v[64:67]
    v_rcp_f32 v53, v53
    v_mfma_f32_16x16x32_bf16 v[68:71], a[100:103], v[20:23], v[68:71]
    v_rcp_f32 v54, v54
    v_mfma_f32_16x16x32_bf16 v[72:75], a[156:159], v[20:23], v[72:75]
    v_rcp_f32 v55, v55
    v_mfma_f32_16x16x32_bf16 v[76:79], a[212:215], v[20:23], v[76:79]
    s_waitcnt lgkmcnt(0)
    v_mul_f32 v48, v48, v56
    v_mfma_f32_16x16x32_bf16 v[64:67], a[48:51], v[24:27], v[64:67]
    v_mul_f32 v49, v49, v57
    v_mfma_f32_16x16x32_bf16 v[68:71], a[104:107], v[24:27], v[68:71]
    v_mul_f32 v50, v50, v58
    v_mfma_f32_16x16x32_bf16 v[72:75], a[160:163], v[24:27], v[72:75]
    v_mul_f32 v51, v51, v59
    v_mfma_f32_16x16x32_bf16 v[76:79], a[216:219], v[24:27], v[76:79]
    v_max3_u32 v158, v158, v24, v28
    v_mul_f32 v52, v52, v60
    v_mfma_f32_16x16x32_bf16 v[64:67], a[52:55], v[28:31], v[64:67]
    v_mul_f32 v53, v53, v61
    v_mfma_f32_16x16x32_bf16 v[68:71], a[108:111], v[28:31], v[68:71]
    v_mul_f32 v54, v54, v62
    v_mfma_f32_16x16x32_bf16 v[72:75], a[164:167], v[28:31], v[72:75]
    v_mul_f32 v55, v55, v63
    v_mfma_f32_16x16x32_bf16 v[76:79], a[220:223], v[28:31], v[76:79]
    v_cvt_pk_bf16_f32 v40, v48, v49
    v_cvt_pk_bf16_f32 v41, v50, v51
    v_cvt_pk_bf16_f32 v42, v52, v53
    v_cvt_pk_bf16_f32 v43, v54, v55
    v_min_u32 v40, 0xfffffffe, v40
    v_cmp_eq_u32 vcc, -1, v158
    s_cbranch_vccnz Lredo_161
    buffer_store_dwordx4 v[40:43], v1, s[8:11], s24 offen sc1
    s_nop 3
    v_pk_mul_f32 v[64:65], v[168:169], v[64:65] op_sel_hi:[0,1]
    v_pk_mul_f32 v[66:67], v[168:169], v[66:67] op_sel_hi:[0,1]
    v_pk_mul_f32 v[68:69], v[168:169], v[68:69] op_sel_hi:[0,1]
    v_pk_mul_f32 v[70:71], v[168:169], v[70:71] op_sel_hi:[0,1]
    v_exp_f32 v64, v64
    v_exp_f32 v65, v65
    v_exp_f32 v66, v66
    v_exp_f32 v67, v67
    v_exp_f32 v68, v68
    v_exp_f32 v69, v69
    v_exp_f32 v70, v70
    v_exp_f32 v71, v71
    v_pk_fma_f32 v[64:65], v[64:65], v[170:171], v[170:171] op_sel_hi:[1,0,0]
    v_pk_fma_f32 v[66:67], v[66:67], v[170:171], v[170:171] op_sel_hi:[1,0,0]
    v_pk_fma_f32 v[68:69], v[68:69], v[170:171], v[170:171] op_sel_hi:[1,0,0]
    v_pk_fma_f32 v[70:71], v[70:71], v[170:171], v[170:171] op_sel_hi:[1,0,0]
    v_rcp_f32 v64, v64
    v_rcp_f32 v65, v65
    v_rcp_f32 v66, v66
    v_rcp_f32 v67, v67
    v_rcp_f32 v68, v68
    v_rcp_f32 v69, v69
    v_rcp_f32 v70, v70
    v_rcp_f32 v71, v71
    v_pk_mul_f32 v[64:65], v[64:65], v[72:73]
    v_pk_mul_f32 v[66:67], v[66:67], v[74:75]
    v_pk_mul_f32 v[68:69], v[68:69], v[76:77]
    v_pk_mul_f32 v[70:71], v[70:71], v[78:79]
    v_cvt_pk_bf16_f32 v44, v64, v65
    v_cvt_pk_bf16_f32 v45, v66, v67
    v_cvt_pk_bf16_f32 v46, v68, v69
    v_cvt_pk_bf16_f32 v47, v70, v71
    v_min_u32 v44, 0xfffffffe, v44
    buffer_store_dwordx4 v[44:47], v1, s[8:11], s25 offen sc1
    s_mul_i32 s21, s44, 2048
    s_lshl_b32 s20, s15, 7
    s_add_u32 s21, s21, s20
    s_add_u32 s21, s21, 123146240
    s_barrier
    buffer_store_dword v15, v14, s[8:11], s21 offen sc1
    s_cmp_lt_u32 s46, 64
    s_cbranch_scc1 Lb1_157
Ldone_156:
    s_branch interleave_layers__memory_aug_recurrent_mem_tr__glu_gated_glu__prompt_kernel_exit
Lredo_161:
    s_sub_u32 s18, s18, 64
    s_cbranch_scc1 interleave_layers__memory_aug_recurrent_mem_tr__glu_gated_glu__prompt_kernel_exit
    s_mov_b32 s28, s38
    s_xor_b32 s29, s54, 32768
    s_add_u32 s29, s29, s31
    s_waitcnt vmcnt(0)
    s_barrier
    s_branch Lld_158
Lrole6_23:
    v_and_b32 v7, 63, v0
    v_lshlrev_b32 v1, 4, v7
    v_cmp_eq_u32 vcc, 0, v0
    v_mov_b32 v14, 2130706432
    v_mov_b32 v15, 1
    v_cndmask_b32 v14, v14, 0, vcc
    s_cmp_eq_u32 s19, 0
    s_cbranch_scc0 Lsn_166
    s_mov_b32 s70, 32
    s_mov_b32 s71, 0
    s_mov_b32 s72, 2
    s_mov_b32 s73, 0
    s_mov_b32 s74, 1
    s_mov_b32 s75, 4
    s_mov_b32 s76, 56
    s_branch Lsj_165
Lsn_166:
    s_cmp_eq_u32 s19, 1
    s_cbranch_scc0 Lsn_167
    s_mov_b32 s70, 32
    s_mov_b32 s71, 0
    s_mov_b32 s72, 2
    s_mov_b32 s73, 1
    s_mov_b32 s74, 1
    s_mov_b32 s75, 4
    s_mov_b32 s76, 57
    s_branch Lsj_165
Lsn_167:
    s_cmp_eq_u32 s19, 2
    s_cbranch_scc0 Lsn_168
    s_mov_b32 s70, 28
    s_mov_b32 s71, 1
    s_mov_b32 s72, 2
    s_mov_b32 s73, 0
    s_mov_b32 s74, 1
    s_mov_b32 s75, 4
    s_mov_b32 s76, 58
    s_branch Lsj_165
Lsn_168:
    s_mov_b32 s70, 28
    s_mov_b32 s71, 1
    s_mov_b32 s72, 2
    s_mov_b32 s73, 1
    s_mov_b32 s74, 1
    s_mov_b32 s75, 4
    s_mov_b32 s76, 59
Lsj_165:
    s_lshl_b32 s30, s15, 2
    s_add_u32 s30, s30, s12
    v_and_b32 v2, 15, v7
    v_lshrrev_b32 v3, 4, v7
    v_mul_u32_u24 v11, 896, v2
    s_lshl_b32 s20, s30, 5
    v_add_u32 v11, s20, v11
    v_lshl_add_u32 v10, v3, 3, v11
    v_lshlrev_b32 v12, 4, v2
    v_mul_u32_u24 v13, 1792, v3
    v_add_u32 v13, v13, v12
    v_lshl_add_u32 v12, v3, 2, v12
    s_lshl_b32 s20, s30, 8
    v_add_u32 v12, s20, v12
    v_lshrrev_b32 v4, 1, v3
    v_lshl_add_u32 v11, v4, 4, v11
    v_lshlrev_b32 v6, 8, v4
    v_lshl_add_u32 v6, v2, 4, v6
    s_lshl_b32 s20, s30, 9
    v_add_u32 v6, s20, v6
    v_and_b32 v4, 1, v3
    v_mul_u32_u24 v9, 14336, v4
    v_add_u32 v5, v6, v9
    v_add_u32 v11, v11, v9
    v_lshl_add_u32 v6, v4, 3, v6
    v_lshlrev_b32 v169, 2, v7
    v_add_u32 v169, 124928, v169
    s_lshl_b32 s20, s12, 8
    v_add_u32 v168, s20, v169
    v_lshlrev_b32 v13, 4, v2
    v_lshl_add_u32 v12, v3, 2, v13
    s_lshl_b32 s20, s15, 8
    v_add_u32 v12, s20, v12
    v_lshl_add_u32 v13, v3, 9, v13
    v_add_u32 v170, 256, v13
    v_mov_b32 v171, 2130706432
    v_cmp_gt_u32 vcc, 64, v0
    v_cmp_gt_u32 s[20:21], 3, v3
    s_nop 1
    v_cndmask_b32 v12, v171, v12, vcc
    v_cndmask_b32 v170, v171, v170, s[20:21]
    s_load_dwordx2 s[36:37], s[0:1], 80
    s_load_dwordx2 s[48:49], s[0:1], 88
    v_lshrrev_b32 v4, 1, v7
    v_mul_u32_u24 v4, 896, v4
    v_and_b32 v8, 1, v7
    v_lshl_add_u32 v4, v8, 4, v4
    v_min_u32 v8, 13, v2
    v_lshlrev_b32 v8, 7, v8
    s_mul_i32 s31, s12, 28672
    v_lshlrev_b32 v9, 8, v3
    v_and_b32 v2, 15, v7
    v_lshl_add_u32 v9, v2, 3, v9
    v_add_u32 v9, s31, v9
    s_mov_b32 s38, 1605632
    s_mov_b32 s39, 0x20000
    s_mov_b32 s50, 1835008
    s_mov_b32 s51, 0x20000
    s_and_b32 s24, s30, 0xfe
    s_lshl_b32 s24, s24, 5
    s_and_b32 s25, s12, 1
    s_mul_i32 s25, s25, 802816
    s_add_u32 s24, s24, s25
    s_waitcnt lgkmcnt(0)
    s_mov_b32 s23, s31
    s_add_u32 s22, s24, 0
    s_mov_b32 m0, s23
    s_add_u32 s23, s23, 1024
    buffer_load_dwordx4 v4, s[36:39], s22 offen lds
    s_add_u32 s22, s22, 28672
    s_mov_b32 m0, s23
    s_add_u32 s23, s23, 1024
    buffer_load_dwordx4 v4, s[36:39], s22 offen lds
    s_add_u32 s22, s22, 28672
    s_mov_b32 m0, s23
    s_add_u32 s23, s23, 1024
    buffer_load_dwordx4 v4, s[36:39], s22 offen lds
    s_add_u32 s22, s22, 28672
    s_mov_b32 m0, s23
    s_add_u32 s23, s23, 1024
    buffer_load_dwordx4 v4, s[36:39], s22 offen lds
    s_add_u32 s22, s22, 28672
    s_mov_b32 m0, s23
    s_add_u32 s23, s23, 1024
    buffer_load_dwordx4 v4, s[36:39], s22 offen lds
    s_add_u32 s22, s22, 28672
    s_mov_b32 m0, s23
    s_add_u32 s23, s23, 1024
    buffer_load_dwordx4 v4, s[36:39], s22 offen lds
    s_add_u32 s22, s22, 28672
    s_mov_b32 m0, s23
    s_add_u32 s23, s23, 1024
    buffer_load_dwordx4 v4, s[36:39], s22 offen lds
    s_add_u32 s22, s22, 28672
    s_mov_b32 m0, s23
    s_add_u32 s23, s23, 1024
    buffer_load_dwordx4 v4, s[36:39], s22 offen lds
    s_add_u32 s22, s22, 28672
    s_mov_b32 m0, s23
    s_add_u32 s23, s23, 1024
    buffer_load_dwordx4 v4, s[36:39], s22 offen lds
    s_add_u32 s22, s22, 28672
    s_mov_b32 m0, s23
    s_add_u32 s23, s23, 1024
    buffer_load_dwordx4 v4, s[36:39], s22 offen lds
    s_add_u32 s22, s22, 28672
    s_mov_b32 m0, s23
    s_add_u32 s23, s23, 1024
    buffer_load_dwordx4 v4, s[36:39], s22 offen lds
    s_add_u32 s22, s22, 28672
    s_mov_b32 m0, s23
    s_add_u32 s23, s23, 1024
    buffer_load_dwordx4 v4, s[36:39], s22 offen lds
    s_add_u32 s22, s22, 28672
    s_mov_b32 m0, s23
    s_add_u32 s23, s23, 1024
    buffer_load_dwordx4 v4, s[36:39], s22 offen lds
    s_add_u32 s22, s22, 28672
    s_mov_b32 m0, s23
    s_add_u32 s23, s23, 1024
    buffer_load_dwordx4 v4, s[36:39], s22 offen lds
    s_add_u32 s22, s22, 28672
    s_mov_b32 m0, s23
    s_add_u32 s23, s23, 1024
    buffer_load_dwordx4 v4, s[36:39], s22 offen lds
    s_add_u32 s22, s22, 28672
    s_mov_b32 m0, s23
    s_add_u32 s23, s23, 1024
    buffer_load_dwordx4 v4, s[36:39], s22 offen lds
    s_add_u32 s22, s22, 28672
    s_mov_b32 m0, s23
    s_add_u32 s23, s23, 1024
    buffer_load_dwordx4 v4, s[36:39], s22 offen lds
    s_add_u32 s22, s22, 28672
    s_mov_b32 m0, s23
    s_add_u32 s23, s23, 1024
    buffer_load_dwordx4 v4, s[36:39], s22 offen lds
    s_add_u32 s22, s22, 28672
    s_mov_b32 m0, s23
    s_add_u32 s23, s23, 1024
    buffer_load_dwordx4 v4, s[36:39], s22 offen lds
    s_add_u32 s22, s22, 28672
    s_mov_b32 m0, s23
    s_add_u32 s23, s23, 1024
    buffer_load_dwordx4 v4, s[36:39], s22 offen lds
    s_add_u32 s22, s22, 28672
    s_mov_b32 m0, s23
    s_add_u32 s23, s23, 1024
    buffer_load_dwordx4 v4, s[36:39], s22 offen lds
    s_add_u32 s22, s22, 28672
    s_mov_b32 m0, s23
    s_add_u32 s23, s23, 1024
    buffer_load_dwordx4 v4, s[36:39], s22 offen lds
    s_add_u32 s22, s22, 28672
    s_mov_b32 m0, s23
    s_add_u32 s23, s23, 1024
    buffer_load_dwordx4 v4, s[36:39], s22 offen lds
    s_add_u32 s22, s22, 28672
    s_mov_b32 m0, s23
    s_add_u32 s23, s23, 1024
    buffer_load_dwordx4 v4, s[36:39], s22 offen lds
    s_add_u32 s22, s22, 28672
    s_mov_b32 m0, s23
    s_add_u32 s23, s23, 1024
    buffer_load_dwordx4 v4, s[36:39], s22 offen lds
    s_add_u32 s22, s22, 28672
    s_mov_b32 m0, s23
    s_add_u32 s23, s23, 1024
    buffer_load_dwordx4 v4, s[36:39], s22 offen lds
    s_add_u32 s22, s22, 28672
    s_mov_b32 m0, s23
    s_add_u32 s23, s23, 1024
    buffer_load_dwordx4 v4, s[36:39], s22 offen lds
    s_add_u32 s22, s22, 28672
    s_mov_b32 m0, s23
    s_add_u32 s23, s23, 1024
    buffer_load_dwordx4 v4, s[36:39], s22 offen lds
    s_add_u32 s22, s22, 28672
    s_waitcnt vmcnt(24) lgkmcnt(0)
    ds_read_b64_tr_b16 a[0:1], v9 offset:0
    ds_read_b64_tr_b16 a[2:3], v9 offset:128
    ds_read_b64_tr_b16 a[4:5], v9 offset:1024
    ds_read_b64_tr_b16 a[6:7], v9 offset:1152
    ds_read_b64_tr_b16 a[8:9], v9 offset:2048
    ds_read_b64_tr_b16 a[10:11], v9 offset:2176
    ds_read_b64_tr_b16 a[12:13], v9 offset:3072
    ds_read_b64_tr_b16 a[14:15], v9 offset:3200
    s_waitcnt vmcnt(20) lgkmcnt(0)
    ds_read_b64_tr_b16 a[16:17], v9 offset:4096
    ds_read_b64_tr_b16 a[18:19], v9 offset:4224
    ds_read_b64_tr_b16 a[20:21], v9 offset:5120
    ds_read_b64_tr_b16 a[22:23], v9 offset:5248
    ds_read_b64_tr_b16 a[24:25], v9 offset:6144
    ds_read_b64_tr_b16 a[26:27], v9 offset:6272
    ds_read_b64_tr_b16 a[28:29], v9 offset:7168
    ds_read_b64_tr_b16 a[30:31], v9 offset:7296
    s_waitcnt vmcnt(16) lgkmcnt(0)
    ds_read_b64_tr_b16 a[32:33], v9 offset:8192
    ds_read_b64_tr_b16 a[34:35], v9 offset:8320
    ds_read_b64_tr_b16 a[36:37], v9 offset:9216
    ds_read_b64_tr_b16 a[38:39], v9 offset:9344
    ds_read_b64_tr_b16 a[40:41], v9 offset:10240
    ds_read_b64_tr_b16 a[42:43], v9 offset:10368
    ds_read_b64_tr_b16 a[44:45], v9 offset:11264
    ds_read_b64_tr_b16 a[46:47], v9 offset:11392
    s_waitcnt vmcnt(12) lgkmcnt(0)
    ds_read_b64_tr_b16 a[48:49], v9 offset:12288
    ds_read_b64_tr_b16 a[50:51], v9 offset:12416
    ds_read_b64_tr_b16 a[52:53], v9 offset:13312
    ds_read_b64_tr_b16 a[54:55], v9 offset:13440
    ds_read_b64_tr_b16 a[56:57], v9 offset:14336
    ds_read_b64_tr_b16 a[58:59], v9 offset:14464
    ds_read_b64_tr_b16 a[60:61], v9 offset:15360
    ds_read_b64_tr_b16 a[62:63], v9 offset:15488
    s_waitcnt vmcnt(8) lgkmcnt(0)
    ds_read_b64_tr_b16 a[64:65], v9 offset:16384
    ds_read_b64_tr_b16 a[66:67], v9 offset:16512
    ds_read_b64_tr_b16 a[68:69], v9 offset:17408
    ds_read_b64_tr_b16 a[70:71], v9 offset:17536
    ds_read_b64_tr_b16 a[72:73], v9 offset:18432
    ds_read_b64_tr_b16 a[74:75], v9 offset:18560
    ds_read_b64_tr_b16 a[76:77], v9 offset:19456
    ds_read_b64_tr_b16 a[78:79], v9 offset:19584
    s_waitcnt vmcnt(4) lgkmcnt(0)
    ds_read_b64_tr_b16 a[80:81], v9 offset:20480
    ds_read_b64_tr_b16 a[82:83], v9 offset:20608
    ds_read_b64_tr_b16 a[84:85], v9 offset:21504
    ds_read_b64_tr_b16 a[86:87], v9 offset:21632
    ds_read_b64_tr_b16 a[88:89], v9 offset:22528
    ds_read_b64_tr_b16 a[90:91], v9 offset:22656
    ds_read_b64_tr_b16 a[92:93], v9 offset:23552
    ds_read_b64_tr_b16 a[94:95], v9 offset:23680
    s_waitcnt vmcnt(0) lgkmcnt(0)
    ds_read_b64_tr_b16 a[96:97], v9 offset:24576
    ds_read_b64_tr_b16 a[98:99], v9 offset:24704
    ds_read_b64_tr_b16 a[100:101], v9 offset:25600
    ds_read_b64_tr_b16 a[102:103], v9 offset:25728
    ds_read_b64_tr_b16 a[104:105], v9 offset:26624
    ds_read_b64_tr_b16 a[106:107], v9 offset:26752
    ds_read_b64_tr_b16 a[108:109], v9 offset:27648
    ds_read_b64_tr_b16 a[110:111], v9 offset:27776
    s_waitcnt lgkmcnt(0)
    s_mov_b32 s23, s31
    s_add_u32 s22, s24, 32
    s_mov_b32 m0, s23
    s_add_u32 s23, s23, 1024
    buffer_load_dwordx4 v4, s[36:39], s22 offen lds
    s_add_u32 s22, s22, 28672
    s_mov_b32 m0, s23
    s_add_u32 s23, s23, 1024
    buffer_load_dwordx4 v4, s[36:39], s22 offen lds
    s_add_u32 s22, s22, 28672
    s_mov_b32 m0, s23
    s_add_u32 s23, s23, 1024
    buffer_load_dwordx4 v4, s[36:39], s22 offen lds
    s_add_u32 s22, s22, 28672
    s_mov_b32 m0, s23
    s_add_u32 s23, s23, 1024
    buffer_load_dwordx4 v4, s[36:39], s22 offen lds
    s_add_u32 s22, s22, 28672
    s_mov_b32 m0, s23
    s_add_u32 s23, s23, 1024
    buffer_load_dwordx4 v4, s[36:39], s22 offen lds
    s_add_u32 s22, s22, 28672
    s_mov_b32 m0, s23
    s_add_u32 s23, s23, 1024
    buffer_load_dwordx4 v4, s[36:39], s22 offen lds
    s_add_u32 s22, s22, 28672
    s_mov_b32 m0, s23
    s_add_u32 s23, s23, 1024
    buffer_load_dwordx4 v4, s[36:39], s22 offen lds
    s_add_u32 s22, s22, 28672
    s_mov_b32 m0, s23
    s_add_u32 s23, s23, 1024
    buffer_load_dwordx4 v4, s[36:39], s22 offen lds
    s_add_u32 s22, s22, 28672
    s_mov_b32 m0, s23
    s_add_u32 s23, s23, 1024
    buffer_load_dwordx4 v4, s[36:39], s22 offen lds
    s_add_u32 s22, s22, 28672
    s_mov_b32 m0, s23
    s_add_u32 s23, s23, 1024
    buffer_load_dwordx4 v4, s[36:39], s22 offen lds
    s_add_u32 s22, s22, 28672
    s_mov_b32 m0, s23
    s_add_u32 s23, s23, 1024
    buffer_load_dwordx4 v4, s[36:39], s22 offen lds
    s_add_u32 s22, s22, 28672
    s_mov_b32 m0, s23
    s_add_u32 s23, s23, 1024
    buffer_load_dwordx4 v4, s[36:39], s22 offen lds
    s_add_u32 s22, s22, 28672
    s_mov_b32 m0, s23
    s_add_u32 s23, s23, 1024
    buffer_load_dwordx4 v4, s[36:39], s22 offen lds
    s_add_u32 s22, s22, 28672
    s_mov_b32 m0, s23
    s_add_u32 s23, s23, 1024
    buffer_load_dwordx4 v4, s[36:39], s22 offen lds
    s_add_u32 s22, s22, 28672
    s_mov_b32 m0, s23
    s_add_u32 s23, s23, 1024
    buffer_load_dwordx4 v4, s[36:39], s22 offen lds
    s_add_u32 s22, s22, 28672
    s_mov_b32 m0, s23
    s_add_u32 s23, s23, 1024
    buffer_load_dwordx4 v4, s[36:39], s22 offen lds
    s_add_u32 s22, s22, 28672
    s_mov_b32 m0, s23
    s_add_u32 s23, s23, 1024
    buffer_load_dwordx4 v4, s[36:39], s22 offen lds
    s_add_u32 s22, s22, 28672
    s_mov_b32 m0, s23
    s_add_u32 s23, s23, 1024
    buffer_load_dwordx4 v4, s[36:39], s22 offen lds
    s_add_u32 s22, s22, 28672
    s_mov_b32 m0, s23
    s_add_u32 s23, s23, 1024
    buffer_load_dwordx4 v4, s[36:39], s22 offen lds
    s_add_u32 s22, s22, 28672
    s_mov_b32 m0, s23
    s_add_u32 s23, s23, 1024
    buffer_load_dwordx4 v4, s[36:39], s22 offen lds
    s_add_u32 s22, s22, 28672
    s_mov_b32 m0, s23
    s_add_u32 s23, s23, 1024
    buffer_load_dwordx4 v4, s[36:39], s22 offen lds
    s_add_u32 s22, s22, 28672
    s_mov_b32 m0, s23
    s_add_u32 s23, s23, 1024
    buffer_load_dwordx4 v4, s[36:39], s22 offen lds
    s_add_u32 s22, s22, 28672
    s_mov_b32 m0, s23
    s_add_u32 s23, s23, 1024
    buffer_load_dwordx4 v4, s[36:39], s22 offen lds
    s_add_u32 s22, s22, 28672
    s_mov_b32 m0, s23
    s_add_u32 s23, s23, 1024
    buffer_load_dwordx4 v4, s[36:39], s22 offen lds
    s_add_u32 s22, s22, 28672
    s_mov_b32 m0, s23
    s_add_u32 s23, s23, 1024
    buffer_load_dwordx4 v4, s[36:39], s22 offen lds
    s_add_u32 s22, s22, 28672
    s_mov_b32 m0, s23
    s_add_u32 s23, s23, 1024
    buffer_load_dwordx4 v4, s[36:39], s22 offen lds
    s_add_u32 s22, s22, 28672
    s_mov_b32 m0, s23
    s_add_u32 s23, s23, 1024
    buffer_load_dwordx4 v4, s[36:39], s22 offen lds
    s_add_u32 s22, s22, 28672
    s_mov_b32 m0, s23
    s_add_u32 s23, s23, 1024
    buffer_load_dwordx4 v4, s[36:39], s22 offen lds
    s_add_u32 s22, s22, 28672
    s_waitcnt vmcnt(24) lgkmcnt(0)
    ds_read_b64_tr_b16 a[112:113], v9 offset:0
    ds_read_b64_tr_b16 a[114:115], v9 offset:128
    ds_read_b64_tr_b16 a[116:117], v9 offset:1024
    ds_read_b64_tr_b16 a[118:119], v9 offset:1152
    ds_read_b64_tr_b16 a[120:121], v9 offset:2048
    ds_read_b64_tr_b16 a[122:123], v9 offset:2176
    ds_read_b64_tr_b16 a[124:125], v9 offset:3072
    ds_read_b64_tr_b16 a[126:127], v9 offset:3200
    s_waitcnt vmcnt(20) lgkmcnt(0)
    ds_read_b64_tr_b16 a[128:129], v9 offset:4096
    ds_read_b64_tr_b16 a[130:131], v9 offset:4224
    ds_read_b64_tr_b16 a[132:133], v9 offset:5120
    ds_read_b64_tr_b16 a[134:135], v9 offset:5248
    ds_read_b64_tr_b16 a[136:137], v9 offset:6144
    ds_read_b64_tr_b16 a[138:139], v9 offset:6272
    ds_read_b64_tr_b16 a[140:141], v9 offset:7168
    ds_read_b64_tr_b16 a[142:143], v9 offset:7296
    s_waitcnt vmcnt(16) lgkmcnt(0)
    ds_read_b64_tr_b16 a[144:145], v9 offset:8192
    ds_read_b64_tr_b16 a[146:147], v9 offset:8320
    ds_read_b64_tr_b16 a[148:149], v9 offset:9216
    ds_read_b64_tr_b16 a[150:151], v9 offset:9344
    ds_read_b64_tr_b16 a[152:153], v9 offset:10240
    ds_read_b64_tr_b16 a[154:155], v9 offset:10368
    ds_read_b64_tr_b16 a[156:157], v9 offset:11264
    ds_read_b64_tr_b16 a[158:159], v9 offset:11392
    s_waitcnt vmcnt(12) lgkmcnt(0)
    ds_read_b64_tr_b16 a[160:161], v9 offset:12288
    ds_read_b64_tr_b16 a[162:163], v9 offset:12416
    ds_read_b64_tr_b16 a[164:165], v9 offset:13312
    ds_read_b64_tr_b16 a[166:167], v9 offset:13440
    ds_read_b64_tr_b16 a[168:169], v9 offset:14336
    ds_read_b64_tr_b16 a[170:171], v9 offset:14464
    ds_read_b64_tr_b16 a[172:173], v9 offset:15360
    ds_read_b64_tr_b16 a[174:175], v9 offset:15488
    s_waitcnt vmcnt(8) lgkmcnt(0)
    ds_read_b64_tr_b16 a[176:177], v9 offset:16384
    ds_read_b64_tr_b16 a[178:179], v9 offset:16512
    ds_read_b64_tr_b16 a[180:181], v9 offset:17408
    ds_read_b64_tr_b16 a[182:183], v9 offset:17536
    ds_read_b64_tr_b16 a[184:185], v9 offset:18432
    ds_read_b64_tr_b16 a[186:187], v9 offset:18560
    ds_read_b64_tr_b16 a[188:189], v9 offset:19456
    ds_read_b64_tr_b16 a[190:191], v9 offset:19584
    s_waitcnt vmcnt(4) lgkmcnt(0)
    ds_read_b64_tr_b16 a[192:193], v9 offset:20480
    ds_read_b64_tr_b16 a[194:195], v9 offset:20608
    ds_read_b64_tr_b16 a[196:197], v9 offset:21504
    ds_read_b64_tr_b16 a[198:199], v9 offset:21632
    ds_read_b64_tr_b16 a[200:201], v9 offset:22528
    ds_read_b64_tr_b16 a[202:203], v9 offset:22656
    ds_read_b64_tr_b16 a[204:205], v9 offset:23552
    ds_read_b64_tr_b16 a[206:207], v9 offset:23680
    s_waitcnt vmcnt(0) lgkmcnt(0)
    ds_read_b64_tr_b16 a[208:209], v9 offset:24576
    ds_read_b64_tr_b16 a[210:211], v9 offset:24704
    ds_read_b64_tr_b16 a[212:213], v9 offset:25600
    ds_read_b64_tr_b16 a[214:215], v9 offset:25728
    ds_read_b64_tr_b16 a[216:217], v9 offset:26624
    ds_read_b64_tr_b16 a[218:219], v9 offset:26752
    ds_read_b64_tr_b16 a[220:221], v9 offset:27648
    ds_read_b64_tr_b16 a[222:223], v9 offset:27776
    s_waitcnt lgkmcnt(0)
    v_lshlrev_b32 v16, 7, v0
    s_mov_b32 s20, 125698048
Lwd_170:
    buffer_load_dwordx2 v[18:19], v16, s[8:11], s20 offen offset:0 sc1
    s_sub_u32 s18, s18, 1
    s_cbranch_scc1 interleave_layers__memory_aug_recurrent_mem_tr__glu_gated_glu__prompt_kernel_exit
    s_waitcnt vmcnt(0)
    v_xor_b32 v18, s78, v18
    v_xor_b32 v19, s79, v19
    v_or_b32 v18, v18, v19
    v_cmp_ne_u32 vcc, 0, v18
    s_cbranch_vccz Lwdok_171
    s_sleep 2
    s_branch Lwd_170
Lwdok_171:
    s_barrier
    v_and_b32 v16, 7, v0
    v_lshlrev_b32 v16, 7, v16
    s_mov_b32 s21, 125730816
Lcm_172:
    buffer_load_dword v17, v16, s[8:11], s21 offen sc1
    s_sub_u32 s18, s18, 1
    s_cbranch_scc1 interleave_layers__memory_aug_recurrent_mem_tr__glu_gated_glu__prompt_kernel_exit
    s_waitcnt vmcnt(0)
    s_lshr_b32 s23, s13, 5
    s_nop 3
    v_readlane_b32 s22, v17, s23
    s_cmp_ge_u32 s22, 32
    s_cbranch_scc1 Lcmd_173
    s_mov_b32 s23, 0
    v_readlane_b32 s22, v17, 0
    s_add_u32 s23, s23, s22
    v_readlane_b32 s22, v17, 1
    s_add_u32 s23, s23, s22
    v_readlane_b32 s22, v17, 2
    s_add_u32 s23, s23, s22
    v_readlane_b32 s22, v17, 3
    s_add_u32 s23, s23, s22
    v_readlane_b32 s22, v17, 4
    s_add_u32 s23, s23, s22
    v_readlane_b32 s22, v17, 5
    s_add_u32 s23, s23, s22
    v_readlane_b32 s22, v17, 6
    s_add_u32 s23, s23, s22
    v_readlane_b32 s22, v17, 7
    s_add_u32 s23, s23, s22
    s_cmp_lt_u32 s23, 256
    s_cbranch_scc1 Lcm_172
    s_mov_b32 s16, 0
Lcmd_173:
    v_mov_b32 v28, -1
    v_mov_b32 v29, -1
    v_mov_b32 v30, -1
    v_mov_b32 v31, -1
    s_mov_b32 s42, 0
Lpf_174:
    s_sub_u32 s20, s42, s70
    s_cselect_b32 s20, s42, s20
    s_cselect_b32 s14, s71, s74
    s_cselect_b32 s21, s72, s75
    s_cselect_b32 s43, s73, s76
    s_mul_i32 s20, s20, s21
    s_add_u32 s43, s43, s20
    s_lshl_b32 s44, s14, 6
    s_add_u32 s44, s44, s43
    s_cmp_ge_u32 s43, 64
    s_cbranch_scc1 Lpfd_175
    s_add_u32 s42, s42, 1
    s_cmp_eq_u32 s14, 0
    s_cbranch_scc0 Lpf_174
    s_mul_i32 s23, s43, 28672
    s_add_u32 s25, s23, 14680064
    s_add_u32 s26, s23, 23855104
    buffer_store_dwordx4 v[28:31], v5, s[8:11], s25 offen sc1
    buffer_store_dwordx4 v[28:31], v5, s[8:11], s26 offen sc1
    s_waitcnt vmcnt(32)
    s_branch Lpf_174
Lpfd_175:
    s_and_b32 s31, s12, 1
    s_mul_i32 s31, s31, 28672
    v_add_u32 v9, s31, v1
    v_add_u32 v171, 57344, v9
    s_lshr_b32 s25, s12, 1
    s_mul_i32 s25, s25, 57344
    s_add_u32 s31, s31, s25
    s_lshl_b32 s25, s12, 11
    s_add_u32 s25, s25, 114688
    v_add_u32 v172, s25, v1
    v_xor_b32 v173, 2048, v172
    s_mov_b32 s42, 0
    s_sub_u32 s20, s42, s70
    s_cselect_b32 s20, s42, s20
    s_cselect_b32 s45, s71, s74
    s_cselect_b32 s21, s72, s75
    s_cselect_b32 s46, s73, s76
    s_mul_i32 s20, s20, s21
    s_add_u32 s46, s46, s20
    s_lshl_b32 s47, s45, 6
    s_add_u32 s47, s47, s46
    s_cmp_ge_u32 s46, 64
    s_cbranch_scc1 Lne_179
    s_mul_i32 s29, s47, 2048
    s_add_u32 s29, s29, 123146240
    buffer_load_dword v4, v8, s[8:11], s29 offen sc1
Lne_179:
    s_waitcnt vmcnt(0)
Lb2_176:
    s_mov_b32 s14, s45
    s_mov_b32 s43, s46
    s_mov_b32 s44, s47
    v_cmp_eq_u32 vcc, 0, v4
    s_cbranch_vccz Lld_177
Lwf_180:
    buffer_load_dword v4, v8, s[8:11], s29 offen sc1
    s_sub_u32 s18, s18, 1
    s_cbranch_scc1 interleave_layers__memory_aug_recurrent_mem_tr__glu_gated_glu__prompt_kernel_exit
    s_waitcnt vmcnt(0)
    v_cmp_eq_u32 vcc, 0, v4
    s_cbranch_vccz Lwfok_181
    s_sleep 2
    s_branch Lwf_180
Lwfok_181:
Lld_177:
    s_barrier
    s_mul_i32 s22, s44, 114688
    s_add_u32 s22, s22, 25690112
    s_add_u32 s22, s22, s31
    s_mov_b32 s23, s31
    s_mov_b32 m0, s23
    s_add_u32 s23, s23, 4096
    buffer_load_dwordx4 v1, s[8:11], s22 offen offset:0 sc1 lds
    buffer_load_dwordx4 v1, s[8:11], s22 offen offset:1024 sc1 lds
    buffer_load_dwordx4 v1, s[8:11], s22 offen offset:2048 sc1 lds
    buffer_load_dwordx4 v1, s[8:11], s22 offen offset:3072 sc1 lds
    s_add_u32 s22, s22, 4096
    s_mov_b32 m0, s23
    s_add_u32 s23, s23, 4096
    buffer_load_dwordx4 v1, s[8:11], s22 offen offset:0 sc1 lds
    buffer_load_dwordx4 v1, s[8:11], s22 offen offset:1024 sc1 lds
    buffer_load_dwordx4 v1, s[8:11], s22 offen offset:2048 sc1 lds
    buffer_load_dwordx4 v1, s[8:11], s22 offen offset:3072 sc1 lds
    s_add_u32 s22, s22, 4096
Lld_177_j:
    s_mov_b32 m0, s23
    s_add_u32 s23, s23, 4096
    buffer_load_dwordx4 v1, s[8:11], s22 offen offset:0 sc1 lds
    buffer_load_dwordx4 v1, s[8:11], s22 offen offset:1024 sc1 lds
    buffer_load_dwordx4 v1, s[8:11], s22 offen offset:2048 sc1 lds
    buffer_load_dwordx4 v1, s[8:11], s22 offen offset:3072 sc1 lds
    s_add_u32 s22, s22, 4096
    s_mul_i32 s26, s44, 28672
    s_add_u32 s26, s26, 16515072
    s_add_u32 s27, s26, 14336
    s_lshl_b32 s24, s43, 13
    s_add_u32 s24, s24, 120782848
    s_waitcnt vmcnt(8)
    s_barrier
    ds_read_b128 v[120:123], v9 offset:0
    ds_read_b128 v[124:127], v171 offset:0
    ds_read_b128 v[128:131], v9 offset:1024
    ds_read_b128 v[132:135], v171 offset:1024
    ds_read_b128 v[136:139], v9 offset:2048
    ds_read_b128 v[140:143], v171 offset:2048
    s_waitcnt lgkmcnt(4)
    v_mfma_f32_16x16x32_bf16 v[64:67], a[0:3], v[120:123], 0
    ds_read_b128 v[144:147], v9 offset:3072
    v_mfma_f32_16x16x32_bf16 v[72:75], a[112:115], v[120:123], 0
    ds_read_b128 v[148:151], v171 offset:3072
    v_mfma_f32_16x16x32_bf16 v[68:71], a[0:3], v[124:127], 0
    v_max_u32 v36, v120, v124
    s_mov_b32 m0, s23
    v_mfma_f32_16x16x32_bf16 v[76:79], a[112:115], v[124:127], 0
    s_waitcnt lgkmcnt(4)
    v_mfma_f32_16x16x32_bf16 v[64:67], a[4:7], v[128:131], v[64:67]
    s_add_u32 s23, s23, 4096
    v_mfma_f32_16x16x32_bf16 v[72:75], a[116:119], v[128:131], v[72:75]
    buffer_load_dwordx4 v1, s[8:11], s22 offen offset:0 sc1 lds
    v_mfma_f32_16x16x32_bf16 v[68:71], a[4:7], v[132:135], v[68:71]
    v_max3_u32 v36, v36, v128, v132
    v_mfma_f32_16x16x32_bf16 v[76:79], a[116:119], v[132:135], v[76:79]
    s_waitcnt lgkmcnt(2)
    v_mfma_f32_16x16x32_bf16 v[64:67], a[8:11], v[136:139], v[64:67]
    buffer_load_dwordx4 v1, s[8:11], s22 offen offset:1024 sc1 lds
    v_mfma_f32_16x16x32_bf16 v[72:75], a[120:123], v[136:139], v[72:75]
    buffer_load_dwordx4 v1, s[8:11], s22 offen offset:2048 sc1 lds
    v_mfma_f32_16x16x32_bf16 v[68:71], a[8:11], v[140:143], v[68:71]
    v_max3_u32 v36, v36, v136, v140
    v_mfma_f32_16x16x32_bf16 v[76:79], a[120:123], v[140:143], v[76:79]
    s_waitcnt lgkmcnt(0)
    v_mfma_f32_16x16x32_bf16 v[64:67], a[12:15], v[144:147], v[64:67]
    buffer_load_dwordx4 v1, s[8:11], s22 offen offset:3072 sc1 lds
    v_mfma_f32_16x16x32_bf16 v[72:75], a[124:127], v[144:147], v[72:75]
    s_add_u32 s22, s22, 4096
    v_mfma_f32_16x16x32_bf16 v[68:71], a[12:15], v[148:151], v[68:71]
    v_max3_u32 v36, v36, v144, v148
    v_mfma_f32_16x16x32_bf16 v[76:79], a[124:127], v[148:151], v[76:79]
    s_waitcnt vmcnt(8)
    s_barrier
    ds_read_b128 v[120:123], v9 offset:4096
    ds_read_b128 v[124:127], v171 offset:4096
    ds_read_b128 v[128:131], v9 offset:5120
    ds_read_b128 v[132:135], v171 offset:5120
    ds_read_b128 v[136:139], v9 offset:6144
    ds_read_b128 v[140:143], v171 offset:6144
    s_waitcnt lgkmcnt(4)
    v_mfma_f32_16x16x32_bf16 v[64:67], a[16:19], v[120:123], v[64:67]
    ds_read_b128 v[144:147], v9 offset:7168
    v_mfma_f32_16x16x32_bf16 v[72:75], a[128:131], v[120:123], v[72:75]
    ds_read_b128 v[148:151], v171 offset:7168
    v_mfma_f32_16x16x32_bf16 v[68:71], a[16:19], v[124:127], v[68:71]
    v_max3_u32 v36, v36, v120, v124
    s_mov_b32 m0, s23
    v_mfma_f32_16x16x32_bf16 v[76:79], a[128:131], v[124:127], v[76:79]
    s_waitcnt lgkmcnt(4)
    v_mfma_f32_16x16x32_bf16 v[64:67], a[20:23], v[128:131], v[64:67]
    s_add_u32 s23, s23, 4096
    v_mfma_f32_16x16x32_bf16 v[72:75], a[132:135], v[128:131], v[72:75]
    buffer_load_dwordx4 v1, s[8:11], s22 offen offset:0 sc1 lds
    v_mfma_f32_16x16x32_bf16 v[68:71], a[20:23], v[132:135], v[68:71]
    v_max3_u32 v36, v36, v128, v132
    v_mfma_f32_16x16x32_bf16 v[76:79], a[132:135], v[132:135], v[76:79]
    s_waitcnt lgkmcnt(2)
    v_mfma_f32_16x16x32_bf16 v[64:67], a[24:27], v[136:139], v[64:67]
    buffer_load_dwordx4 v1, s[8:11], s22 offen offset:1024 sc1 lds
    v_mfma_f32_16x16x32_bf16 v[72:75], a[136:139], v[136:139], v[72:75]
    buffer_load_dwordx4 v1, s[8:11], s22 offen offset:2048 sc1 lds
    v_mfma_f32_16x16x32_bf16 v[68:71], a[24:27], v[140:143], v[68:71]
    v_max3_u32 v36, v36, v136, v140
    v_mfma_f32_16x16x32_bf16 v[76:79], a[136:139], v[140:143], v[76:79]
    s_waitcnt lgkmcnt(0)
    v_mfma_f32_16x16x32_bf16 v[64:67], a[28:31], v[144:147], v[64:67]
    buffer_load_dwordx4 v1, s[8:11], s22 offen offset:3072 sc1 lds
    v_mfma_f32_16x16x32_bf16 v[72:75], a[140:143], v[144:147], v[72:75]
    s_add_u32 s22, s22, 4096
    v_mfma_f32_16x16x32_bf16 v[68:71], a[28:31], v[148:151], v[68:71]
    v_max3_u32 v36, v36, v144, v148
    v_mfma_f32_16x16x32_bf16 v[76:79], a[140:143], v[148:151], v[76:79]
    s_waitcnt vmcnt(8)
    s_barrier
    ds_read_b128 v[120:123], v9 offset:8192
    ds_read_b128 v[124:127], v171 offset:8192
    ds_read_b128 v[128:131], v9 offset:9216
    ds_read_b128 v[132:135], v171 offset:9216
    ds_read_b128 v[136:139], v9 offset:10240
    ds_read_b128 v[140:143], v171 offset:10240
    s_waitcnt lgkmcnt(4)
    v_mfma_f32_16x16x32_bf16 v[64:67], a[32:35], v[120:123], v[64:67]
    ds_read_b128 v[144:147], v9 offset:11264
    v_mfma_f32_16x16x32_bf16 v[72:75], a[144:147], v[120:123], v[72:75]
    ds_read_b128 v[148:151], v171 offset:11264
    v_mfma_f32_16x16x32_bf16 v[68:71], a[32:35], v[124:127], v[68:71]
    v_max3_u32 v36, v36, v120, v124
    s_mov_b32 m0, s23
    v_mfma_f32_16x16x32_bf16 v[76:79], a[144:147], v[124:127], v[76:79]
    s_waitcnt lgkmcnt(4)
    v_mfma_f32_16x16x32_bf16 v[64:67], a[36:39], v[128:131], v[64:67]
    s_add_u32 s23, s23, 4096
    v_mfma_f32_16x16x32_bf16 v[72:75], a[148:151], v[128:131], v[72:75]
    buffer_load_dwordx4 v1, s[8:11], s22 offen offset:0 sc1 lds
    v_mfma_f32_16x16x32_bf16 v[68:71], a[36:39], v[132:135], v[68:71]
    v_max3_u32 v36, v36, v128, v132
    v_mfma_f32_16x16x32_bf16 v[76:79], a[148:151], v[132:135], v[76:79]
    s_waitcnt lgkmcnt(2)
    v_mfma_f32_16x16x32_bf16 v[64:67], a[40:43], v[136:139], v[64:67]
    buffer_load_dwordx4 v1, s[8:11], s22 offen offset:1024 sc1 lds
    v_mfma_f32_16x16x32_bf16 v[72:75], a[152:155], v[136:139], v[72:75]
    buffer_load_dwordx4 v1, s[8:11], s22 offen offset:2048 sc1 lds
    v_mfma_f32_16x16x32_bf16 v[68:71], a[40:43], v[140:143], v[68:71]
    v_max3_u32 v36, v36, v136, v140
    v_mfma_f32_16x16x32_bf16 v[76:79], a[152:155], v[140:143], v[76:79]
    s_waitcnt lgkmcnt(0)
    v_mfma_f32_16x16x32_bf16 v[64:67], a[44:47], v[144:147], v[64:67]
    buffer_load_dwordx4 v1, s[8:11], s22 offen offset:3072 sc1 lds
    v_mfma_f32_16x16x32_bf16 v[72:75], a[156:159], v[144:147], v[72:75]
    s_add_u32 s22, s22, 4096
    v_mfma_f32_16x16x32_bf16 v[68:71], a[44:47], v[148:151], v[68:71]
    v_max3_u32 v36, v36, v144, v148
    v_mfma_f32_16x16x32_bf16 v[76:79], a[156:159], v[148:151], v[76:79]
    s_waitcnt vmcnt(8)
    s_barrier
    ds_read_b128 v[120:123], v9 offset:12288
    ds_read_b128 v[124:127], v171 offset:12288
    ds_read_b128 v[128:131], v9 offset:13312
    ds_read_b128 v[132:135], v171 offset:13312
    ds_read_b128 v[136:139], v9 offset:14336
    ds_read_b128 v[140:143], v171 offset:14336
    s_waitcnt lgkmcnt(4)
    v_mfma_f32_16x16x32_bf16 v[64:67], a[48:51], v[120:123], v[64:67]
    ds_read_b128 v[144:147], v9 offset:15360
    v_mfma_f32_16x16x32_bf16 v[72:75], a[160:163], v[120:123], v[72:75]
    ds_read_b128 v[148:151], v171 offset:15360
    v_mfma_f32_16x16x32_bf16 v[68:71], a[48:51], v[124:127], v[68:71]
    v_max3_u32 v36, v36, v120, v124
    s_mov_b32 m0, s23
    v_mfma_f32_16x16x32_bf16 v[76:79], a[160:163], v[124:127], v[76:79]
    s_waitcnt lgkmcnt(4)
    v_mfma_f32_16x16x32_bf16 v[64:67], a[52:55], v[128:131], v[64:67]
    s_add_u32 s23, s23, 4096
    v_mfma_f32_16x16x32_bf16 v[72:75], a[164:167], v[128:131], v[72:75]
    buffer_load_dwordx4 v1, s[8:11], s22 offen offset:0 sc1 lds
    v_mfma_f32_16x16x32_bf16 v[68:71], a[52:55], v[132:135], v[68:71]
    v_max3_u32 v36, v36, v128, v132
    v_mfma_f32_16x16x32_bf16 v[76:79], a[164:167], v[132:135], v[76:79]
    s_waitcnt lgkmcnt(2)
    v_mfma_f32_16x16x32_bf16 v[64:67], a[56:59], v[136:139], v[64:67]
    buffer_load_dwordx4 v1, s[8:11], s22 offen offset:1024 sc1 lds
    v_mfma_f32_16x16x32_bf16 v[72:75], a[168:171], v[136:139], v[72:75]
    buffer_load_dwordx4 v1, s[8:11], s22 offen offset:2048 sc1 lds
    v_mfma_f32_16x16x32_bf16 v[68:71], a[56:59], v[140:143], v[68:71]
    v_max3_u32 v36, v36, v136, v140
    v_mfma_f32_16x16x32_bf16 v[76:79], a[168:171], v[140:143], v[76:79]
    s_waitcnt lgkmcnt(0)
    v_mfma_f32_16x16x32_bf16 v[64:67], a[60:63], v[144:147], v[64:67]
    buffer_load_dwordx4 v1, s[8:11], s22 offen offset:3072 sc1 lds
    v_mfma_f32_16x16x32_bf16 v[72:75], a[172:175], v[144:147], v[72:75]
    s_add_u32 s22, s22, 4096
    v_mfma_f32_16x16x32_bf16 v[68:71], a[60:63], v[148:151], v[68:71]
    v_max3_u32 v36, v36, v144, v148
    v_mfma_f32_16x16x32_bf16 v[76:79], a[172:175], v[148:151], v[76:79]
    s_waitcnt vmcnt(8)
    s_barrier
    ds_read_b128 v[120:123], v9 offset:16384
    ds_read_b128 v[124:127], v171 offset:16384
    ds_read_b128 v[128:131], v9 offset:17408
    ds_read_b128 v[132:135], v171 offset:17408
    ds_read_b128 v[136:139], v9 offset:18432
    ds_read_b128 v[140:143], v171 offset:18432
    s_waitcnt lgkmcnt(4)
    v_mfma_f32_16x16x32_bf16 v[64:67], a[64:67], v[120:123], v[64:67]
    ds_read_b128 v[144:147], v9 offset:19456
    v_mfma_f32_16x16x32_bf16 v[72:75], a[176:179], v[120:123], v[72:75]
    ds_read_b128 v[148:151], v171 offset:19456
    v_mfma_f32_16x16x32_bf16 v[68:71], a[64:67], v[124:127], v[68:71]
    v_max3_u32 v36, v36, v120, v124
    v_mfma_f32_16x16x32_bf16 v[76:79], a[176:179], v[124:127], v[76:79]
    s_waitcnt lgkmcnt(4)
    v_mfma_f32_16x16x32_bf16 v[64:67], a[68:71], v[128:131], v[64:67]
    buffer_load_dwordx2 v[24:25], v6, s[8:11], s26 offen sc1
    v_mfma_f32_16x16x32_bf16 v[72:75], a[180:183], v[128:131], v[72:75]
    v_mfma_f32_16x16x32_bf16 v[68:71], a[68:71], v[132:135], v[68:71]
    v_max3_u32 v36, v36, v128, v132
    v_mfma_f32_16x16x32_bf16 v[76:79], a[180:183], v[132:135], v[76:79]
    s_waitcnt lgkmcnt(2)
    v_mfma_f32_16x16x32_bf16 v[64:67], a[72:75], v[136:139], v[64:67]
    buffer_load_dwordx2 v[26:27], v6, s[8:11], s27 offen sc1
    v_mfma_f32_16x16x32_bf16 v[72:75], a[184:187], v[136:139], v[72:75]
    v_mfma_f32_16x16x32_bf16 v[68:71], a[72:75], v[140:143], v[68:71]
    v_max3_u32 v36, v36, v136, v140
    v_mfma_f32_16x16x32_bf16 v[76:79], a[184:187], v[140:143], v[76:79]
    s_waitcnt lgkmcnt(0)
    v_mfma_f32_16x16x32_bf16 v[64:67], a[76:79], v[144:147], v[64:67]
    buffer_load_dwordx4 v[80:83], v13, s[8:11], s24 offen sc1
    v_mfma_f32_16x16x32_bf16 v[72:75], a[188:191], v[144:147], v[72:75]
    v_mfma_f32_16x16x32_bf16 v[68:71], a[76:79], v[148:151], v[68:71]
    v_max3_u32 v36, v36, v144, v148
    buffer_load_dwordx4 v[84:87], v170, s[8:11], s24 offen sc1
    v_mfma_f32_16x16x32_bf16 v[76:79], a[188:191], v[148:151], v[76:79]
    s_waitcnt vmcnt(8)
    s_barrier
    ds_read_b128 v[120:123], v9 offset:20480
    ds_read_b128 v[124:127], v171 offset:20480
    ds_read_b128 v[128:131], v9 offset:21504
    ds_read_b128 v[132:135], v171 offset:21504
    ds_read_b128 v[136:139], v9 offset:22528
    ds_read_b128 v[140:143], v171 offset:22528
    s_waitcnt lgkmcnt(4)
    v_mfma_f32_16x16x32_bf16 v[64:67], a[80:83], v[120:123], v[64:67]
    ds_read_b128 v[144:147], v9 offset:23552
    v_mfma_f32_16x16x32_bf16 v[72:75], a[192:195], v[120:123], v[72:75]
    ds_read_b128 v[148:151], v171 offset:23552
    v_mfma_f32_16x16x32_bf16 v[68:71], a[80:83], v[124:127], v[68:71]
    v_max3_u32 v36, v36, v120, v124
    v_mfma_f32_16x16x32_bf16 v[76:79], a[192:195], v[124:127], v[76:79]
    s_waitcnt lgkmcnt(4)
    v_mfma_f32_16x16x32_bf16 v[64:67], a[84:87], v[128:131], v[64:67]
    v_mfma_f32_16x16x32_bf16 v[72:75], a[196:199], v[128:131], v[72:75]
    v_mfma_f32_16x16x32_bf16 v[68:71], a[84:87], v[132:135], v[68:71]
    v_max3_u32 v36, v36, v128, v132
    v_mfma_f32_16x16x32_bf16 v[76:79], a[196:199], v[132:135], v[76:79]
    s_waitcnt lgkmcnt(2)
    v_mfma_f32_16x16x32_bf16 v[64:67], a[88:91], v[136:139], v[64:67]
    v_mfma_f32_16x16x32_bf16 v[72:75], a[200:203], v[136:139], v[72:75]
    v_mfma_f32_16x16x32_bf16 v[68:71], a[88:91], v[140:143], v[68:71]
    v_max3_u32 v36, v36, v136, v140
    v_mfma_f32_16x16x32_bf16 v[76:79], a[200:203], v[140:143], v[76:79]
    s_waitcnt lgkmcnt(0)
    v_mfma_f32_16x16x32_bf16 v[64:67], a[92:95], v[144:147], v[64:67]
    v_mfma_f32_16x16x32_bf16 v[72:75], a[204:207], v[144:147], v[72:75]
    v_mfma_f32_16x16x32_bf16 v[68:71], a[92:95], v[148:151], v[68:71]
    v_max3_u32 v36, v36, v144, v148
    v_mfma_f32_16x16x32_bf16 v[76:79], a[204:207], v[148:151], v[76:79]
    s_waitcnt vmcnt(4)
    s_barrier
    ds_read_b128 v[120:123], v9 offset:24576
    ds_read_b128 v[124:127], v171 offset:24576
    ds_read_b128 v[128:131], v9 offset:25600
    ds_read_b128 v[132:135], v171 offset:25600
    ds_read_b128 v[136:139], v9 offset:26624
    ds_read_b128 v[140:143], v171 offset:26624
    s_waitcnt lgkmcnt(4)
    v_mfma_f32_16x16x32_bf16 v[64:67], a[96:99], v[120:123], v[64:67]
    ds_read_b128 v[144:147], v9 offset:27648
    v_mfma_f32_16x16x32_bf16 v[72:75], a[208:211], v[120:123], v[72:75]
    ds_read_b128 v[148:151], v171 offset:27648
    v_mfma_f32_16x16x32_bf16 v[68:71], a[96:99], v[124:127], v[68:71]
    v_max3_u32 v36, v36, v120, v124
    v_mfma_f32_16x16x32_bf16 v[76:79], a[208:211], v[124:127], v[76:79]
    s_waitcnt lgkmcnt(4)
    v_mfma_f32_16x16x32_bf16 v[64:67], a[100:103], v[128:131], v[64:67]
    v_mfma_f32_16x16x32_bf16 v[72:75], a[212:215], v[128:131], v[72:75]
    v_mfma_f32_16x16x32_bf16 v[68:71], a[100:103], v[132:135], v[68:71]
    v_max3_u32 v36, v36, v128, v132
    v_mfma_f32_16x16x32_bf16 v[76:79], a[212:215], v[132:135], v[76:79]
    s_waitcnt lgkmcnt(2)
    v_mfma_f32_16x16x32_bf16 v[64:67], a[104:107], v[136:139], v[64:67]
    v_mfma_f32_16x16x32_bf16 v[72:75], a[216:219], v[136:139], v[72:75]
    v_mfma_f32_16x16x32_bf16 v[68:71], a[104:107], v[140:143], v[68:71]
    v_max3_u32 v36, v36, v136, v140
    v_mfma_f32_16x16x32_bf16 v[76:79], a[216:219], v[140:143], v[76:79]
    s_waitcnt lgkmcnt(0)
    v_mfma_f32_16x16x32_bf16 v[64:67], a[108:111], v[144:147], v[64:67]
    v_mfma_f32_16x16x32_bf16 v[72:75], a[220:223], v[144:147], v[72:75]
    v_mfma_f32_16x16x32_bf16 v[68:71], a[108:111], v[148:151], v[68:71]
    v_max3_u32 v36, v36, v144, v148
    v_mfma_f32_16x16x32_bf16 v[76:79], a[220:223], v[148:151], v[76:79]
    s_add_u32 s42, s42, 1
    s_bitcmp1_b32 s12, 0
    s_nop 3
    ds_write_b32 v168, v36 offset:1024
    s_cbranch_scc1 Lkh_182
    ds_write_b128 v172, v[72:75]
    ds_write_b128 v172, v[76:79] offset:1024
    s_branch Lkj_183
Lkh_182:
    ds_write_b128 v172, v[64:67]
    ds_write_b128 v172, v[68:71] offset:1024
    v_mov_b32 v64, v72
    v_mov_b32 v65, v73
    v_mov_b32 v66, v74
    v_mov_b32 v67, v75
    v_mov_b32 v68, v76
    v_mov_b32 v69, v77
    v_mov_b32 v70, v78
    v_mov_b32 v71, v79
Lkj_183:
    s_waitcnt vmcnt(0) lgkmcnt(0)
    s_barrier
    ds_read_b128 v[16:19], v173
    ds_read_b128 v[20:23], v173 offset:1024
    ds_read2st64_b32 v[2:3], v169 offset0:4 offset1:5
Lrv_184:
    v_max3_u32 v36, v24, v25, v26
    v_max_u32 v36, v36, v27
    v_cmp_eq_u32 vcc, -1, v36
    s_cbranch_vccz Lrok_185
    buffer_load_dwordx2 v[24:25], v6, s[8:11], s26 offen sc1
    buffer_load_dwordx2 v[26:27], v6, s[8:11], s27 offen sc1
    s_sub_u32 s18, s18, 1
    s_cbranch_scc1 interleave_layers__memory_aug_recurrent_mem_tr__glu_gated_glu__prompt_kernel_exit
    s_waitcnt vmcnt(0)
    s_branch Lrv_184
Lrok_185:
    s_waitcnt lgkmcnt(0)
    v_max_u32 v2, v2, v3
    v_cmp_eq_u32 vcc, -1, v2
    s_cbranch_vccnz Lredo_178
    v_pk_add_f32 v[16:17], v[16:17], v[64:65]
    v_pk_add_f32 v[18:19], v[18:19], v[66:67]
    v_pk_add_f32 v[20:21], v[20:21], v[68:69]
    v_pk_add_f32 v[22:23], v[22:23], v[70:71]
    v_lshlrev_b32 v2, 16, v24
    v_and_b32 v3, 0xffff0000, v24
    v_add_f32 v16, v16, v2
    v_add_f32 v17, v17, v3
    v_cvt_pk_bf16_f32 v28, v16, v17
    v_lshlrev_b32 v16, 16, v28
    v_and_b32 v17, 0xffff0000, v28
    v_lshlrev_b32 v2, 16, v25
    v_and_b32 v3, 0xffff0000, v25
    v_add_f32 v18, v18, v2
    v_add_f32 v19, v19, v3
    v_cvt_pk_bf16_f32 v29, v18, v19
    v_lshlrev_b32 v18, 16, v29
    v_and_b32 v19, 0xffff0000, v29
    v_lshlrev_b32 v2, 16, v26
    v_and_b32 v3, 0xffff0000, v26
    v_add_f32 v20, v20, v2
    v_add_f32 v21, v21, v3
    v_cvt_pk_bf16_f32 v30, v20, v21
    v_lshlrev_b32 v20, 16, v30
    v_and_b32 v21, 0xffff0000, v30
    v_lshlrev_b32 v2, 16, v27
    v_and_b32 v3, 0xffff0000, v27
    v_add_f32 v22, v22, v2
    v_add_f32 v23, v23, v3
    v_cvt_pk_bf16_f32 v31, v22, v23
    v_lshlrev_b32 v22, 16, v31
    v_and_b32 v23, 0xffff0000, v31
    s_mul_i32 s23, s43, 28672
    s_cmp_eq_u32 s14, 0
    s_cbranch_scc0 Lb2l1_186
    v_add_f32 v108, v16, v17
    v_mul_f32 v109, v16, v16
    v_add_f32 v108, v108, v18
    v_fmac_f32 v109, v17, v17
    v_add_f32 v108, v108, v19
    v_fmac_f32 v109, v18, v18
    v_fmac_f32 v109, v19, v19
    v_add_f32 v110, v20, v21
    v_mul_f32 v111, v20, v20
    v_add_f32 v110, v110, v22
    v_fmac_f32 v111, v21, v21
    v_add_f32 v110, v110, v23
    v_fmac_f32 v111, v22, v22
    v_fmac_f32 v111, v23, v23
    s_nop 1
    v_permlane32_swap_b32 v108, v110
    v_permlane32_swap_b32 v109, v111
    v_add_f32 v108, v108, v110
    v_add_f32 v109, v109, v111
    s_nop 1
    v_permlane16_swap_b32 v108, v109
    v_add_f32 v108, v108, v109
    ds_write_b32 v168, v108
    s_waitcnt lgkmcnt(0)
    s_barrier
    ds_read2st64_b32 v[108:109], v169 offset0:0 offset1:1
    ds_read2st64_b32 v[110:111], v169 offset0:2 offset1:3
    s_waitcnt lgkmcnt(0)
    v_add_f32 v108, v108, v109
    v_add_f32 v110, v110, v111
    v_add_f32 v108, v108, v110
    v_min_u32 v108, 0xfffffffe, v108
    s_cmp_eq_u32 s16, 1
    s_cbranch_scc0 Lsl_188
    buffer_store_dword v108, v12, s[8:11], s24 offen
    s_branch Lst_189
Lsl_188:
    buffer_store_dword v108, v12, s[8:11], s24 offen sc1
Lst_189:
    buffer_load_dwordx4 v[80:83], v13, s[8:11], s24 offen sc1
    buffer_load_dwordx4 v[84:87], v170, s[8:11], s24 offen sc1
    s_sub_u32 s18, s18, 1
    s_cbranch_scc1 interleave_layers__memory_aug_recurrent_mem_tr__glu_gated_glu__prompt_kernel_exit
    s_waitcnt vmcnt(0)
    v_max3_u32 v2, v80, v81, v82
    v_max3_u32 v2, v2, v83, v84
    v_max3_u32 v2, v2, v85, v86
    v_max_u32 v2, v2, v87
    v_cmp_eq_u32 vcc, -1, v2
    s_cbranch_vccnz Lst_189
    s_sub_u32 s20, s42, s70
    s_cselect_b32 s20, s42, s20
    s_cselect_b32 s45, s71, s74
    s_cselect_b32 s21, s72, s75
    s_cselect_b32 s46, s73, s76
    s_mul_i32 s20, s20, s21
    s_add_u32 s46, s46, s20
    s_lshl_b32 s47, s45, 6
    s_add_u32 s47, s47, s46
    s_cmp_ge_u32 s46, 64
    s_cbranch_scc1 Lne_190
    s_mul_i32 s29, s47, 2048
    s_add_u32 s29, s29, 123146240
    buffer_load_dword v4, v8, s[8:11], s29 offen sc1
Lne_190:
    v_pk_add_f32 v[80:81], v[80:81], v[84:85]
    v_pk_add_f32 v[82:83], v[82:83], v[86:87]
    s_nop 1
    v_permlane32_swap_b32 v80, v82
    v_permlane32_swap_b32 v81, v83
    v_add_f32 v80, v80, v82
    v_add_f32 v81, v81, v83
    s_nop 1
    v_permlane16_swap_b32 v80, v81
    v_add_f32 v80, v80, v81
    v_mov_b32 v81, v80
    s_nop 1
    v_permlane16_swap_b32 v80, v81
    v_mov_b32 v82, v80
    v_mov_b32 v83, v81
    s_mov_b32 s20, 0x3b124925
    s_mov_b32 s21, 0x3727c5ac
    v_permlane32_swap_b32 v80, v82
    v_permlane32_swap_b32 v81, v83
    v_mul_f32 v80, s20, v80
    v_mul_f32 v81, s20, v81
    v_fma_f32 v81, -v80, v80, v81
    v_max_f32 v81, 0, v81
    v_add_f32 v81, s21, v81
    v_rsq_f32 v81, v81
    v_mul_f32 v82, s20, v82
    v_mul_f32 v83, s20, v83
    v_fma_f32 v83, -v82, v82, v83
    v_max_f32 v83, 0, v83
    v_add_f32 v83, s21, v83
    v_rsq_f32 v83, v83
    s_nop 0
    v_sub_f32 v16, v16, v80
    v_sub_f32 v17, v17, v80
    v_sub_f32 v18, v18, v80
    v_sub_f32 v19, v19, v80
    v_mul_f32 v16, v16, v81
    v_mul_f32 v17, v17, v81
    v_mul_f32 v18, v18, v81
    v_mul_f32 v19, v19, v81
    v_cvt_pk_bf16_f32 v32, v16, v17
    v_cvt_pk_bf16_f32 v33, v18, v19
    v_sub_f32 v20, v20, v82
    v_sub_f32 v21, v21, v82
    v_sub_f32 v22, v22, v82
    v_sub_f32 v23, v23, v82
    v_mul_f32 v20, v20, v83
    v_mul_f32 v21, v21, v83
    v_mul_f32 v22, v22, v83
    v_mul_f32 v23, v23, v83
    v_cvt_pk_bf16_f32 v34, v20, v21
    v_cvt_pk_bf16_f32 v35, v22, v23
    v_min_u32 v28, 0xfffffffe, v28
    v_min_u32 v29, 0xfffffffe, v29
    v_min_u32 v30, 0xfffffffe, v30
    v_min_u32 v31, 0xfffffffe, v31
    v_min_u32 v32, 0xfffffffe, v32
    v_min_u32 v33, 0xfffffffe, v33
    v_min_u32 v34, 0xfffffffe, v34
    v_min_u32 v35, 0xfffffffe, v35
    s_nop 1
    v_permlane16_swap_b32 v32, v34
    v_permlane16_swap_b32 v33, v35
    s_add_u32 s25, s23, 14680064
    buffer_store_dwordx4 v[32:35], v5, s[8:11], s25 offen sc1
    s_mul_i32 s21, s44, 1024
    s_lshl_b32 s20, s15, 7
    s_add_u32 s21, s21, s20
    s_add_u32 s21, s21, 122163200
    s_barrier
    buffer_store_dword v15, v14, s[8:11], s21 offen sc1
    s_nop 1
    v_permlane16_swap_b32 v28, v30
    v_permlane16_swap_b32 v29, v31
    s_add_u32 s26, s23, 23855104
    buffer_store_dwordx4 v[28:31], v5, s[8:11], s26 offen sc1
    s_waitcnt vmcnt(3)
    s_branch Lb2e_187
Lb2l1_186:
    s_sub_u32 s20, s42, s70
    s_cselect_b32 s20, s42, s20
    s_cselect_b32 s45, s71, s74
    s_cselect_b32 s21, s72, s75
    s_cselect_b32 s46, s73, s76
    s_mul_i32 s20, s20, s21
    s_add_u32 s46, s46, s20
    s_lshl_b32 s47, s45, 6
    s_add_u32 s47, s47, s46
    s_cmp_ge_u32 s46, 64
    s_cbranch_scc1 Lne_191
    s_mul_i32 s29, s47, 2048
    s_add_u32 s29, s29, 123146240
    buffer_load_dword v4, v8, s[8:11], s29 offen sc1
Lne_191:
    s_nop 1
    v_permlane16_swap_b32 v28, v30
    v_permlane16_swap_b32 v29, v31
    buffer_store_dwordx4 v[28:31], v11, s[48:51], s23 offen
    s_waitcnt vmcnt(1)
Lb2e_187:
    s_cmp_lt_u32 s46, 64
    s_cbranch_scc1 Lb2_176
Ldone_164:
    s_branch interleave_layers__memory_aug_recurrent_mem_tr__glu_gated_glu__prompt_kernel_exit
Lredo_178:
    s_sub_u32 s42, s42, 1
    s_sub_u32 s18, s18, 64
    s_cbranch_scc1 interleave_layers__memory_aug_recurrent_mem_tr__glu_gated_glu__prompt_kernel_exit
    s_branch Lld_177
Lrole7_24:
    s_branch Lpvd_193
Lpv_from_v:
    s_cmp_ge_u32 s15, 7
    s_cselect_b32 s19, 4, 3
    s_cselect_b32 s20, 7, 0
    s_sub_u32 s15, s15, s20
Lpvd_193:
    v_and_b32 v7, 63, v0
    v_lshlrev_b32 v1, 4, v7
    v_cmp_eq_u32 vcc, 0, v0
    v_mov_b32 v14, 2130706432
    v_mov_b32 v15, 1
    v_cndmask_b32 v14, v14, 0, vcc
    s_lshl_b32 s30, s15, 2
    s_add_u32 s30, s30, s12
    v_and_b32 v2, 15, v7
    v_lshrrev_b32 v3, 4, v7
    v_mul_u32_u24 v11, 896, v2
    s_lshl_b32 s20, s30, 5
    v_add_u32 v11, s20, v11
    v_lshl_add_u32 v10, v3, 3, v11
    v_lshlrev_b32 v12, 4, v2
    v_mul_u32_u24 v13, 1792, v3
    v_add_u32 v13, v13, v12
    v_lshl_add_u32 v12, v3, 2, v12
    s_lshl_b32 s20, s30, 8
    v_add_u32 v12, s20, v12
    v_lshrrev_b32 v4, 1, v3
    v_lshl_add_u32 v11, v4, 4, v11
    v_lshlrev_b32 v6, 8, v4
    v_lshl_add_u32 v6, v2, 4, v6
    s_lshl_b32 s20, s30, 9
    v_add_u32 v6, s20, v6
    v_and_b32 v4, 1, v3
    v_mul_u32_u24 v9, 14336, v4
    v_add_u32 v5, v6, v9
    v_add_u32 v11, v11, v9
    v_lshl_add_u32 v6, v4, 3, v6
    v_lshlrev_b32 v169, 2, v7
    v_add_u32 v169, 49152, v169
    s_lshl_b32 s20, s12, 8
    v_add_u32 v168, s20, v169
    v_lshlrev_b32 v13, 4, v2
    v_lshl_add_u32 v12, v3, 2, v13
    s_lshl_b32 s20, s15, 8
    v_add_u32 v12, s20, v12
    v_lshl_add_u32 v13, v3, 9, v13
    v_add_u32 v170, 256, v13
    v_mov_b32 v171, 2130706432
    v_cmp_gt_u32 vcc, 64, v0
    v_cmp_gt_u32 s[20:21], 3, v3
    s_nop 1
    v_cndmask_b32 v12, v171, v12, vcc
    v_cndmask_b32 v170, v171, v170, s[20:21]
    s_load_dwordx2 s[36:37], s[0:1], 0
    v_lshlrev_b32 v8, 7, v2
    v_mov_b32 v13, v8
    v_and_b32 v4, 1, v7
    s_lshl_b32 s20, s15, 1
    v_add_u32 v4, s20, v4
    v_lshlrev_b32 v4, 7, v4
    s_mov_b32 s38, 1835008
    s_mov_b32 s39, 0x20000
    s_mov_b32 s42, 0
    s_and_b32 s34, s30, 0xfe
    s_lshl_b32 s34, s34, 10
    s_and_b32 s20, s12, 1
    s_mul_i32 s35, s20, 57344
    s_add_u32 s35, s35, s34
    s_mul_i32 s21, s20, 229376
    s_add_u32 s34, s34, s21
    s_lshl_b32 s21, s20, 14
    v_add_u32 v171, s21, v1
    s_lshl_b32 s21, s20, 12
    s_add_u32 s21, s21, 32768
    v_add_u32 v174, s21, v1
    s_lshl_b32 s21, s12, 11
    s_add_u32 s21, s21, 40960
    v_add_u32 v172, s21, v1
    v_xor_b32 v173, 2048, v172
    s_waitcnt lgkmcnt(0)
    v_mov_b32 v28, -1
    v_mov_b32 v29, -1
    v_mov_b32 v30, -1
    v_mov_b32 v31, -1
Lpf_194:
    s_mul_i32 s21, s42, 3
    s_add_u32 s21, s21, s19
    s_mov_b32 s14, 0
    s_mov_b32 s43, s21
    s_cmp_lt_u32 s21, 10
    s_cbranch_scc1 Lmd_197
    s_cmp_ge_u32 s21, 118
    s_cbranch_scc1 Lm2_196
    s_sub_u32 s20, s21, 10
    s_and_b32 s14, s20, 1
    s_lshr_b32 s43, s20, 1
    s_xor_b32 s20, s14, 1
    s_mul_i32 s20, s20, 10
    s_add_u32 s43, s43, s20
    s_branch Lmd_197
Lm2_196:
    s_mov_b32 s14, 1
    s_sub_u32 s43, s21, 64
Lmd_197:
    s_lshl_b32 s44, s14, 6
    s_add_u32 s44, s44, s43
    s_cmp_ge_u32 s43, 64
    s_cbranch_scc1 Lpfd_195
    s_add_u32 s42, s42, 1
    s_mul_i32 s25, s44, 28672
    s_add_u32 s25, s25, 16515072
    buffer_store_dwordx4 v[28:31], v5, s[8:11], s25 offen sc1
    s_waitcnt vmcnt(32)
    s_branch Lpf_194
Lpfd_195:
    s_mov_b32 s42, 0
    v_lshlrev_b32 v16, 7, v0
    s_mov_b32 s20, 125698048
Lwd_204:
    buffer_load_dwordx2 v[18:19], v16, s[8:11], s20 offen offset:0 sc1
    s_sub_u32 s18, s18, 1
    s_cbranch_scc1 interleave_layers__memory_aug_recurrent_mem_tr__glu_gated_glu__prompt_kernel_exit
    s_waitcnt vmcnt(0)
    v_xor_b32 v18, s78, v18
    v_xor_b32 v19, s79, v19
    v_or_b32 v18, v18, v19
    v_cmp_ne_u32 vcc, 0, v18
    s_cbranch_vccz Lwdok_205
    s_sleep 2
    s_branch Lwd_204
Lwdok_205:
    s_barrier
    s_mul_i32 s21, s42, 3
    s_add_u32 s21, s21, s19
    s_mov_b32 s45, 0
    s_mov_b32 s46, s21
    s_cmp_lt_u32 s21, 10
    s_cbranch_scc1 Lmd_208
    s_cmp_ge_u32 s21, 118
    s_cbranch_scc1 Lm2_207
    s_sub_u32 s20, s21, 10
    s_and_b32 s45, s20, 1
    s_lshr_b32 s46, s20, 1
    s_xor_b32 s20, s45, 1
    s_mul_i32 s20, s20, 10
    s_add_u32 s46, s46, s20
    s_branch Lmd_208
Lm2_207:
    s_mov_b32 s45, 1
    s_sub_u32 s46, s21, 64
Lmd_208:
    s_lshl_b32 s47, s45, 6
    s_add_u32 s47, s47, s46
    s_cmp_ge_u32 s46, 64
    s_cbranch_scc1 Lne_206
    s_mul_i32 s26, s47, 2048
    s_add_u32 s26, s26, 121835520
    s_mul_i32 s27, s47, 4096
    s_add_u32 s27, s27, 122228736
    s_mul_i32 s28, s47, 2048
    s_add_u32 s28, s28, 122753024
    buffer_load_dword v9, v8, s[8:11], s26 offen sc1
    buffer_load_dword v164, v13, s[8:11], s27 offen sc1
    buffer_load_dword v165, v4, s[8:11], s28 offen sc1
Lne_206:
    s_waitcnt vmcnt(0)
Lpv_198:
    s_mov_b32 s14, s45
    s_mov_b32 s43, s46
    s_mov_b32 s44, s47
    s_waitcnt vmcnt(2)
    v_cmp_eq_u32 vcc, 0, v9
    s_cbranch_vccz Lok_209
Lwf_210:
    buffer_load_dword v9, v8, s[8:11], s26 offen sc1
    s_sub_u32 s18, s18, 1
    s_cbranch_scc1 interleave_layers__memory_aug_recurrent_mem_tr__glu_gated_glu__prompt_kernel_exit
    s_waitcnt vmcnt(0)
    v_cmp_eq_u32 vcc, 0, v9
    s_cbranch_vccz Lwfok_211
    s_sleep 2
    s_branch Lwf_210
Lwfok_211:
Lok_209:
    s_mul_i32 s25, s44, 28672
    s_add_u32 s25, s25, 16515072
    s_lshl_b32 s24, s14, 7
    s_add_u32 s24, s24, s43
    s_lshl_b32 s24, s24, 13
    s_add_u32 s24, s24, 120258560
    v_min_u32 v2, v164, v165
    v_cmp_eq_u32 vcc, 0, v2
    s_cbranch_vccnz Ljit_212
    s_mul_i32 s22, s44, 40960
    s_mul_i32 s23, s12, 10240
    s_add_u32 s22, s22, s23
    s_add_u32 s22, s22, 113770496
    s_mov_b32 m0, s23
    s_add_u32 s23, s23, 4096
    buffer_load_dwordx4 v1, s[8:11], s22 offen offset:0 sc1 lds
    buffer_load_dwordx4 v1, s[8:11], s22 offen offset:1024 sc1 lds
    buffer_load_dwordx4 v1, s[8:11], s22 offen offset:2048 sc1 lds
    buffer_load_dwordx4 v1, s[8:11], s22 offen offset:3072 sc1 lds
    s_add_u32 s22, s22, 4096
    s_mov_b32 m0, s23
    s_add_u32 s23, s23, 4096
    buffer_load_dwordx4 v1, s[8:11], s22 offen offset:0 sc1 lds
    buffer_load_dwordx4 v1, s[8:11], s22 offen offset:1024 sc1 lds
    buffer_load_dwordx4 v1, s[8:11], s22 offen offset:2048 sc1 lds
    buffer_load_dwordx4 v1, s[8:11], s22 offen offset:3072 sc1 lds
    s_add_u32 s22, s22, 4096
    s_mov_b32 m0, s23
    s_add_u32 s23, s23, 4096
    buffer_load_dwordx4 v1, s[8:11], s22 offen offset:0 sc1 lds
    buffer_load_dwordx4 v1, s[8:11], s22 offen offset:1024 sc1 lds
    s_mul_i32 s22, s44, 458752
    s_add_u32 s22, s22, s34
    s_add_u32 s22, s22, 40370176
    buffer_load_dwordx4 v[32:35], v1, s[8:11], s22 offen offset:0 sc1
    buffer_load_dwordx4 v[36:39], v1, s[8:11], s22 offen offset:1024 sc1
    s_add_u32 s22, s22, 28672
    buffer_load_dwordx4 v[40:43], v1, s[8:11], s22 offen offset:0 sc1
    buffer_load_dwordx4 v[44:47], v1, s[8:11], s22 offen offset:1024 sc1
    s_add_u32 s22, s22, 28672
    buffer_load_dwordx4 v[48:51], v1, s[8:11], s22 offen offset:0 sc1
    buffer_load_dwordx4 v[52:55], v1, s[8:11], s22 offen offset:1024 sc1
    s_add_u32 s22, s22, 28672
    buffer_load_dwordx4 v[56:59], v1, s[8:11], s22 offen offset:0 sc1
    buffer_load_dwordx4 v[60:63], v1, s[8:11], s22 offen offset:1024 sc1
    s_add_u32 s22, s22, 28672
    buffer_load_dwordx4 v[64:67], v1, s[8:11], s22 offen offset:0 sc1
    buffer_load_dwordx4 v[68:71], v1, s[8:11], s22 offen offset:1024 sc1
    s_add_u32 s22, s22, 28672
    buffer_load_dwordx4 v[72:75], v1, s[8:11], s22 offen offset:0 sc1
    buffer_load_dwordx4 v[76:79], v1, s[8:11], s22 offen offset:1024 sc1
    s_add_u32 s22, s22, 28672
    buffer_load_dwordx4 v[80:83], v1, s[8:11], s22 offen offset:0 sc1
    buffer_load_dwordx4 v[84:87], v1, s[8:11], s22 offen offset:1024 sc1
    s_add_u32 s22, s22, 28672
    buffer_load_dwordx4 v[88:91], v1, s[8:11], s22 offen offset:0 sc1
    buffer_load_dwordx4 v[92:95], v1, s[8:11], s22 offen offset:1024 sc1
    s_mul_i32 s32, s43, 28672
    s_cmp_eq_u32 s14, 0
    s_cbranch_scc0 La_213
    s_add_u32 s33, s32, 14336
    buffer_load_dwordx2 v[24:25], v10, s[36:39], s32 offen
    buffer_load_dwordx2 v[26:27], v10, s[36:39], s33 offen
    s_branch Lb_214
La_213:
    s_add_u32 s32, s32, 23855104
    s_add_u32 s33, s32, 14336
    buffer_load_dwordx2 v[24:25], v6, s[8:11], s32 offen sc1
    buffer_load_dwordx2 v[26:27], v6, s[8:11], s33 offen sc1
Lb_214:
    s_mul_i32 s22, s44, 114688
    s_add_u32 s22, s22, s35
    s_add_u32 s22, s22, 99090432
    buffer_load_dwordx4 v[96:99], v1, s[8:11], s22 offen offset:0 sc1
    buffer_load_dwordx4 v[100:103], v1, s[8:11], s22 offen offset:1024 sc1
    s_add_u32 s22, s22, 28672
    buffer_load_dwordx4 v[104:107], v1, s[8:11], s22 offen offset:0 sc1
    buffer_load_dwordx4 v[108:111], v1, s[8:11], s22 offen offset:1024 sc1
    s_mov_b32 s29, 1
    s_waitcnt vmcnt(22)
    s_branch Lrun_202
Ljit_212:
    s_mul_i32 s22, s44, 458752
    s_add_u32 s22, s22, s34
    s_add_u32 s22, s22, 40370176
    buffer_load_dwordx4 v[32:35], v1, s[8:11], s22 offen offset:0 sc1
    buffer_load_dwordx4 v[36:39], v1, s[8:11], s22 offen offset:1024 sc1
    s_add_u32 s22, s22, 28672
    buffer_load_dwordx4 v[40:43], v1, s[8:11], s22 offen offset:0 sc1
    buffer_load_dwordx4 v[44:47], v1, s[8:11], s22 offen offset:1024 sc1
    s_add_u32 s22, s22, 28672
    buffer_load_dwordx4 v[48:51], v1, s[8:11], s22 offen offset:0 sc1
    buffer_load_dwordx4 v[52:55], v1, s[8:11], s22 offen offset:1024 sc1
    s_add_u32 s22, s22, 28672
    buffer_load_dwordx4 v[56:59], v1, s[8:11], s22 offen offset:0 sc1
    buffer_load_dwordx4 v[60:63], v1, s[8:11], s22 offen offset:1024 sc1
    s_add_u32 s22, s22, 28672
    buffer_load_dwordx4 v[64:67], v1, s[8:11], s22 offen offset:0 sc1
    buffer_load_dwordx4 v[68:71], v1, s[8:11], s22 offen offset:1024 sc1
    s_add_u32 s22, s22, 28672
    buffer_load_dwordx4 v[72:75], v1, s[8:11], s22 offen offset:0 sc1
    buffer_load_dwordx4 v[76:79], v1, s[8:11], s22 offen offset:1024 sc1
    s_add_u32 s22, s22, 28672
    buffer_load_dwordx4 v[80:83], v1, s[8:11], s22 offen offset:0 sc1
    buffer_load_dwordx4 v[84:87], v1, s[8:11], s22 offen offset:1024 sc1
    s_add_u32 s22, s22, 28672
    buffer_load_dwordx4 v[88:91], v1, s[8:11], s22 offen offset:0 sc1
    buffer_load_dwordx4 v[92:95], v1, s[8:11], s22 offen offset:1024 sc1
    s_mul_i32 s32, s43, 28672
    s_cmp_eq_u32 s14, 0
    s_cbranch_scc0 La_215
    s_add_u32 s33, s32, 14336
    buffer_load_dwordx2 v[24:25], v10, s[36:39], s32 offen
    buffer_load_dwordx2 v[26:27], v10, s[36:39], s33 offen
    s_branch Lb_216
La_215:
    s_add_u32 s32, s32, 23855104
    s_add_u32 s33, s32, 14336
    buffer_load_dwordx2 v[24:25], v6, s[8:11], s32 offen sc1
    buffer_load_dwordx2 v[26:27], v6, s[8:11], s33 offen sc1
Lb_216:
    v_cmp_eq_u32 vcc, 0, v164
    s_cbranch_vccz Lok_217
Lwf_218:
    buffer_load_dword v164, v13, s[8:11], s27 offen sc1
    s_sub_u32 s18, s18, 1
    s_cbranch_scc1 interleave_layers__memory_aug_recurrent_mem_tr__glu_gated_glu__prompt_kernel_exit
    s_waitcnt vmcnt(0)
    v_cmp_eq_u32 vcc, 0, v164
    s_cbranch_vccz Lwfok_219
    s_sleep 2
    s_branch Lwf_218
Lwfok_219:
Lok_217:
    s_mul_i32 s22, s44, 40960
    s_mul_i32 s23, s12, 10240
    s_add_u32 s22, s22, s23
    s_add_u32 s22, s22, 113770496
    s_mov_b32 m0, s23
    s_add_u32 s23, s23, 4096
    buffer_load_dwordx4 v1, s[8:11], s22 offen offset:0 sc1 lds
    buffer_load_dwordx4 v1, s[8:11], s22 offen offset:1024 sc1 lds
    buffer_load_dwordx4 v1, s[8:11], s22 offen offset:2048 sc1 lds
    buffer_load_dwordx4 v1, s[8:11], s22 offen offset:3072 sc1 lds
    s_add_u32 s22, s22, 4096
    s_mov_b32 m0, s23
    s_add_u32 s23, s23, 4096
    buffer_load_dwordx4 v1, s[8:11], s22 offen offset:0 sc1 lds
    buffer_load_dwordx4 v1, s[8:11], s22 offen offset:1024 sc1 lds
    buffer_load_dwordx4 v1, s[8:11], s22 offen offset:2048 sc1 lds
    buffer_load_dwordx4 v1, s[8:11], s22 offen offset:3072 sc1 lds
    s_add_u32 s22, s22, 4096
    s_mov_b32 m0, s23
    s_add_u32 s23, s23, 4096
    buffer_load_dwordx4 v1, s[8:11], s22 offen offset:0 sc1 lds
    buffer_load_dwordx4 v1, s[8:11], s22 offen offset:1024 sc1 lds
    buffer_load_dword v165, v4, s[8:11], s28 offen sc1
    s_mov_b32 s29, 0
    s_waitcnt vmcnt(0)
    v_cmp_eq_u32 vcc, 0, v165
    s_cbranch_vccnz Lrun_202
    s_mul_i32 s22, s44, 114688
    s_add_u32 s22, s22, s35
    s_add_u32 s22, s22, 99090432
    buffer_load_dwordx4 v[96:99], v1, s[8:11], s22 offen offset:0 sc1
    buffer_load_dwordx4 v[100:103], v1, s[8:11], s22 offen offset:1024 sc1
    s_add_u32 s22, s22, 28672
    buffer_load_dwordx4 v[104:107], v1, s[8:11], s22 offen offset:0 sc1
    buffer_load_dwordx4 v[108:111], v1, s[8:11], s22 offen offset:1024 sc1
    s_mov_b32 s29, 1
Lrun_202:
    s_barrier
    ds_read_b128 v[112:115], v171 offset:0
    ds_read_b128 v[116:119], v171 offset:1024
    ds_read_b128 v[120:123], v171 offset:2048
    ds_read_b128 v[124:127], v171 offset:3072
    ds_read_b128 v[128:131], v171 offset:4096
    ds_read_b128 v[132:135], v171 offset:5120
    s_waitcnt lgkmcnt(4) vmcnt(20)
    v_mfma_f32_16x16x32_bf16 v[144:147], v[32:35], v[112:115], 0
    v_max_u32 v166, v112, v114
    v_mfma_f32_16x16x32_bf16 v[152:155], v[36:39], v[112:115], 0
    ds_read_b128 v[136:139], v171 offset:6144
    v_mfma_f32_16x16x32_bf16 v[148:151], v[32:35], v[116:119], 0
    v_max3_u32 v166, v166, v116, v118
    v_mfma_f32_16x16x32_bf16 v[156:159], v[36:39], v[116:119], 0
    ds_read_b128 v[140:143], v171 offset:7168
    s_waitcnt lgkmcnt(4) vmcnt(18)
    v_mfma_f32_16x16x32_bf16 v[144:147], v[40:43], v[120:123], v[144:147]
    v_max3_u32 v166, v166, v120, v122
    v_mfma_f32_16x16x32_bf16 v[152:155], v[44:47], v[120:123], v[152:155]
    ds_read_b128 v[112:115], v171 offset:8192
    v_mfma_f32_16x16x32_bf16 v[148:151], v[40:43], v[124:127], v[148:151]
    v_max3_u32 v166, v166, v124, v126
    v_mfma_f32_16x16x32_bf16 v[156:159], v[44:47], v[124:127], v[156:159]
    ds_read_b128 v[116:119], v171 offset:9216
    s_waitcnt lgkmcnt(4) vmcnt(16)
    v_mfma_f32_16x16x32_bf16 v[144:147], v[48:51], v[128:131], v[144:147]
    v_max3_u32 v166, v166, v128, v130
    v_mfma_f32_16x16x32_bf16 v[152:155], v[52:55], v[128:131], v[152:155]
    ds_read_b128 v[120:123], v171 offset:10240
    v_mfma_f32_16x16x32_bf16 v[148:151], v[48:51], v[132:135], v[148:151]
    v_max3_u32 v166, v166, v132, v134
    v_mfma_f32_16x16x32_bf16 v[156:159], v[52:55], v[132:135], v[156:159]
    ds_read_b128 v[124:127], v171 offset:11264
    s_waitcnt lgkmcnt(4) vmcnt(14)
    v_mfma_f32_16x16x32_bf16 v[144:147], v[56:59], v[136:139], v[144:147]
    v_max3_u32 v166, v166, v136, v138
    v_mfma_f32_16x16x32_bf16 v[152:155], v[60:63], v[136:139], v[152:155]
    ds_read_b128 v[128:131], v171 offset:12288
    v_mfma_f32_16x16x32_bf16 v[148:151], v[56:59], v[140:143], v[148:151]
    v_max3_u32 v166, v166, v140, v142
    v_mfma_f32_16x16x32_bf16 v[156:159], v[60:63], v[140:143], v[156:159]
    ds_read_b128 v[132:135], v171 offset:13312
    s_waitcnt lgkmcnt(4) vmcnt(12)
    v_mfma_f32_16x16x32_bf16 v[144:147], v[64:67], v[112:115], v[144:147]
    v_max3_u32 v166, v166, v112, v114
    v_mfma_f32_16x16x32_bf16 v[152:155], v[68:71], v[112:115], v[152:155]
    ds_read_b128 v[136:139], v171 offset:14336
    v_mfma_f32_16x16x32_bf16 v[148:151], v[64:67], v[116:119], v[148:151]
    v_max3_u32 v166, v166, v116, v118
    v_mfma_f32_16x16x32_bf16 v[156:159], v[68:71], v[116:119], v[156:159]
    ds_read_b128 v[140:143], v171 offset:15360
    s_waitcnt lgkmcnt(4) vmcnt(10)
    v_mfma_f32_16x16x32_bf16 v[144:147], v[72:75], v[120:123], v[144:147]
    v_max3_u32 v166, v166, v120, v122
    v_mfma_f32_16x16x32_bf16 v[152:155], v[76:79], v[120:123], v[152:155]
    ds_read_b128 v[112:115], v174 offset:0
    v_mfma_f32_16x16x32_bf16 v[148:151], v[72:75], v[124:127], v[148:151]
    v_max3_u32 v166, v166, v124, v126
    v_mfma_f32_16x16x32_bf16 v[156:159], v[76:79], v[124:127], v[156:159]
    ds_read_b128 v[116:119], v174 offset:1024
    s_waitcnt lgkmcnt(4) vmcnt(8)
    v_mfma_f32_16x16x32_bf16 v[144:147], v[80:83], v[128:131], v[144:147]
    v_max3_u32 v166, v166, v128, v130
    v_mfma_f32_16x16x32_bf16 v[152:155], v[84:87], v[128:131], v[152:155]
    ds_read_b128 v[120:123], v174 offset:2048
    v_mfma_f32_16x16x32_bf16 v[148:151], v[80:83], v[132:135], v[148:151]
    v_max3_u32 v166, v166, v132, v134
    v_mfma_f32_16x16x32_bf16 v[156:159], v[84:87], v[132:135], v[156:159]
    ds_read_b128 v[124:127], v174 offset:3072
    s_waitcnt lgkmcnt(4) vmcnt(6)
    v_mfma_f32_16x16x32_bf16 v[144:147], v[88:91], v[136:139], v[144:147]
    v_max3_u32 v166, v166, v136, v138
    v_mfma_f32_16x16x32_bf16 v[152:155], v[92:95], v[136:139], v[152:155]
    v_mfma_f32_16x16x32_bf16 v[148:151], v[88:91], v[140:143], v[148:151]
    v_max3_u32 v166, v166, v140, v142
    v_mfma_f32_16x16x32_bf16 v[156:159], v[92:95], v[140:143], v[156:159]
    s_cmp_eq_u32 s29, 1
    s_cbranch_scc1 Lvok_220
    v_cmp_eq_u32 vcc, 0, v165
    s_cbranch_vccz Lok_221
Lwf_222:
    buffer_load_dword v165, v4, s[8:11], s28 offen sc1
    s_sub_u32 s18, s18, 1
    s_cbranch_scc1 interleave_layers__memory_aug_recurrent_mem_tr__glu_gated_glu__prompt_kernel_exit
    s_waitcnt vmcnt(0)
    v_cmp_eq_u32 vcc, 0, v165
    s_cbranch_vccz Lwfok_223
    s_sleep 2
    s_branch Lwf_222
Lwfok_223:
Lok_221:
    s_mul_i32 s22, s44, 114688
    s_add_u32 s22, s22, s35
    s_add_u32 s22, s22, 99090432
    buffer_load_dwordx4 v[96:99], v1, s[8:11], s22 offen offset:0 sc1
    buffer_load_dwordx4 v[100:103], v1, s[8:11], s22 offen offset:1024 sc1
    s_add_u32 s22, s22, 28672
    buffer_load_dwordx4 v[104:107], v1, s[8:11], s22 offen offset:0 sc1
    buffer_load_dwordx4 v[108:111], v1, s[8:11], s22 offen offset:1024 sc1
    s_mov_b32 s29, 1
Lvok_220:
    s_waitcnt vmcnt(0)
    s_waitcnt lgkmcnt(2)
    v_mfma_f32_16x16x32_bf16 v[144:147], v[96:99], v[112:115], v[144:147]
    v_max3_u32 v166, v166, v112, v114
    v_mfma_f32_16x16x32_bf16 v[152:155], v[100:103], v[112:115], v[152:155]
    v_mfma_f32_16x16x32_bf16 v[148:151], v[96:99], v[116:119], v[148:151]
    v_max3_u32 v166, v166, v116, v118
    v_mfma_f32_16x16x32_bf16 v[156:159], v[100:103], v[116:119], v[156:159]
    s_waitcnt lgkmcnt(0)
    v_mfma_f32_16x16x32_bf16 v[144:147], v[104:107], v[120:123], v[144:147]
    v_max3_u32 v166, v166, v120, v122
    v_mfma_f32_16x16x32_bf16 v[152:155], v[108:111], v[120:123], v[152:155]
    v_mfma_f32_16x16x32_bf16 v[148:151], v[104:107], v[124:127], v[148:151]
    v_max3_u32 v166, v166, v124, v126
    v_mfma_f32_16x16x32_bf16 v[156:159], v[108:111], v[124:127], v[156:159]
    s_bitcmp1_b32 s12, 0
    s_nop 4
    ds_write_b32 v168, v166 offset:1024
    s_cbranch_scc1 Lkh_224
    ds_write_b128 v172, v[152:155]
    ds_write_b128 v172, v[156:159] offset:1024
    s_branch Lkj_225
Lkh_224:
    ds_write_b128 v172, v[144:147]
    ds_write_b128 v172, v[148:151] offset:1024
    v_mov_b32 v144, v152
    v_mov_b32 v145, v153
    v_mov_b32 v146, v154
    v_mov_b32 v147, v155
    v_mov_b32 v148, v156
    v_mov_b32 v149, v157
    v_mov_b32 v150, v158
    v_mov_b32 v151, v159
Lkj_225:
    s_waitcnt lgkmcnt(0)
    s_barrier
    ds_read_b128 v[16:19], v173
    ds_read_b128 v[20:23], v173 offset:1024
    ds_read2st64_b32 v[2:3], v169 offset0:4 offset1:5
    s_cmp_eq_u32 s14, 0
    s_cbranch_scc1 Lnr_203
Lrv_226:
    v_max3_u32 v166, v24, v25, v26
    v_max_u32 v166, v166, v27
    v_cmp_eq_u32 vcc, -1, v166
    s_cbranch_vccz Lrok_227
    buffer_load_dwordx2 v[24:25], v6, s[8:11], s32 offen sc1
    buffer_load_dwordx2 v[26:27], v6, s[8:11], s33 offen sc1
    s_sub_u32 s18, s18, 1
    s_cbranch_scc1 interleave_layers__memory_aug_recurrent_mem_tr__glu_gated_glu__prompt_kernel_exit
    s_waitcnt vmcnt(0)
    s_branch Lrv_226
Lrok_227:
Lnr_203:
    s_waitcnt lgkmcnt(0)
    v_max_u32 v2, v2, v3
    v_cmp_eq_u32 vcc, -1, v2
    s_cbranch_vccnz Lredo_201
    s_add_u32 s42, s42, 1
    s_mul_i32 s21, s42, 3
    s_add_u32 s21, s21, s19
    s_mov_b32 s45, 0
    s_mov_b32 s46, s21
    s_cmp_lt_u32 s21, 10
    s_cbranch_scc1 Lmd_230
    s_cmp_ge_u32 s21, 118
    s_cbranch_scc1 Lm2_229
    s_sub_u32 s20, s21, 10
    s_and_b32 s45, s20, 1
    s_lshr_b32 s46, s20, 1
    s_xor_b32 s20, s45, 1
    s_mul_i32 s20, s20, 10
    s_add_u32 s46, s46, s20
    s_branch Lmd_230
Lm2_229:
    s_mov_b32 s45, 1
    s_sub_u32 s46, s21, 64
Lmd_230:
    s_lshl_b32 s47, s45, 6
    s_add_u32 s47, s47, s46
    s_cmp_ge_u32 s46, 64
    s_cbranch_scc1 Lne_228
    s_mul_i32 s26, s47, 2048
    s_add_u32 s26, s26, 121835520
    s_mul_i32 s27, s47, 4096
    s_add_u32 s27, s27, 122228736
    s_mul_i32 s28, s47, 2048
    s_add_u32 s28, s28, 122753024
    buffer_load_dword v9, v8, s[8:11], s26 offen sc1
    buffer_load_dword v164, v13, s[8:11], s27 offen sc1
    buffer_load_dword v165, v4, s[8:11], s28 offen sc1
Lne_228:
    v_pk_add_f32 v[16:17], v[16:17], v[144:145]
    v_pk_add_f32 v[18:19], v[18:19], v[146:147]
    v_pk_add_f32 v[20:21], v[20:21], v[148:149]
    v_pk_add_f32 v[22:23], v[22:23], v[150:151]
    v_lshlrev_b32 v2, 16, v24
    v_and_b32 v3, 0xffff0000, v24
    v_add_f32 v16, v16, v2
    v_add_f32 v17, v17, v3
    v_cvt_pk_bf16_f32 v28, v16, v17
    v_lshlrev_b32 v16, 16, v28
    v_and_b32 v17, 0xffff0000, v28
    v_lshlrev_b32 v2, 16, v25
    v_and_b32 v3, 0xffff0000, v25
    v_add_f32 v18, v18, v2
    v_add_f32 v19, v19, v3
    v_cvt_pk_bf16_f32 v29, v18, v19
    v_lshlrev_b32 v18, 16, v29
    v_and_b32 v19, 0xffff0000, v29
    v_lshlrev_b32 v2, 16, v26
    v_and_b32 v3, 0xffff0000, v26
    v_add_f32 v20, v20, v2
    v_add_f32 v21, v21, v3
    v_cvt_pk_bf16_f32 v30, v20, v21
    v_lshlrev_b32 v20, 16, v30
    v_and_b32 v21, 0xffff0000, v30
    v_lshlrev_b32 v2, 16, v27
    v_and_b32 v3, 0xffff0000, v27
    v_add_f32 v22, v22, v2
    v_add_f32 v23, v23, v3
    v_cvt_pk_bf16_f32 v31, v22, v23
    v_lshlrev_b32 v22, 16, v31
    v_and_b32 v23, 0xffff0000, v31
    v_min_u32 v28, 0xfffffffe, v28
    v_min_u32 v29, 0xfffffffe, v29
    v_min_u32 v30, 0xfffffffe, v30
    v_min_u32 v31, 0xfffffffe, v31
    s_nop 1
    v_permlane16_swap_b32 v28, v30
    v_permlane16_swap_b32 v29, v31
    buffer_store_dwordx4 v[28:31], v5, s[8:11], s25 offen sc1
    v_add_f32 v160, v16, v17
    v_mul_f32 v161, v16, v16
    v_add_f32 v160, v160, v18
    v_fmac_f32 v161, v17, v17
    v_add_f32 v160, v160, v19
    v_fmac_f32 v161, v18, v18
    v_fmac_f32 v161, v19, v19
    v_add_f32 v162, v20, v21
    v_mul_f32 v163, v20, v20
    v_add_f32 v162, v162, v22
    v_fmac_f32 v163, v21, v21
    v_add_f32 v162, v162, v23
    v_fmac_f32 v163, v22, v22
    v_fmac_f32 v163, v23, v23
    s_nop 1
    v_permlane32_swap_b32 v160, v162
    v_permlane32_swap_b32 v161, v163
    v_add_f32 v160, v160, v162
    v_add_f32 v161, v161, v163
    s_nop 1
    v_permlane16_swap_b32 v160, v161
    v_add_f32 v160, v160, v161
    ds_write_b32 v168, v160
    s_waitcnt lgkmcnt(0)
    s_barrier
    ds_read2st64_b32 v[160:161], v169 offset0:0 offset1:1
    ds_read2st64_b32 v[162:163], v169 offset0:2 offset1:3
    s_waitcnt lgkmcnt(0)
    v_add_f32 v160, v160, v161
    v_add_f32 v162, v162, v163
    v_add_f32 v160, v160, v162
    v_min_u32 v160, 0xfffffffe, v160
    buffer_store_dword v160, v12, s[8:11], s24 offen sc1
    s_cmp_lt_u32 s46, 64
    s_cbranch_scc1 Lpv_198
Ldone_192:
    s_branch interleave_layers__memory_aug_recurrent_mem_tr__glu_gated_glu__prompt_kernel_exit
Lredo_201:
    s_sub_u32 s18, s18, 64
    s_cbranch_scc1 interleave_layers__memory_aug_recurrent_mem_tr__glu_gated_glu__prompt_kernel_exit
    s_barrier
    s_mul_i32 s22, s44, 40960
    s_mul_i32 s23, s12, 10240
    s_add_u32 s22, s22, s23
    s_add_u32 s22, s22, 113770496
    s_mov_b32 m0, s23
    s_add_u32 s23, s23, 4096
    buffer_load_dwordx4 v1, s[8:11], s22 offen offset:0 sc1 lds
    buffer_load_dwordx4 v1, s[8:11], s22 offen offset:1024 sc1 lds
    buffer_load_dwordx4 v1, s[8:11], s22 offen offset:2048 sc1 lds
    buffer_load_dwordx4 v1, s[8:11], s22 offen offset:3072 sc1 lds
    s_add_u32 s22, s22, 4096
    s_mov_b32 m0, s23
    s_add_u32 s23, s23, 4096
    buffer_load_dwordx4 v1, s[8:11], s22 offen offset:0 sc1 lds
    buffer_load_dwordx4 v1, s[8:11], s22 offen offset:1024 sc1 lds
    buffer_load_dwordx4 v1, s[8:11], s22 offen offset:2048 sc1 lds
    buffer_load_dwordx4 v1, s[8:11], s22 offen offset:3072 sc1 lds
    s_add_u32 s22, s22, 4096
    s_mov_b32 m0, s23
    s_add_u32 s23, s23, 4096
    buffer_load_dwordx4 v1, s[8:11], s22 offen offset:0 sc1 lds
    buffer_load_dwordx4 v1, s[8:11], s22 offen offset:1024 sc1 lds
    s_waitcnt vmcnt(0)
    s_branch Lrun_202
.p2align 2
.type interleave_layers__memory_aug_recurrent_mem_tr__glu_gated_glu__prompt_kernel_tab,@object
interleave_layers__memory_aug_recurrent_mem_tr__glu_gated_glu__prompt_kernel_tab:
.long 0x1, 0x101, 0x201, 0x301, 0x401, 0x501, 0x601, 0x701
.long 0x801, 0x901, 0xa01, 0xb01, 0xc01, 0xd01, 0xe01, 0xf01
.long 0x2, 0x102, 0x202, 0x302, 0x402, 0x502, 0x602, 0x702
.long 0x802, 0x902, 0xa02, 0xb02, 0xc02, 0xd02, 0x0, 0x0
.long 0x11, 0x111, 0x211, 0x311, 0x411, 0x511, 0x611, 0x711
.long 0x811, 0x911, 0xa11, 0xb11, 0xc11, 0xd11, 0xe11, 0xf11
.long 0x12, 0x112, 0x212, 0x312, 0x412, 0x512, 0x612, 0x712
.long 0x812, 0x912, 0xa12, 0xb12, 0xc12, 0xd12, 0x0, 0x0
.long 0x3, 0x10003, 0x20003, 0x30003, 0x4, 0x10004, 0x20004, 0x603
.long 0x10603, 0x20603, 0x30603, 0x604, 0x10604, 0x20604, 0xc03, 0x10c03
.long 0x20c03, 0x30c03, 0xc04, 0x10c04, 0x20c04, 0x6, 0x106, 0x206
.long 0x306, 0x406, 0x506, 0x606, 0x10705, 0x805, 0x10805, 0x905
.long 0x103, 0x10103, 0x20103, 0x30103, 0x104, 0x10104, 0x20104, 0x703
.long 0x10703, 0x20703, 0x30703, 0x704, 0x10704, 0x20704, 0xd03, 0x10d03
.long 0x20d03, 0x30d03, 0xd04, 0x10d04, 0x20d04, 0x10006, 0x10106, 0x10206
.long 0x10306, 0x10406, 0x10506, 0x10606, 0x10905, 0xa05, 0x10a05, 0xb05
.long 0x203, 0x10203, 0x20203, 0x30203, 0x204, 0x10204, 0x20204, 0x803
.long 0x10803, 0x20803, 0x30803, 0x804, 0x10804, 0x20804, 0xe03, 0x10e03
.long 0x20e03, 0x30e03, 0xe04, 0x10e04, 0x20e04, 0x20006, 0x20106, 0x20206
.long 0x20306, 0x20406, 0x20506, 0x20606, 0x10b05, 0xc05, 0x10c05, 0xd05
.long 0x303, 0x10303, 0x20303, 0x30303, 0x304, 0x10304, 0x20304, 0x903
.long 0x10903, 0x20903, 0x30903, 0x904, 0x10904, 0x20904, 0xf03, 0x10f03
.long 0x20f03, 0x30f03, 0xf04, 0x10f04, 0x20f04, 0x30006, 0x30106, 0x30206
.long 0x30306, 0x30406, 0x30506, 0x30606, 0x10d05, 0x0, 0x0, 0x0
.long 0x403, 0x10403, 0x20403, 0x30403, 0x404, 0x10404, 0x20404, 0xa03
.long 0x10a03, 0x20a03, 0x30a03, 0xa04, 0x10a04, 0x20a04, 0x7, 0x107
.long 0x207, 0x307, 0x407, 0x507, 0x607, 0x10007, 0x10107, 0x10207
.long 0x10307, 0x10407, 0x10507, 0x10607, 0x5, 0x10005, 0x105, 0x10105
.long 0x503, 0x10503, 0x20503, 0x30503, 0x504, 0x10504, 0x20504, 0xb03
.long 0x10b03, 0x20b03, 0x30b03, 0xb04, 0x10b04, 0x20b04, 0x20007, 0x20107
.long 0x20207, 0x20307, 0x20407, 0x20507, 0x20607, 0x205, 0x10205, 0x305
.long 0x10305, 0x405, 0x10405, 0x505, 0x10505, 0x605, 0x10605, 0x705
.section .rodata,"a"
.p2align 6
.amdhsa_kernel interleave_layers__memory_aug_recurrent_mem_tr__glu_gated_glu__prompt_kernel
.amdhsa_next_free_vgpr 512
.amdhsa_next_free_sgpr 102
.amdhsa_accum_offset 256
.amdhsa_group_segment_fixed_size 0
.amdhsa_kernarg_size 112
.amdhsa_user_sgpr_count 2
.amdhsa_user_sgpr_kernarg_segment_ptr 1
.amdhsa_system_sgpr_workgroup_id_x 1
.end_amdhsa_kernel
```
